```python
import torch

def _softmax(x, axis=-1):
    return torch.softmax(x, dim=axis)
def _gelu(x):
    return torch.nn.functional.gelu(x, approximate="tanh")
def _silu(x):
    return torch.nn.functional.silu(x)
def _sigmoid(x):
    return torch.sigmoid(x)
def _layernorm(x, axis=-1, eps=1e-5):
    m = x.mean(dim=axis, keepdim=True)
    v = x.var(dim=axis, keepdim=True, unbiased=False)
    return (x - m) / torch.sqrt(v + eps)
def _scatter_add(tgt, idx, src, axis=0):
    return tgt.clone().index_add_(axis, idx, src)
def _segment_sum(src, seg, n):
    out = torch.zeros((n,) + src.shape[1:], dtype=src.dtype)
    return out.index_add_(0, seg, src)
def _pad(x, pw):
    flat = tuple(v for pair in reversed(pw) for v in pair)
    return torch.nn.functional.pad(x, flat)

kernel_name = 'interleave_layers__sliding_block__glu_gated_bilinear__prompt'

def setup_inputs():

    _w = (lambda a: (lambda t: t.to(torch.bfloat16) if t.is_floating_point() else t)(torch.as_tensor(a)))
    def _A_setup():
        B, S, D = 1, 2048, 512
        return {
            "x": _w((lambda *s: torch.randn(*s, dtype=torch.bfloat16) * 0.05)(B, S, D)),
            "wqkv": _w((lambda *s: torch.randn(*s, dtype=torch.bfloat16) * 0.05)(D, 3 * D)),
            "wo": _w((lambda *s: torch.randn(*s, dtype=torch.bfloat16) * 0.05)(D, D)),
        }
    _A_in = _A_setup()

    def _B_setup():
        B, S, D, F = 1, 2048, 512, 1376
        return {
            "x": _w((lambda *s: torch.randn(*s, dtype=torch.bfloat16) * 0.05)(B, S, D)),
            "w_gate": _w((lambda *s: torch.randn(*s, dtype=torch.bfloat16) * 0.8)(D, F) * (D ** -0.5)),
            "w_up": _w((lambda *s: torch.randn(*s, dtype=torch.bfloat16) * 0.8)(D, F) * (D ** -0.5)),
            "w_down": _w((lambda *s: torch.randn(*s, dtype=torch.bfloat16) * 0.8)(F, D) * (F ** -0.5)),
        }
    _B_in = _B_setup()

    return {
        "A_x": _A_in["x"],
        "A_wqkv": _A_in["wqkv"],
        "A_wo": _A_in["wo"],
        "B_x": _B_in["x"],
        "B_w_gate": _B_in["w_gate"],
        "B_w_up": _B_in["w_up"],
        "B_w_down": _B_in["w_down"],
    }

def reference(A_x, A_wqkv, A_wo, B_x, B_w_gate, B_w_up, B_w_down):
    def _A_ref(x, wqkv, wo):
        B, S, D = x.shape
        H = 32; Dh = D // H; W = 256
        qkv = (lambda x, *d: x.permute(*d))((x @ wqkv).reshape(B, S, 3, H, Dh), 2, 0, 3, 1, 4)
        q, k, v = qkv[0], qkv[1], qkv[2]
        scores = torch.einsum("bhqd,bhkd->bhqk", q, k) * (Dh ** -0.5)
        idx = torch.arange(S)
        mask = (idx[:, None] - idx[None, :] >= 0) & (idx[:, None] - idx[None, :] < W)
        scores = torch.where(mask[None, None], scores, -1e9)
        p = _softmax(scores, axis=-1)
        o = torch.einsum("bhqk,bhkd->bhqd", p, v)
        return (lambda x, *d: x.permute(*d))(o, 0, 2, 1, 3).reshape(B, S, D) @ wo

    def _B_ref(x, w_gate, w_up, w_down):
        g = torch.einsum("bsd,df->bsf", x, w_gate)
        u = torch.einsum("bsd,df->bsf", x, w_up)
        h = g * u
        return torch.einsum("bsf,fd->bsd", h, w_down)

    x = A_x
    x = x + _A_ref(_layernorm(x, axis=-1), A_wqkv, A_wo)
    x = x + _B_ref(_layernorm(x, axis=-1), B_w_gate, B_w_up, B_w_down)
    x = x + _A_ref(_layernorm(x, axis=-1), A_wqkv, A_wo)
    x = x + _B_ref(_layernorm(x, axis=-1), B_w_gate, B_w_up, B_w_down)
    return x
```

```asm
; @launch grid=(256,1,1) block=(256,1,1) lds=163840
.amdgcn_target "amdgcn-amd-amdhsa--gfx950"
.text
.globl interleave_layers__sliding_block__glu_gated_bilinear__prompt_kernel
.p2align 8
.type interleave_layers__sliding_block__glu_gated_bilinear__prompt_kernel,@function
interleave_layers__sliding_block__glu_gated_bilinear__prompt_kernel:
 s_load_dwordx16 s[32:47], s[0:1], 0
 s_load_dwordx2 s[48:49], s[0:1], 72
 s_cmp_ge_u32 s2, 256
 s_cbranch_scc1 L_exit
 v_lshrrev_b32 v1, 6, v0
 v_and_b32 v0, 63, v0
 v_readfirstlane_b32 s50, v1
 v_lshlrev_b32 v0, 4, v0
 s_and_b32 s53, s2, 7
 s_lshr_b32 s54, s2, 3
 s_lshr_b32 s51, s54, 4
 s_lshl1_add_u32 s51, s53, s51
 s_and_b32 s52, s54, 15
 s_lshl2_add_u32 s58, s51, s50
 s_lshl_b32 s65, s50, 12
 s_add_u32 s3, s54, 8
 s_lshr_b32 s3, s3, 4
 s_lshl_b32 s3, s3, 1
 s_sub_u32 s72, s54, s3
 s_and_b32 s3, s54, 14
 s_cmp_eq_u32 s3, 6
 s_cselect_b32 s72, 99, s72
 s_mov_b32 s6, 268435456
 s_mov_b32 s7, 0x20000
 s_mov_b32 s10, 2097152
 s_mov_b32 s11, 0x20000
 s_mov_b32 s14, 1572864
 s_mov_b32 s15, 0x20000
 s_mov_b32 s18, 2097152
 s_mov_b32 s19, 0x20000
 s_mov_b32 s26, 1409024
 s_mov_b32 s27, 0x20000
 s_mov_b32 s23, 0x20000
 v_lshrrev_b32 v1, 4, v0
 v_lshrrev_b32 v192, 3, v1
 v_lshlrev_b32 v192, 10, v192
 v_and_b32 v2, 0x70, v0
 v_add_u32 v192, v192, v2
 v_and_b32 v2, 0x30, v1
 v_xor_b32 v194, v192, v2
 v_xor_b32 v195, 64, v194
 v_lshrrev_b32 v193, 2, v1
 v_mul_u32_u24 v193, 3072, v193
 v_and_b32 v2, 0x30, v0
 s_lshl_b32 s28, s52, 6
 v_add3_u32 v193, v193, v2, s28
 v_and_b32 v3, 0x200, v0
 v_add_u32 v3, v3, v0
 s_lshl4_add_u32 s28, s58, s52
 s_lshl_b32 s28, s28, 11
 s_lshl2_add_u32 s29, s54, s50
 s_waitcnt lgkmcnt(0)
 s_mov_b64 s[8:9], s[32:33]
 s_mov_b64 s[12:13], s[34:35]
 s_mov_b64 s[24:25], s[40:41]
 s_lshl_b32 s35, s58, 15
 s_cmp_lt_u32 s29, 32
 s_cselect_b64 s[20:21], s[36:37], s[44:45]
 s_mov_b32 s22, 1409024
 s_cselect_b32 s22, 524288, s22
 s_cselect_b32 s31, 0, 32
 s_mul_i32 s33, s50, 49152
 s_mul_i32 s34, s50, 3072
 s_add_u32 s34, s34, 65536
 s_add_u32 m0, s65, 16384
 s_add_u32 s32, s35, 0
 buffer_load_dwordx4 v194, s[8:11], s32 offen lds
 s_add_u32 m0, s65, 17408
 s_add_u32 s32, s35, 8192
 buffer_load_dwordx4 v195, s[8:11], s32 offen lds
 s_add_u32 m0, s65, 18432
 s_add_u32 s32, s35, 16384
 buffer_load_dwordx4 v194, s[8:11], s32 offen lds
 s_add_u32 m0, s65, 19456
 s_add_u32 s32, s35, 24576
 buffer_load_dwordx4 v195, s[8:11], s32 offen lds
 s_add_u32 m0, s34, 0
 s_add_u32 s32, s33, 0
 buffer_load_dwordx4 v193, s[12:15], s32 offen offset:1024 lds
 buffer_load_dwordx4 v193, s[12:15], s32 offen offset:2048 lds
 buffer_load_dwordx4 v[200:203], v3, s[8:11], s28 offen offset:0
 buffer_load_dwordx4 v[204:207], v3, s[8:11], s28 offen offset:512
 s_lshl3_add_u32 s3, s72, s53
 s_lshl2_add_u32 s3, s3, s50
 s_mul_i32 s3, s3, 1792
 v_lshl_add_u32 v2, v0, 3, s3
 s_lshl2_add_u32 s3, s72, s50
 s_mul_i32 s3, s3, 14336
 s_add_u32 s3, s3, 4294953344
 v_cmp_gt_u32 vcc, 224, v0
 v_lshl_add_u32 v4, v0, 6, s3
 s_nop 0
 v_cndmask_b32 v2, v4, v2, vcc
 s_mov_b64 exec, 0xfffffff
 buffer_load_dword v4, v2, s[12:15], 0 offen
 s_mov_b64 exec, -1
 s_load_dword s55, s[48:49], 0
 s_mov_b64 s[4:5], s[48:49]
 s_mov_b64 s[16:17], s[46:47]
 s_sub_u32 s31, s29, s31
 s_lshl_b32 s31, s31, 14
 s_lshl_b32 s3, s53, 7
 s_add_u32 s31, s31, s3
 s_mov_b32 s37, s31
 s_mul_i32 s38, s53, 241664
 s_lshl_b32 s3, s29, 11
 s_add_u32 s38, s38, s3
 s_add_u32 s38, s38, 23068672
 s_cmp_lt_u32 s29, 118
 s_cselect_b32 s38, s38, 2146435072
 s_lshl_b32 s39, s2, 7
 s_add_u32 s39, s39, 786432
 s_cmp_eq_u32 s50, 0
 s_cselect_b32 s39, s39, 2146435072
 s_mul_i32 s59, s58, 36864
 s_add_u32 s59, s59, 1048576
 s_mul_i32 s60, s58, 90112
 s_add_u32 s60, s60, 4194304
 s_lshl_b32 s61, s58, 11
 s_add_u32 s61, s61, 3407872
 s_lshr_b32 s28, s52, 3
 s_lshl_b32 s28, s28, 1
 s_lshl2_add_u32 s28, s51, s28
 s_lshr_b32 s70, s50, 1
 s_add_u32 s62, s28, s70
 s_xor_b32 s63, s62, 1
 s_sub_u32 s71, 3, s70
 s_and_b32 s28, s52, 7
 s_and_b32 s29, s50, 1
 s_lshl1_add_u32 s64, s28, s29
 s_mov_b32 s57, 400000
 s_mov_b32 s66, 0x0000ffff
 s_mov_b32 s67, 0x0000ffff
 s_getreg_b32 s56, hwreg(HW_REG_XCC_ID, 0, 4)
 v_bfe_u32 v2, v1, 1, 3
 v_lshrrev_b32 v3, 5, v1
 v_xor_b32 v2, v2, v3
 v_and_b32 v3, 31, v1
 v_lshlrev_b32 v14, 6, v3
 v_lshlrev_b32 v3, 7, v3
 v_lshl_add_u32 v196, v2, 4, v3
 v_add_u32 v196, s65, v196
 v_xor_b32 v197, 32, v196
 v_xor_b32 v198, 64, v196
 v_xor_b32 v199, 96, v196
 v_bfe_u32 v28, v0, 6, 2
 v_lshrrev_b32 v2, 9, v0
 v_mad_u32_u24 v28, v2, 8, v28
 v_mul_u32_u24 v28, 64, v28
 v_bfe_u32 v2, v0, 8, 1
 v_mul_u32_u24 v2, 32, v2
 s_add_u32 m0, s65, 32768
 s_add_u32 s32, s35, 128
 buffer_load_dwordx4 v194, s[8:11], s32 offen lds
 v_add_u32 v28, v28, v2
 v_bfe_u32 v2, v0, 4, 2
 v_lshl_add_u32 v28, v2, 3, v28
 v_add_u32 v28, 65536, v28
 v_add_u32 v29, 49152, v28
 s_and_b32 s28, s50, 1
 s_mul_i32 s29, s70, 3
 s_add_u32 s28, s28, s29
 s_lshl_b32 s28, s28, 10
 v_add_u32 v20, s28, v28
 v_add_u32 v21, s28, v29
 v_mov_b32 v16, 0x3f803f80
 v_mov_b32 v17, 0x3f803f80
 v_mov_b32 v18, 0x3f803f80
 v_mov_b32 v19, 0x3f803f80
 v_bfe_u32 v30, v0, 6, 2
 v_lshrrev_b32 v2, 9, v0
 v_mad_u32_u24 v30, v2, 4, v30
 s_add_u32 m0, s65, 33792
 s_add_u32 s32, s35, 8320
 buffer_load_dwordx4 v195, s[8:11], s32 offen lds
 v_mul_u32_u24 v30, 128, v30
 v_bfe_u32 v2, v0, 8, 1
 v_mul_u32_u24 v2, 32, v2
 v_add_u32 v30, v30, v2
 v_bfe_u32 v2, v0, 4, 2
 v_lshl_add_u32 v30, v2, 3, v30
 v_add_u32 v30, s65, v30
 v_and_b32 v2, 15, v1
 s_lshl_b32 s28, s50, 1
 s_mul_i32 s29, s50, 5
 s_add_u32 s29, s29, 6
 v_add_u32 v12, s28, v2
 v_add_u32 v13, s29, v2
 v_cmp_gt_u32 vcc, 2, v2
 v_min_u32 v3, 8, v2
 v_add_u32 v3, 21, v3
 v_cndmask_b32 v12, v13, v12, vcc
 v_cmp_gt_u32 vcc, 7, v2
 s_add_u32 m0, s65, 34816
 s_add_u32 s32, s35, 16512
 buffer_load_dwordx4 v194, s[8:11], s32 offen lds
 s_lshr_b32 s28, s64, 1
 s_lshl_b32 s28, s28, 7
 v_cndmask_b32 v12, v3, v12, vcc
 s_add_u32 s28, s28, 786432
 v_lshl_add_u32 v12, v12, 10, s28
 s_lshl_b32 s28, s50, 6
 s_add_u32 s28, s28, s53
 s_lshl_b32 s28, s28, 7
 s_add_u32 s28, s28, 4096
 v_cmp_gt_u32 vcc, 32, v1
 v_and_b32 v2, 7, v1
 v_lshl_add_u32 v13, v2, 10, s28
 v_cndmask_b32 v12, v13, v12, vcc
 s_waitcnt lgkmcnt(0)
 s_and_b32 s55, s55, 0xfffffff0
 s_add_u32 s55, s55, 0x9e3779b0
 s_or_b32 s56, s56, s55
 s_add_u32 m0, s65, 35840
 s_add_u32 s32, s35, 24704
 buffer_load_dwordx4 v195, s[8:11], s32 offen lds
 s_getpc_b64 s[30:31]
L_pc:
 s_lshl2_add_u32 s3, s54, s50
 s_mul_i32 s3, s3, 512
 v_lshl_add_u32 v2, v0, 3, s3
 v_min_u32 v2, L_codeend-L_pc-4, v2
 s_mov_b64 exec, 15
 global_load_dword v15, v2, s[30:31]
 s_mov_b64 exec, -1
 s_mul_i32 s28, s62, 36864
 s_lshl_b32 s29, s64, 8
 s_add_u32 s28, s28, s29
 s_add_u32 s28, s28, 1081216
 s_lshl_b32 s29, s52, 7
 s_add_u32 s29, s29, s61
 v_lshl_add_u32 v1, v0, 3, s28
 v_writelane_b32 v1, s29, 0
 s_mov_b64 exec, 7
 buffer_load_dword v31, v1, s[4:7], 0 offen
 s_mov_b64 exec, -1
 s_waitcnt vmcnt(11)
 ds_read_b128 v[32:35], v196 offset:16384
 ds_read_b128 v[36:39], v197 offset:16384
 ds_read_b128 v[40:43], v198 offset:16384
 ds_read_b128 v[44:47], v199 offset:16384
 s_waitcnt vmcnt(9)
 s_barrier
 ds_read_b64_tr_b16 a[240:241], v28 offset:1024
 ds_read_b64_tr_b16 a[242:243], v28 offset:1280
 ds_read_b64_tr_b16 a[244:245], v28 offset:2048
 ds_read_b64_tr_b16 a[246:247], v28 offset:2304
 ds_read_b64_tr_b16 a[248:249], v28 offset:4096
 ds_read_b64_tr_b16 a[250:251], v28 offset:4352
 ds_read_b64_tr_b16 a[252:253], v28 offset:5120
 ds_read_b64_tr_b16 a[254:255], v28 offset:5376
 s_lshl_b32 s28, s2, 7
 s_add_u32 s28, s28, 4096
 s_cmp_eq_u32 s50, 1
 s_cselect_b32 s28, s28, 2146435072
 v_lshrrev_b32 v1, 2, v0
 v_mov_b32 v2, s56
 s_mov_b32 exec_hi, 0
 buffer_store_dword v2, v1, s[4:7], s28 offen sc1
 s_mov_b32 exec_hi, -1
 s_waitcnt lgkmcnt(6)
 v_mfma_f32_32x32x16_bf16 v[160:175], a[240:243], v[32:35], 0
 s_add_u32 m0, s34, 12288
 s_add_u32 s32, s33, 196608
 buffer_load_dwordx4 v193, s[12:15], s32 offen offset:1024 lds
 v_mov_b32 v8, 0
 v_mov_b32 v10, 0
 s_waitcnt vmcnt(10)
 v_dot2_f32_bf16 v8, v200, v16, v8
 v_dot2_f32_bf16 v10, v200, v200, v10
 v_dot2_f32_bf16 v8, v201, v16, v8
 v_dot2_f32_bf16 v10, v201, v201, v10
 ds_read_b64_tr_b16 a[240:241], v20 offset:1024
 ds_read_b64_tr_b16 a[242:243], v20 offset:1280
 s_waitcnt lgkmcnt(6)
 v_mfma_f32_32x32x16_bf16 v[176:191], v[32:35], a[244:247], 0
 buffer_load_dwordx4 v193, s[12:15], s32 offen offset:2048 lds
 s_add_u32 m0, s65, 0
 s_nop 0
 buffer_load_dwordx4 v192, s[20:23], s37 offen lds
 s_add_u32 m0, s65, 1024
 s_add_u32 s37, s37, 8192
 buffer_load_dwordx4 v192, s[20:23], s37 offen lds
 s_mov_b64 s[20:21], s[42:43]
 s_mov_b32 s22, 1409024
 v_dot2_f32_bf16 v8, v202, v16, v8
 v_dot2_f32_bf16 v10, v202, v202, v10
 v_dot2_f32_bf16 v8, v203, v16, v8
 v_dot2_f32_bf16 v10, v203, v203, v10
 s_waitcnt vmcnt(12)
 v_dot2_f32_bf16 v8, v204, v16, v8
 v_dot2_f32_bf16 v10, v204, v204, v10
 ds_read_b64_tr_b16 a[244:245], v28 offset:7168
 ds_read_b64_tr_b16 a[246:247], v28 offset:7424
 s_waitcnt lgkmcnt(6)
 v_mfma_f32_32x32x16_bf16 v[160:175], a[248:251], v[36:39], v[160:175]
 s_add_u32 m0, s65, 49152
 s_add_u32 s32, s35, 256
 buffer_load_dwordx4 v194, s[8:11], s32 offen lds
 v_dot2_f32_bf16 v8, v205, v16, v8
 v_dot2_f32_bf16 v10, v205, v205, v10
 v_dot2_f32_bf16 v8, v206, v16, v8
 v_dot2_f32_bf16 v10, v206, v206, v10
 v_dot2_f32_bf16 v8, v207, v16, v8
 v_dot2_f32_bf16 v10, v207, v207, v10
 ds_read_b64_tr_b16 a[248:249], v28 offset:8192
 ds_read_b64_tr_b16 a[250:251], v28 offset:8448
 s_waitcnt lgkmcnt(6)
 v_mfma_f32_32x32x16_bf16 v[176:191], v[36:39], a[252:255], v[176:191]
 s_add_u32 m0, s65, 50176
 s_add_u32 s32, s35, 8448
 buffer_load_dwordx4 v195, s[8:11], s32 offen lds
 v_mov_b32 v25, s55
 v_mov_b32 v27, s55
 v_lshrrev_b32 v2, 9, v0
 v_and_b32 v3, 0x30, v0
 v_lshl_add_u32 v2, v2, 6, v3
 v_add_f32_dpp v8, v8, v8 quad_perm:[1,0,3,2] row_mask:0xf bank_mask:0xf
 ds_read_b64_tr_b16 a[252:253], v28 offset:10240
 ds_read_b64_tr_b16 a[254:255], v28 offset:10496
 s_waitcnt lgkmcnt(6)
 v_mfma_f32_32x32x16_bf16 v[240:255], v[16:19], a[240:243], 0
 s_add_u32 m0, s65, 51200
 s_add_u32 s32, s35, 16640
 buffer_load_dwordx4 v194, s[8:11], s32 offen lds
 v_add_f32_dpp v10, v10, v10 quad_perm:[1,0,3,2] row_mask:0xf bank_mask:0xf
 v_add_f32_dpp v8, v8, v8 quad_perm:[2,3,0,1] row_mask:0xf bank_mask:0xf
 s_nop 0
 v_add_f32_dpp v10, v10, v10 quad_perm:[2,3,0,1] row_mask:0xf bank_mask:0xf
 v_add_f32_dpp v8, v8, v8 row_half_mirror row_mask:0xf bank_mask:0xf
 s_nop 0
 v_add_f32_dpp v10, v10, v10 row_half_mirror row_mask:0xf bank_mask:0xf
 v_add_f32_dpp v8, v8, v8 row_mirror row_mask:0xf bank_mask:0xf
 ds_read_b64_tr_b16 a[240:241], v28 offset:11264
 ds_read_b64_tr_b16 a[242:243], v28 offset:11520
 s_waitcnt lgkmcnt(6)
 v_mfma_f32_32x32x16_bf16 v[160:175], a[244:247], v[40:43], v[160:175]
 s_add_u32 m0, s65, 52224
 s_add_u32 s32, s35, 24832
 buffer_load_dwordx4 v195, s[8:11], s32 offen lds
 s_waitcnt vmcnt(11)
 ds_read_b128 v[48:51], v196 offset:32768
 ds_read_b128 v[52:55], v197 offset:32768
 ds_read_b128 v[56:59], v198 offset:32768
 ds_read_b128 v[60:63], v199 offset:32768
 v_add_f32_dpp v10, v10, v10 row_mirror row_mask:0xf bank_mask:0xf
 v_mov_b32 v9, v8
 v_mov_b32 v11, v10
 s_nop 0
 v_permlane16_swap_b32 v8, v9
 v_permlane16_swap_b32 v10, v11
 v_add_f32 v8, v8, v9
 ds_read_b64_tr_b16 a[244:245], v20 offset:7168
 ds_read_b64_tr_b16 a[246:247], v20 offset:7424
 s_waitcnt lgkmcnt(10)
 v_mfma_f32_32x32x16_bf16 v[176:191], v[40:43], a[248:251], v[176:191]
 s_add_u32 m0, s34, 24576
 s_add_u32 s32, s33, 393216
 buffer_load_dwordx4 v193, s[12:15], s32 offen offset:1024 lds
 v_add_f32 v10, v10, v11
 v_mul_f32 v8, 0xbb000000, v8
 v_mul_f32 v10, 0x3b000000, v10
 v_fma_f32 v10, -v8, v8, v10
 v_max_f32 v10, 0, v10
 v_add_f32 v10, 0x3727c5ac, v10
 s_waitcnt vmcnt(7)
 s_barrier
 ds_read_b64_tr_b16 a[248:249], v28 offset:13312
 ds_read_b64_tr_b16 a[250:251], v28 offset:13568
 s_waitcnt lgkmcnt(10)
 v_mfma_f32_32x32x16_bf16 v[160:175], a[252:255], v[44:47], v[160:175]
 buffer_load_dwordx4 v193, s[12:15], s32 offen offset:2048 lds
 v_rsq_f32 v26, v10
 v_cvt_pk_bf16_f32 v24, v8, v8
 s_lshl4_add_u32 s28, s58, s52
 s_lshl_b32 s28, s28, 7
 s_add_u32 s28, s28, 917504
 s_mov_b32 exec_lo, 15
 s_mov_b32 exec_hi, 15
 buffer_store_dwordx4 v[24:27], v2, s[4:7], s28 offen sc1
 s_mov_b64 exec, -1
 ds_read_b64_tr_b16 a[252:253], v28 offset:14336
 ds_read_b64_tr_b16 a[254:255], v28 offset:14592
 s_waitcnt lgkmcnt(10)
 v_mfma_f32_32x32x16_bf16 v[176:191], v[44:47], a[240:243], v[176:191]
 s_add_u32 m0, s65, 16384
 s_add_u32 s32, s35, 384
 buffer_load_dwordx4 v194, s[8:11], s32 offen lds
 ds_read_b64_tr_b16 a[240:241], v28 offset:16384
 ds_read_b64_tr_b16 a[242:243], v28 offset:16640
 s_waitcnt lgkmcnt(6)
 v_mfma_f32_32x32x16_bf16 v[240:255], v[16:19], a[244:247], v[240:255]
 s_add_u32 m0, s65, 17408
 s_add_u32 s32, s35, 8576
 buffer_load_dwordx4 v195, s[8:11], s32 offen lds
 ds_read_b64_tr_b16 a[244:245], v28 offset:17408
 ds_read_b64_tr_b16 a[246:247], v28 offset:17664
 s_waitcnt lgkmcnt(6)
 v_mfma_f32_32x32x16_bf16 v[160:175], a[248:251], v[48:51], v[160:175]
 s_add_u32 m0, s65, 18432
 s_add_u32 s32, s35, 16768
 buffer_load_dwordx4 v194, s[8:11], s32 offen lds
 ds_read_b64_tr_b16 a[248:249], v20 offset:13312
 ds_read_b64_tr_b16 a[250:251], v20 offset:13568
 s_waitcnt lgkmcnt(6)
 v_mfma_f32_32x32x16_bf16 v[176:191], v[48:51], a[252:255], v[176:191]
 s_add_u32 m0, s65, 19456
 s_add_u32 s32, s35, 24960
 buffer_load_dwordx4 v195, s[8:11], s32 offen lds
 ds_read_b64_tr_b16 a[252:253], v28 offset:19456
 ds_read_b64_tr_b16 a[254:255], v28 offset:19712
 s_waitcnt lgkmcnt(6)
 v_mfma_f32_32x32x16_bf16 v[160:175], a[240:243], v[52:55], v[160:175]
 ds_read_b64_tr_b16 a[240:241], v28 offset:20480
 ds_read_b64_tr_b16 a[242:243], v28 offset:20736
 s_waitcnt lgkmcnt(6)
 v_mfma_f32_32x32x16_bf16 v[176:191], v[52:55], a[244:247], v[176:191]
 s_add_u32 m0, s34, 36864
 s_add_u32 s32, s33, 589824
 buffer_load_dwordx4 v193, s[12:15], s32 offen offset:1024 lds
 ds_read_b64_tr_b16 a[244:245], v28 offset:22528
 ds_read_b64_tr_b16 a[246:247], v28 offset:22784
 s_waitcnt lgkmcnt(6)
 v_mfma_f32_32x32x16_bf16 v[240:255], v[16:19], a[248:251], v[240:255]
 ds_read_b64_tr_b16 a[248:249], v28 offset:23552
 ds_read_b64_tr_b16 a[250:251], v28 offset:23808
 s_waitcnt lgkmcnt(6)
 v_mfma_f32_32x32x16_bf16 v[160:175], a[252:255], v[56:59], v[160:175]
 buffer_load_dwordx4 v193, s[12:15], s32 offen offset:2048 lds
 s_waitcnt vmcnt(9)
 ds_read_b128 v[64:67], v196 offset:49152
 ds_read_b128 v[68:71], v197 offset:49152
 ds_read_b128 v[72:75], v198 offset:49152
 ds_read_b128 v[76:79], v199 offset:49152
 ds_read_b64_tr_b16 a[252:253], v20 offset:19456
 ds_read_b64_tr_b16 a[254:255], v20 offset:19712
 s_waitcnt lgkmcnt(10)
 v_mfma_f32_32x32x16_bf16 v[176:191], v[56:59], a[240:243], v[176:191]
 s_add_u32 m0, s65, 32768
 s_add_u32 s32, s35, 512
 buffer_load_dwordx4 v194, s[8:11], s32 offen lds
 s_waitcnt vmcnt(8)
 s_barrier
 ds_read_b64_tr_b16 a[240:241], v28 offset:25600
 ds_read_b64_tr_b16 a[242:243], v28 offset:25856
 s_waitcnt lgkmcnt(10)
 v_mfma_f32_32x32x16_bf16 v[160:175], a[244:247], v[60:63], v[160:175]
 ds_read_b64_tr_b16 a[244:245], v28 offset:26624
 ds_read_b64_tr_b16 a[246:247], v28 offset:26880
 s_waitcnt lgkmcnt(10)
 v_mfma_f32_32x32x16_bf16 v[176:191], v[60:63], a[248:251], v[176:191]
 s_add_u32 m0, s65, 33792
 s_add_u32 s32, s35, 8704
 buffer_load_dwordx4 v195, s[8:11], s32 offen lds
 ds_read_b64_tr_b16 v[200:201], v30 offset:0
 ds_read_b64_tr_b16 v[202:203], v30 offset:1024
 ds_read_b64_tr_b16 v[204:205], v30 offset:64
 ds_read_b64_tr_b16 v[206:207], v30 offset:1088
 ds_read_b64_tr_b16 a[248:249], v28 offset:28672
 ds_read_b64_tr_b16 a[250:251], v28 offset:28928
 s_waitcnt lgkmcnt(10)
 v_mfma_f32_32x32x16_bf16 v[240:255], v[16:19], a[252:255], v[240:255]
 ds_read_b64_tr_b16 a[252:253], v28 offset:29696
 ds_read_b64_tr_b16 a[254:255], v28 offset:29952
 s_waitcnt lgkmcnt(10)
 v_mfma_f32_32x32x16_bf16 v[160:175], a[240:243], v[64:67], v[160:175]
 s_add_u32 m0, s65, 34816
 s_add_u32 s32, s35, 16896
 buffer_load_dwordx4 v194, s[8:11], s32 offen lds
 ds_read_b64_tr_b16 a[240:241], v20 offset:25600
 ds_read_b64_tr_b16 a[242:243], v20 offset:25856
 s_waitcnt lgkmcnt(10)
 v_mfma_f32_32x32x16_bf16 v[176:191], v[64:67], a[244:247], v[176:191]
 s_add_u32 m0, s65, 35840
 s_add_u32 s32, s35, 25088
 buffer_load_dwordx4 v195, s[8:11], s32 offen lds
 s_waitcnt lgkmcnt(8)
 buffer_store_dwordx4 v[200:203], v0, s[4:7], s38 offen sc1
 ds_read_b64_tr_b16 a[244:245], v28 offset:31744
 ds_read_b64_tr_b16 a[246:247], v28 offset:32000
 s_waitcnt lgkmcnt(6)
 v_mfma_f32_32x32x16_bf16 v[160:175], a[248:251], v[68:71], v[160:175]
 ds_read_b64_tr_b16 a[248:249], v28 offset:32768
 ds_read_b64_tr_b16 a[250:251], v28 offset:33024
 s_waitcnt lgkmcnt(6)
 v_mfma_f32_32x32x16_bf16 v[176:191], v[68:71], a[252:255], v[176:191]
 s_add_u32 m0, s34, 49152
 s_add_u32 s32, s33, 786432
 buffer_load_dwordx4 v193, s[12:15], s32 offen offset:1024 lds
 buffer_store_dwordx4 v[204:207], v0, s[4:7], s38 offen offset:1024 sc1
 ds_read_b64_tr_b16 a[252:253], v28 offset:34816
 ds_read_b64_tr_b16 a[254:255], v28 offset:35072
 s_waitcnt lgkmcnt(6)
 v_mfma_f32_32x32x16_bf16 v[240:255], v[16:19], a[240:243], v[240:255]
 v_bfe_u32 v223, v0, 4, 5
 ds_read_b64_tr_b16 a[240:241], v28 offset:35840
 ds_read_b64_tr_b16 a[242:243], v28 offset:36096
 s_waitcnt lgkmcnt(6)
 v_mfma_f32_32x32x16_bf16 v[160:175], a[244:247], v[72:75], v[160:175]
 buffer_load_dwordx4 v193, s[12:15], s32 offen offset:2048 lds
 s_waitcnt vmcnt(10)
 ds_read_b128 v[80:83], v196 offset:16384
 ds_read_b128 v[84:87], v197 offset:16384
 ds_read_b128 v[88:91], v198 offset:16384
 ds_read_b128 v[92:95], v199 offset:16384
 v_lshrrev_b32 v239, 9, v0
 ds_read_b64_tr_b16 a[244:245], v20 offset:31744
 ds_read_b64_tr_b16 a[246:247], v20 offset:32000
 s_waitcnt lgkmcnt(10)
 v_mfma_f32_32x32x16_bf16 v[176:191], v[72:75], a[248:251], v[176:191]
 s_add_u32 m0, s65, 49152
 s_add_u32 s32, s35, 640
 buffer_load_dwordx4 v194, s[8:11], s32 offen lds
 v_lshlrev_b32 v239, 2, v239
 s_waitcnt vmcnt(9)
 s_barrier
 ds_read_b64_tr_b16 a[248:249], v28 offset:37888
 ds_read_b64_tr_b16 a[250:251], v28 offset:38144
 s_waitcnt lgkmcnt(10)
 v_mfma_f32_32x32x16_bf16 v[160:175], a[252:255], v[76:79], v[160:175]
 v_sub_u32 v223, v223, v239
 ds_read_b64_tr_b16 a[252:253], v28 offset:38912
 ds_read_b64_tr_b16 a[254:255], v28 offset:39168
 s_waitcnt lgkmcnt(10)
 v_mfma_f32_32x32x16_bf16 v[176:191], v[76:79], a[240:243], v[176:191]
 s_add_u32 m0, s65, 50176
 s_add_u32 s32, s35, 8832
 buffer_load_dwordx4 v195, s[8:11], s32 offen lds
 v_mov_b32 v239, 0xf149f2ca
 ds_read_b64_tr_b16 a[240:241], v28 offset:40960
 ds_read_b64_tr_b16 a[242:243], v28 offset:41216
 s_waitcnt lgkmcnt(6)
 v_mfma_f32_32x32x16_bf16 v[240:255], v[16:19], a[244:247], v[240:255]
 v_cmp_le_i32 s[42:43], 0, v223
 ds_read_b64_tr_b16 a[244:245], v28 offset:41984
 ds_read_b64_tr_b16 a[246:247], v28 offset:42240
 s_waitcnt lgkmcnt(6)
 v_mfma_f32_32x32x16_bf16 v[160:175], a[248:251], v[80:83], v[160:175]
 s_add_u32 m0, s65, 51200
 s_add_u32 s32, s35, 17024
 buffer_load_dwordx4 v194, s[8:11], s32 offen lds
 v_cmp_le_i32 s[44:45], 1, v223
 ds_read_b64_tr_b16 a[248:249], v20 offset:37888
 ds_read_b64_tr_b16 a[250:251], v20 offset:38144
 s_waitcnt lgkmcnt(6)
 v_mfma_f32_32x32x16_bf16 v[176:191], v[80:83], a[252:255], v[176:191]
 s_add_u32 m0, s65, 52224
 s_add_u32 s32, s35, 25216
 buffer_load_dwordx4 v195, s[8:11], s32 offen lds
 v_cndmask_b32 v208, v239, 0, s[42:43]
 ds_read_b64_tr_b16 a[252:253], v28 offset:44032
 ds_read_b64_tr_b16 a[254:255], v28 offset:44288
 s_waitcnt lgkmcnt(6)
 v_mfma_f32_32x32x16_bf16 v[160:175], a[240:243], v[84:87], v[160:175]
 v_cndmask_b32 v224, 0, v239, s[42:43]
 ds_read_b64_tr_b16 a[240:241], v28 offset:45056
 ds_read_b64_tr_b16 a[242:243], v28 offset:45312
 s_waitcnt lgkmcnt(6)
 v_mfma_f32_32x32x16_bf16 v[176:191], v[84:87], a[244:247], v[176:191]
 s_add_u32 m0, s34, 61440
 s_add_u32 s32, s33, 983040
 buffer_load_dwordx4 v193, s[12:15], s32 offen offset:1024 lds
 v_cmp_le_i32 s[46:47], 2, v223
 ds_read_b64_tr_b16 a[244:245], v28 offset:47104
 ds_read_b64_tr_b16 a[246:247], v28 offset:47360
 s_waitcnt lgkmcnt(6)
 v_mfma_f32_32x32x16_bf16 v[240:255], v[16:19], a[248:251], v[240:255]
 v_cndmask_b32 v209, v239, 0, s[44:45]
 ds_read_b64_tr_b16 a[248:249], v28 offset:48128
 ds_read_b64_tr_b16 a[250:251], v28 offset:48384
 s_waitcnt lgkmcnt(6)
 v_mfma_f32_32x32x16_bf16 v[160:175], a[252:255], v[88:91], v[160:175]
 buffer_load_dwordx4 v193, s[12:15], s32 offen offset:2048 lds
 s_waitcnt vmcnt(10)
 ds_read_b128 v[96:99], v196 offset:32768
 ds_read_b128 v[100:103], v197 offset:32768
 ds_read_b128 v[104:107], v198 offset:32768
 ds_read_b128 v[108:111], v199 offset:32768
 v_cndmask_b32 v225, 0, v239, s[44:45]
 ds_read_b64_tr_b16 a[252:253], v20 offset:44032
 ds_read_b64_tr_b16 a[254:255], v20 offset:44288
 s_waitcnt lgkmcnt(10)
 v_mfma_f32_32x32x16_bf16 v[176:191], v[88:91], a[240:243], v[176:191]
 s_add_u32 m0, s65, 16384
 s_add_u32 s32, s35, 768
 buffer_load_dwordx4 v194, s[8:11], s32 offen lds
 v_cmp_le_i32 s[42:43], 3, v223
 s_waitcnt vmcnt(7)
 s_barrier
 v_lshrrev_b32 v1, 2, v0
 v_mov_b32 v2, s55
 s_mov_b32 exec_hi, 0
 buffer_store_dword v2, v1, s[4:7], s39 offen sc1
 s_mov_b32 exec_hi, -1
 ds_read_b64_tr_b16 a[240:241], v29 offset:1024
 ds_read_b64_tr_b16 a[242:243], v29 offset:1280
 s_waitcnt lgkmcnt(10)
 v_mfma_f32_32x32x16_bf16 v[160:175], a[244:247], v[92:95], v[160:175]
 v_cndmask_b32 v210, v239, 0, s[46:47]
 ds_read_b64_tr_b16 a[244:245], v29 offset:2048
 ds_read_b64_tr_b16 a[246:247], v29 offset:2304
 s_waitcnt lgkmcnt(10)
 v_mfma_f32_32x32x16_bf16 v[176:191], v[92:95], a[248:251], v[176:191]
 s_add_u32 m0, s65, 17408
 s_add_u32 s32, s35, 8960
 buffer_load_dwordx4 v195, s[8:11], s32 offen lds
 v_cndmask_b32 v226, 0, v239, s[46:47]
 ds_read_b64_tr_b16 a[248:249], v29 offset:4096
 ds_read_b64_tr_b16 a[250:251], v29 offset:4352
 s_waitcnt lgkmcnt(6)
 v_mfma_f32_32x32x16_bf16 v[240:255], v[16:19], a[252:255], v[240:255]
 v_cmp_le_i32 s[44:45], 8, v223
 ds_read_b64_tr_b16 a[252:253], v29 offset:5120
 ds_read_b64_tr_b16 a[254:255], v29 offset:5376
 s_waitcnt lgkmcnt(6)
 v_mfma_f32_32x32x16_bf16 v[160:175], a[240:243], v[96:99], v[160:175]
 s_add_u32 m0, s65, 18432
 s_add_u32 s32, s35, 17152
 buffer_load_dwordx4 v194, s[8:11], s32 offen lds
 v_cndmask_b32 v211, v239, 0, s[42:43]
 ds_read_b64_tr_b16 a[240:241], v21 offset:1024
 ds_read_b64_tr_b16 a[242:243], v21 offset:1280
 s_waitcnt lgkmcnt(6)
 v_mfma_f32_32x32x16_bf16 v[176:191], v[96:99], a[244:247], v[176:191]
 s_add_u32 m0, s65, 19456
 s_add_u32 s32, s35, 25344
 buffer_load_dwordx4 v195, s[8:11], s32 offen lds
 v_cndmask_b32 v227, 0, v239, s[42:43]
 ds_read_b64_tr_b16 a[244:245], v29 offset:7168
 ds_read_b64_tr_b16 a[246:247], v29 offset:7424
 s_waitcnt lgkmcnt(6)
 v_mfma_f32_32x32x16_bf16 v[160:175], a[248:251], v[100:103], v[160:175]
 v_cmp_le_i32 s[46:47], 9, v223
 ds_read_b64_tr_b16 a[248:249], v29 offset:8192
 ds_read_b64_tr_b16 a[250:251], v29 offset:8448
 s_waitcnt lgkmcnt(6)
 v_mfma_f32_32x32x16_bf16 v[176:191], v[100:103], a[252:255], v[176:191]
 s_add_u32 m0, s34, 73728
 s_add_u32 s32, s33, 1179648
 buffer_load_dwordx4 v193, s[12:15], s32 offen offset:1024 lds
 v_cndmask_b32 v212, v239, 0, s[44:45]
 ds_read_b64_tr_b16 a[252:253], v29 offset:10240
 ds_read_b64_tr_b16 a[254:255], v29 offset:10496
 s_waitcnt lgkmcnt(6)
 v_mfma_f32_32x32x16_bf16 v[240:255], v[16:19], a[240:243], v[240:255]
 v_cndmask_b32 v228, 0, v239, s[44:45]
 ds_read_b64_tr_b16 a[240:241], v29 offset:11264
 ds_read_b64_tr_b16 a[242:243], v29 offset:11520
 s_waitcnt lgkmcnt(6)
 v_mfma_f32_32x32x16_bf16 v[160:175], a[244:247], v[104:107], v[160:175]
 buffer_load_dwordx4 v193, s[12:15], s32 offen offset:2048 lds
 s_waitcnt vmcnt(9)
 ds_read_b128 v[112:115], v196 offset:49152
 ds_read_b128 v[116:119], v197 offset:49152
 ds_read_b128 v[120:123], v198 offset:49152
 ds_read_b128 v[124:127], v199 offset:49152
 v_cmp_le_i32 s[42:43], 10, v223
 ds_read_b64_tr_b16 a[244:245], v21 offset:7168
 ds_read_b64_tr_b16 a[246:247], v21 offset:7424
 s_waitcnt lgkmcnt(10)
 v_mfma_f32_32x32x16_bf16 v[176:191], v[104:107], a[248:251], v[176:191]
 s_add_u32 m0, s65, 32768
 s_add_u32 s32, s35, 896
 buffer_load_dwordx4 v194, s[8:11], s32 offen lds
 v_cndmask_b32 v213, v239, 0, s[46:47]
 s_waitcnt vmcnt(8)
 s_barrier
 ds_read_b64_tr_b16 a[248:249], v29 offset:13312
 ds_read_b64_tr_b16 a[250:251], v29 offset:13568
 s_waitcnt lgkmcnt(10)
 v_mfma_f32_32x32x16_bf16 v[160:175], a[252:255], v[108:111], v[160:175]
 v_cndmask_b32 v229, 0, v239, s[46:47]
 ds_read_b64_tr_b16 a[252:253], v29 offset:14336
 ds_read_b64_tr_b16 a[254:255], v29 offset:14592
 s_waitcnt lgkmcnt(10)
 v_mfma_f32_32x32x16_bf16 v[176:191], v[108:111], a[240:243], v[176:191]
 s_add_u32 m0, s65, 33792
 s_add_u32 s32, s35, 9088
 buffer_load_dwordx4 v195, s[8:11], s32 offen lds
 v_cmp_le_i32 s[44:45], 11, v223
 ds_read_b64_tr_b16 a[240:241], v29 offset:16384
 ds_read_b64_tr_b16 a[242:243], v29 offset:16640
 s_waitcnt lgkmcnt(6)
 v_mfma_f32_32x32x16_bf16 v[240:255], v[16:19], a[244:247], v[240:255]
 v_cndmask_b32 v214, v239, 0, s[42:43]
 ds_read_b64_tr_b16 a[244:245], v29 offset:17408
 ds_read_b64_tr_b16 a[246:247], v29 offset:17664
 s_waitcnt lgkmcnt(6)
 v_mfma_f32_32x32x16_bf16 v[160:175], a[248:251], v[112:115], v[160:175]
 s_add_u32 m0, s65, 34816
 s_add_u32 s32, s35, 17280
 buffer_load_dwordx4 v194, s[8:11], s32 offen lds
 v_cndmask_b32 v230, 0, v239, s[42:43]
 ds_read_b64_tr_b16 a[248:249], v21 offset:13312
 ds_read_b64_tr_b16 a[250:251], v21 offset:13568
 s_waitcnt lgkmcnt(6)
 v_mfma_f32_32x32x16_bf16 v[176:191], v[112:115], a[252:255], v[176:191]
 s_add_u32 m0, s65, 35840
 s_add_u32 s32, s35, 25472
 buffer_load_dwordx4 v195, s[8:11], s32 offen lds
 v_cmp_le_i32 s[46:47], 16, v223
 ds_read_b64_tr_b16 a[252:253], v29 offset:19456
 ds_read_b64_tr_b16 a[254:255], v29 offset:19712
 s_waitcnt lgkmcnt(6)
 v_mfma_f32_32x32x16_bf16 v[160:175], a[240:243], v[116:119], v[160:175]
 v_cndmask_b32 v215, v239, 0, s[44:45]
 ds_read_b64_tr_b16 a[240:241], v29 offset:20480
 ds_read_b64_tr_b16 a[242:243], v29 offset:20736
 s_waitcnt lgkmcnt(6)
 v_mfma_f32_32x32x16_bf16 v[176:191], v[116:119], a[244:247], v[176:191]
 s_add_u32 m0, s34, 86016
 s_add_u32 s32, s33, 1376256
 buffer_load_dwordx4 v193, s[12:15], s32 offen offset:1024 lds
 v_cndmask_b32 v231, 0, v239, s[44:45]
 ds_read_b64_tr_b16 a[244:245], v29 offset:22528
 ds_read_b64_tr_b16 a[246:247], v29 offset:22784
 s_waitcnt lgkmcnt(6)
 v_mfma_f32_32x32x16_bf16 v[240:255], v[16:19], a[248:251], v[240:255]
 v_cmp_le_i32 s[42:43], 17, v223
 ds_read_b64_tr_b16 a[248:249], v29 offset:23552
 ds_read_b64_tr_b16 a[250:251], v29 offset:23808
 s_waitcnt lgkmcnt(6)
 v_mfma_f32_32x32x16_bf16 v[160:175], a[252:255], v[120:123], v[160:175]
 buffer_load_dwordx4 v193, s[12:15], s32 offen offset:2048 lds
 s_waitcnt vmcnt(8)
 ds_read_b128 v[128:131], v196 offset:16384
 ds_read_b128 v[132:135], v197 offset:16384
 ds_read_b128 v[136:139], v198 offset:16384
 ds_read_b128 v[140:143], v199 offset:16384
 v_cndmask_b32 v216, v239, 0, s[46:47]
 ds_read_b64_tr_b16 a[252:253], v21 offset:19456
 ds_read_b64_tr_b16 a[254:255], v21 offset:19712
 s_waitcnt lgkmcnt(10)
 v_mfma_f32_32x32x16_bf16 v[176:191], v[120:123], a[240:243], v[176:191]
 s_lshl_b32 s36, s58, 11
 s_add_u32 s36, s36, 917504
 buffer_load_dwordx4 v[24:27], v14, s[4:7], s36 offen sc1
 v_cndmask_b32 v232, 0, v239, s[46:47]
 s_waitcnt vmcnt(7)
 s_barrier
 ds_read_b64_tr_b16 a[240:241], v29 offset:25600
 ds_read_b64_tr_b16 a[242:243], v29 offset:25856
 s_waitcnt lgkmcnt(10)
 v_mfma_f32_32x32x16_bf16 v[160:175], a[244:247], v[124:127], v[160:175]
 v_cmp_le_i32 s[44:45], 18, v223
 ds_read_b64_tr_b16 a[244:245], v29 offset:26624
 ds_read_b64_tr_b16 a[246:247], v29 offset:26880
 s_waitcnt lgkmcnt(10)
 v_mfma_f32_32x32x16_bf16 v[176:191], v[124:127], a[248:251], v[176:191]
 s_add_u32 m0, s34, 0
 s_add_u32 s32, s33, 0
 buffer_load_dwordx4 v193, s[12:15], s32 offen lds
 v_cndmask_b32 v217, v239, 0, s[42:43]
 ds_read_b64_tr_b16 a[248:249], v29 offset:28672
 ds_read_b64_tr_b16 a[250:251], v29 offset:28928
 s_waitcnt lgkmcnt(6)
 v_mfma_f32_32x32x16_bf16 v[240:255], v[16:19], a[252:255], v[240:255]
 v_cndmask_b32 v233, 0, v239, s[42:43]
 ds_read_b64_tr_b16 a[252:253], v29 offset:29696
 ds_read_b64_tr_b16 a[254:255], v29 offset:29952
 s_waitcnt lgkmcnt(6)
 v_mfma_f32_32x32x16_bf16 v[160:175], a[240:243], v[128:131], v[160:175]
 s_add_u32 m0, s34, 12288
 s_add_u32 s32, s33, 196608
 buffer_load_dwordx4 v193, s[12:15], s32 offen lds
 v_cmp_le_i32 s[46:47], 19, v223
 ds_read_b64_tr_b16 a[240:241], v21 offset:25600
 ds_read_b64_tr_b16 a[242:243], v21 offset:25856
 s_waitcnt lgkmcnt(6)
 v_mfma_f32_32x32x16_bf16 v[176:191], v[128:131], a[244:247], v[176:191]
 s_add_u32 m0, s34, 24576
 s_add_u32 s32, s33, 393216
 buffer_load_dwordx4 v193, s[12:15], s32 offen lds
 v_cndmask_b32 v218, v239, 0, s[44:45]
 ds_read_b64_tr_b16 a[244:245], v29 offset:31744
 ds_read_b64_tr_b16 a[246:247], v29 offset:32000
 s_waitcnt lgkmcnt(6)
 v_mfma_f32_32x32x16_bf16 v[160:175], a[248:251], v[132:135], v[160:175]
 v_cndmask_b32 v234, 0, v239, s[44:45]
 ds_read_b64_tr_b16 a[248:249], v29 offset:32768
 ds_read_b64_tr_b16 a[250:251], v29 offset:33024
 s_waitcnt lgkmcnt(6)
 v_mfma_f32_32x32x16_bf16 v[176:191], v[132:135], a[252:255], v[176:191]
 s_add_u32 m0, s34, 36864
 s_add_u32 s32, s33, 589824
 buffer_load_dwordx4 v193, s[12:15], s32 offen lds
 v_cmp_le_i32 s[42:43], 24, v223
 ds_read_b64_tr_b16 a[252:253], v29 offset:34816
 ds_read_b64_tr_b16 a[254:255], v29 offset:35072
 s_waitcnt lgkmcnt(6)
 v_mfma_f32_32x32x16_bf16 v[240:255], v[16:19], a[240:243], v[240:255]
 v_cndmask_b32 v219, v239, 0, s[46:47]
 ds_read_b64_tr_b16 a[240:241], v29 offset:35840
 ds_read_b64_tr_b16 a[242:243], v29 offset:36096
 s_waitcnt lgkmcnt(6)
 v_mfma_f32_32x32x16_bf16 v[160:175], a[244:247], v[136:139], v[160:175]
 s_add_u32 m0, s34, 49152
 s_add_u32 s32, s33, 786432
 buffer_load_dwordx4 v193, s[12:15], s32 offen lds
 s_waitcnt vmcnt(8)
 ds_read_b128 v[144:147], v196 offset:32768
 ds_read_b128 v[148:151], v197 offset:32768
 ds_read_b128 v[152:155], v198 offset:32768
 ds_read_b128 v[156:159], v199 offset:32768
 v_cndmask_b32 v235, 0, v239, s[46:47]
 ds_read_b64_tr_b16 a[244:245], v21 offset:31744
 ds_read_b64_tr_b16 a[246:247], v21 offset:32000
 s_waitcnt lgkmcnt(10)
 v_mfma_f32_32x32x16_bf16 v[176:191], v[136:139], a[248:251], v[176:191]
 s_add_u32 m0, s34, 61440
 s_add_u32 s32, s33, 983040
 buffer_load_dwordx4 v193, s[12:15], s32 offen lds
 v_cmp_le_i32 s[44:45], 25, v223
 s_waitcnt vmcnt(7)
 s_barrier
 ds_read_b64_tr_b16 a[248:249], v29 offset:37888
 ds_read_b64_tr_b16 a[250:251], v29 offset:38144
 s_waitcnt lgkmcnt(10)
 v_mfma_f32_32x32x16_bf16 v[160:175], a[252:255], v[140:143], v[160:175]
 v_cndmask_b32 v220, v239, 0, s[42:43]
 ds_read_b64_tr_b16 a[252:253], v29 offset:38912
 ds_read_b64_tr_b16 a[254:255], v29 offset:39168
 s_waitcnt lgkmcnt(10)
 v_mfma_f32_32x32x16_bf16 v[176:191], v[140:143], a[240:243], v[176:191]
 s_add_u32 m0, s34, 73728
 s_add_u32 s32, s33, 1179648
 buffer_load_dwordx4 v193, s[12:15], s32 offen lds
 v_cndmask_b32 v236, 0, v239, s[42:43]
 ds_read_b64_tr_b16 a[240:241], v29 offset:40960
 ds_read_b64_tr_b16 a[242:243], v29 offset:41216
 s_waitcnt lgkmcnt(6)
 v_mfma_f32_32x32x16_bf16 v[240:255], v[16:19], a[244:247], v[240:255]
 v_cmp_le_i32 s[46:47], 26, v223
 ds_read_b64_tr_b16 a[244:245], v29 offset:41984
 ds_read_b64_tr_b16 a[246:247], v29 offset:42240
 s_waitcnt lgkmcnt(6)
 v_mfma_f32_32x32x16_bf16 v[160:175], a[248:251], v[144:147], v[160:175]
 s_add_u32 m0, s34, 86016
 s_add_u32 s32, s33, 1376256
 buffer_load_dwordx4 v193, s[12:15], s32 offen lds
 v_cndmask_b32 v221, v239, 0, s[44:45]
 ds_read_b64_tr_b16 a[248:249], v21 offset:37888
 ds_read_b64_tr_b16 a[250:251], v21 offset:38144
 s_waitcnt lgkmcnt(6)
 v_mfma_f32_32x32x16_bf16 v[176:191], v[144:147], a[252:255], v[176:191]
 buffer_load_dword v13, v12, s[4:7], 0 offen sc1
 v_cndmask_b32 v237, 0, v239, s[44:45]
 ds_read_b64_tr_b16 a[252:253], v29 offset:44032
 ds_read_b64_tr_b16 a[254:255], v29 offset:44288
 s_waitcnt lgkmcnt(6)
 v_mfma_f32_32x32x16_bf16 v[160:175], a[240:243], v[148:151], v[160:175]
 v_cmp_le_i32 s[42:43], 27, v223
 ds_read_b64_tr_b16 a[240:241], v29 offset:45056
 ds_read_b64_tr_b16 a[242:243], v29 offset:45312
 s_waitcnt lgkmcnt(6)
 v_mfma_f32_32x32x16_bf16 v[176:191], v[148:151], a[244:247], v[176:191]
 v_cndmask_b32 v222, v239, 0, s[46:47]
 ds_read_b64_tr_b16 a[244:245], v29 offset:47104
 ds_read_b64_tr_b16 a[246:247], v29 offset:47360
 s_waitcnt lgkmcnt(6)
 v_mfma_f32_32x32x16_bf16 v[240:255], v[16:19], a[248:251], v[240:255]
 v_cndmask_b32 v238, 0, v239, s[46:47]
 ds_read_b64_tr_b16 a[248:249], v29 offset:48128
 ds_read_b64_tr_b16 a[250:251], v29 offset:48384
 s_waitcnt lgkmcnt(6)
 v_mfma_f32_32x32x16_bf16 v[160:175], a[252:255], v[152:155], v[160:175]
 v_cndmask_b32 v223, v239, 0, s[42:43]
 ds_read_b64_tr_b16 a[252:253], v21 offset:44032
 ds_read_b64_tr_b16 a[254:255], v21 offset:44288
 s_waitcnt lgkmcnt(6)
 v_mfma_f32_32x32x16_bf16 v[176:191], v[152:155], a[240:243], v[176:191]
 v_cndmask_b32 v239, 0, v239, s[42:43]
 s_waitcnt lgkmcnt(4)
 v_mfma_f32_32x32x16_bf16 v[160:175], a[244:247], v[156:159], v[160:175]
 s_waitcnt lgkmcnt(2)
 v_mfma_f32_32x32x16_bf16 v[176:191], v[156:159], a[248:251], v[176:191]
 s_waitcnt lgkmcnt(0)
 v_mfma_f32_32x32x16_bf16 v[240:255], v[16:19], a[252:255], v[240:255]
 v_bfe_u32 v15, v0, 2, 7
 v_and_b32 v1, 0x200, v0
 v_lshrrev_b32 v30, 2, v0
 v_add_u32 v30, s65, v30
 v_lshl_add_u32 v31, v1, 4, v15
 v_lshl_add_u32 v15, v1, 3, v15
 s_waitcnt vmcnt(9)
 v_xor_b32 v1, s55, v25
 v_xor_b32 v27, s55, v27
 v_or_b32 v1, v1, v27
 v_cmp_ne_u32 vcc, 0, v1
 s_cbranch_vccnz L1_spin
L2_got:
 v_mov_b32 v8, v24
 v_mov_b32 v3, v26
 v_cvt_pk_bf16_f32 v2, v240, v240
 v_lshlrev_b32 v2, 16, v2
 v_sub_f32 v2, v240, v2
 v_cvt_pk_bf16_f32 v2, v240, v2
 ds_write_b32 v30, v2 offset:49152
 v_mov_b32 v6, 0
 v_mov_b32 v7, 0
 v_mov_b32 v14, v30
 s_waitcnt lgkmcnt(0)
 s_barrier
 ds_read_b32 v4, v31 offset:49152
 ds_read_b32 v5, v31 offset:53248
 v_lshrrev_b32 v1, 2, v0
 v_add_u32 v1, s65, v1
 ds_write_b32 v1, v3 offset:49664
 v_lshrrev_b32 v1, 9, v0
 v_lshl_add_u32 v1, v1, 4, s65
 ds_read_b128 v[240:243], v1 offset:49664
 ds_read_b128 v[244:247], v1 offset:49696
 ds_read_b128 v[248:251], v1 offset:49728
 ds_read_b128 v[252:255], v1 offset:49760
 v_mov_b32 v9, 0
 v_mov_b32 v10, 0
 v_mov_b32 v11, 0
 s_waitcnt lgkmcnt(5)
 s_nop 0
 v_mfma_f32_32x32x16_bf16 v[160:175], v[4:7], v[8:11], v[160:175]
 v_mov_b32 v9, v8
 v_mov_b32 v8, 0
 s_nop 1
 v_mfma_f32_32x32x16_bf16 v[176:191], v[8:11], v[4:7], v[176:191]
 s_mul_i32 s3, s50, 3072
 v_add_u32 v20, s3, v28
 v_add_u32 v21, s3, v29
 v_mov_b32 v10, v9
 v_mov_b32 v11, v9
 v_mov_b32 v9, 0
 s_lshl_b32 s28, s52, 6
 s_add_u32 s28, s28, s58
 s_lshl_b32 s28, s28, 12
 s_add_u32 s28, s28, 10485760
 v_add_u32 v31, s65, v0
 v_pk_mul_f32 v[160:161], v[2:3], v[160:161] op_sel:[1,0]
 v_pk_mul_f32 v[162:163], v[2:3], v[162:163] op_sel:[1,0]
 v_pk_mul_f32 v[164:165], v[2:3], v[164:165] op_sel:[1,0]
 v_pk_mul_f32 v[166:167], v[2:3], v[166:167] op_sel:[1,0]
 v_cvt_pk_bf16_f32 v160, v160, v161
 v_cvt_pk_bf16_f32 v161, v162, v163
 v_cvt_pk_bf16_f32 v162, v164, v165
 v_cvt_pk_bf16_f32 v163, v166, v167
 buffer_store_dwordx4 v[160:163], v0, s[4:7], s28 offen sc1
 v_pk_mul_f32 v[168:169], v[2:3], v[168:169] op_sel:[1,0]
 v_pk_mul_f32 v[170:171], v[2:3], v[170:171] op_sel:[1,0]
 v_pk_mul_f32 v[172:173], v[2:3], v[172:173] op_sel:[1,0]
 v_pk_mul_f32 v[174:175], v[2:3], v[174:175] op_sel:[1,0]
 v_cvt_pk_bf16_f32 v168, v168, v169
 v_cvt_pk_bf16_f32 v169, v170, v171
 v_cvt_pk_bf16_f32 v170, v172, v173
 v_cvt_pk_bf16_f32 v171, v174, v175
 buffer_store_dwordx4 v[168:171], v0, s[4:7], s28 offen offset:1024 sc1
 s_waitcnt lgkmcnt(3)
 v_pk_mul_f32 v[176:177], v[240:241], v[176:177]
 v_pk_mul_f32 v[178:179], v[242:243], v[178:179]
 s_waitcnt lgkmcnt(2)
 v_pk_mul_f32 v[180:181], v[244:245], v[180:181]
 v_pk_mul_f32 v[182:183], v[246:247], v[182:183]
 v_cvt_pk_bf16_f32 v176, v176, v177
 v_cvt_pk_bf16_f32 v177, v178, v179
 v_cvt_pk_bf16_f32 v178, v180, v181
 v_cvt_pk_bf16_f32 v179, v182, v183
 buffer_store_dwordx4 v[176:179], v0, s[4:7], s28 offen offset:2048 sc1
 s_waitcnt lgkmcnt(1)
 v_pk_mul_f32 v[184:185], v[248:249], v[184:185]
 v_pk_mul_f32 v[186:187], v[250:251], v[186:187]
 s_waitcnt lgkmcnt(0)
 v_pk_mul_f32 v[188:189], v[252:253], v[188:189]
 v_pk_mul_f32 v[190:191], v[254:255], v[190:191]
 v_cvt_pk_bf16_f32 v184, v184, v185
 v_cvt_pk_bf16_f32 v185, v186, v187
 v_cvt_pk_bf16_f32 v186, v188, v189
 v_cvt_pk_bf16_f32 v187, v190, v191
 buffer_store_dwordx4 v[184:187], v0, s[4:7], s28 offen offset:3072 sc1
 s_waitcnt vmcnt(5)
 s_waitcnt vmcnt(4)
 v_and_b32 v1, 0xfffffff0, v13
 v_cmp_ne_u32 vcc, s55, v1
 s_cbranch_vccnz L3_spin
L4_got:
 v_xor_b32 v13, s56, v13
 s_barrier
 ds_read_b64_tr_b16 a[240:241], v28 offset:0
 ds_read_b64_tr_b16 a[242:243], v28 offset:256
 ds_read_b64_tr_b16 a[244:245], v20 offset:0
 ds_read_b64_tr_b16 a[246:247], v20 offset:256
 ds_read_b64_tr_b16 a[248:249], v28 offset:3072
 ds_read_b64_tr_b16 a[250:251], v28 offset:3328
 ds_read_b64_tr_b16 a[252:253], v20 offset:12288
 ds_read_b64_tr_b16 a[254:255], v20 offset:12544
 s_waitcnt lgkmcnt(6)
 v_mfma_f32_32x32x16_bf16 v[192:207], a[240:243], v[32:35], 0
 ds_read_b64_tr_b16 a[240:241], v28 offset:6144
 ds_read_b64_tr_b16 a[242:243], v28 offset:6400
 ds_write_b128 v31, v[160:163] offset:32768
 v_lshrrev_b32 v22, 7, v0
 v_mul_u32_u24 v22, 2752, v22
 v_and_b32 v2, 0x70, v0
 v_add_u32 v22, v22, v2
 s_lshl2_add_u32 s32, s53, s50
 s_mul_i32 s32, s32, 44032
 s_lshl_b32 s3, s72, 7
 s_add_u32 s32, s32, s3
 s_cmp_lt_u32 s72, 22
 s_cselect_b32 s32, s32, 2146435072
 s_add_u32 s33, s32, 22016
 s_add_u32 m0, s65, 0
 s_nop 0
 buffer_load_dwordx4 v22, s[24:27], s32 offen lds
 s_waitcnt lgkmcnt(7)
 v_mfma_f32_32x32x16_bf16 v[240:255], v[16:19], a[244:247], 0
 ds_read_b64_tr_b16 a[244:245], v20 offset:24576
 ds_read_b64_tr_b16 a[246:247], v20 offset:24832
 ds_write_b128 v31, v[168:171] offset:33792
 s_add_u32 m0, s65, 1024
 s_nop 0
 buffer_load_dwordx4 v22, s[24:27], s33 offen lds
 s_waitcnt lgkmcnt(8)
 v_mfma_f32_32x32x16_bf16 v[192:207], a[248:251], v[36:39], v[192:207]
 ds_read_b64_tr_b16 a[248:249], v28 offset:9216
 ds_read_b64_tr_b16 a[250:251], v28 offset:9472
 ds_write_b128 v31, v[176:179] offset:34816
 s_add_u32 m0, s65, 2048
 s_nop 0
 buffer_load_dwordx4 v22, s[20:23], s32 offen lds
 s_waitcnt lgkmcnt(9)
 v_mfma_f32_32x32x16_bf16 v[240:255], v[16:19], a[252:255], v[240:255]
 ds_read_b64_tr_b16 a[252:253], v20 offset:36864
 ds_read_b64_tr_b16 a[254:255], v20 offset:37120
 ds_write_b128 v31, v[184:187] offset:35840
 s_add_u32 m0, s65, 3072
 s_nop 0
 buffer_load_dwordx4 v22, s[20:23], s33 offen lds
 s_waitcnt lgkmcnt(10)
 v_mfma_f32_32x32x16_bf16 v[192:207], a[240:243], v[40:43], v[192:207]
 ds_read_b64_tr_b16 a[240:241], v28 offset:12288
 ds_read_b64_tr_b16 a[242:243], v28 offset:12544
 s_waitcnt lgkmcnt(9)
 v_mfma_f32_32x32x16_bf16 v[240:255], v[16:19], a[244:247], v[240:255]
 ds_read_b64_tr_b16 a[244:245], v21 offset:0
 ds_read_b64_tr_b16 a[246:247], v21 offset:256
 s_waitcnt lgkmcnt(8)
 v_mfma_f32_32x32x16_bf16 v[192:207], a[248:251], v[44:47], v[192:207]
 ds_read_b64_tr_b16 a[248:249], v28 offset:15360
 ds_read_b64_tr_b16 a[250:251], v28 offset:15616
 s_waitcnt lgkmcnt(7)
 v_mfma_f32_32x32x16_bf16 v[240:255], v[16:19], a[252:255], v[240:255]
 ds_read_b64_tr_b16 a[252:253], v21 offset:12288
 ds_read_b64_tr_b16 a[254:255], v21 offset:12544
 s_waitcnt lgkmcnt(6)
 v_mfma_f32_32x32x16_bf16 v[192:207], a[240:243], v[48:51], v[192:207]
 ds_read_b64_tr_b16 a[240:241], v28 offset:18432
 ds_read_b64_tr_b16 a[242:243], v28 offset:18688
 s_waitcnt lgkmcnt(6)
 v_mfma_f32_32x32x16_bf16 v[240:255], v[16:19], a[244:247], v[240:255]
 ds_read_b64_tr_b16 a[244:245], v21 offset:24576
 ds_read_b64_tr_b16 a[246:247], v21 offset:24832
 s_waitcnt lgkmcnt(6)
 v_mfma_f32_32x32x16_bf16 v[192:207], a[248:251], v[52:55], v[192:207]
 ds_read_b64_tr_b16 a[248:249], v28 offset:21504
 ds_read_b64_tr_b16 a[250:251], v28 offset:21760
 s_waitcnt lgkmcnt(6)
 v_mfma_f32_32x32x16_bf16 v[240:255], v[16:19], a[252:255], v[240:255]
 ds_read_b64_tr_b16 a[252:253], v21 offset:36864
 ds_read_b64_tr_b16 a[254:255], v21 offset:37120
 s_waitcnt lgkmcnt(6)
 v_mfma_f32_32x32x16_bf16 v[192:207], a[240:243], v[56:59], v[192:207]
 ds_read_b64_tr_b16 a[240:241], v28 offset:24576
 ds_read_b64_tr_b16 a[242:243], v28 offset:24832
 s_lshl4_add_u32 s29, s58, s52
 s_lshl_b32 s29, s29, 7
 s_add_u32 s29, s29, 262144
 v_lshrrev_b32 v1, 2, v0
 v_mov_b32 v2, s55
 s_mov_b32 exec_hi, 0
 s_waitcnt vmcnt(4)
 buffer_store_dword v2, v1, s[4:7], s29 offen sc1
 s_mov_b32 exec_hi, -1
 s_waitcnt lgkmcnt(6)
 v_mfma_f32_32x32x16_bf16 v[240:255], v[16:19], a[244:247], v[240:255]
 ds_read_b64_tr_b16 a[244:245], v28 offset:27648
 ds_read_b64_tr_b16 a[246:247], v28 offset:27904
 s_waitcnt lgkmcnt(6)
 v_mfma_f32_32x32x16_bf16 v[192:207], a[248:251], v[60:63], v[192:207]
 ds_read_b64_tr_b16 a[248:249], v28 offset:30720
 ds_read_b64_tr_b16 a[250:251], v28 offset:30976
 s_lshr_b32 s41, s64, 1
 s_mul_i32 s41, s41, 241664
 s_and_b32 s48, s64, 1
 s_lshl_b32 s48, s48, 10
 s_add_u32 s41, s41, s48
 s_add_u32 s41, s41, 23068672
 s_lshl_b32 s48, s50, 3
 s_lshl_b32 s48, s48, 11
 s_add_u32 s48, s48, s41
 s_xor_b32 s49, s48, 1024
 buffer_load_dwordx4 a[0:3], v0, s[4:7], s48 offen sc1
 s_waitcnt lgkmcnt(6)
 v_mfma_f32_32x32x16_bf16 v[240:255], v[16:19], a[252:255], v[240:255]
 ds_read_b64_tr_b16 a[252:253], v28 offset:33792
 ds_read_b64_tr_b16 a[254:255], v28 offset:34048
 buffer_load_dwordx4 a[4:7], v0, s[4:7], s49 offen sc1
 s_waitcnt lgkmcnt(6)
 v_mfma_f32_32x32x16_bf16 v[192:207], a[240:243], v[64:67], v[192:207]
 ds_read_b64_tr_b16 a[240:241], v28 offset:36864
 ds_read_b64_tr_b16 a[242:243], v28 offset:37120
 s_waitcnt lgkmcnt(6)
 v_mfma_f32_32x32x16_bf16 v[192:207], a[244:247], v[68:71], v[192:207]
 ds_read_b64_tr_b16 a[244:245], v28 offset:39936
 ds_read_b64_tr_b16 a[246:247], v28 offset:40192
 buffer_load_dwordx4 a[8:11], v0, s[4:7], s48 offen offset:2048 sc1
 s_waitcnt lgkmcnt(6)
 v_mfma_f32_32x32x16_bf16 v[192:207], a[248:251], v[72:75], v[192:207]
 ds_read_b64_tr_b16 a[248:249], v28 offset:43008
 ds_read_b64_tr_b16 a[250:251], v28 offset:43264
 buffer_load_dwordx4 a[12:15], v0, s[4:7], s49 offen offset:2048 sc1
 s_add_u32 s48, s48, 4096
 s_add_u32 s49, s49, 4096
 s_waitcnt lgkmcnt(6)
 v_mfma_f32_32x32x16_bf16 v[192:207], a[252:255], v[76:79], v[192:207]
 ds_read_b64_tr_b16 a[252:253], v28 offset:46080
 ds_read_b64_tr_b16 a[254:255], v28 offset:46336
 v_cvt_pk_bf16_f32 v1, v240, v240
 v_lshlrev_b32 v1, 16, v1
 v_sub_f32 v1, v240, v1
 v_cvt_pk_bf16_f32 v1, v240, v1
 v_cmp_gt_u32 vcc, 512, v0
 s_nop 1
 v_cndmask_b32 v1, v13, v1, vcc
 ds_write_b32 v14, v1 offset:49408
 s_waitcnt lgkmcnt(7)
 v_mfma_f32_32x32x16_bf16 v[192:207], a[240:243], v[80:83], v[192:207]
 ds_read_b64_tr_b16 a[240:241], v29 offset:0
 ds_read_b64_tr_b16 a[242:243], v29 offset:256
 buffer_load_dwordx4 a[16:19], v0, s[4:7], s48 offen sc1
 s_waitcnt lgkmcnt(7)
 v_mfma_f32_32x32x16_bf16 v[192:207], a[244:247], v[84:87], v[192:207]
 ds_read_b64_tr_b16 a[244:245], v29 offset:3072
 ds_read_b64_tr_b16 a[246:247], v29 offset:3328
 s_waitcnt lgkmcnt(7)
 v_mfma_f32_32x32x16_bf16 v[192:207], a[248:251], v[88:91], v[192:207]
 ds_read_b64_tr_b16 a[248:249], v29 offset:6144
 ds_read_b64_tr_b16 a[250:251], v29 offset:6400
 buffer_load_dwordx4 a[20:23], v0, s[4:7], s49 offen sc1
 s_waitcnt lgkmcnt(7)
 v_mfma_f32_32x32x16_bf16 v[192:207], a[252:255], v[92:95], v[192:207]
 ds_read_b64_tr_b16 a[252:253], v29 offset:9216
 ds_read_b64_tr_b16 a[254:255], v29 offset:9472
 buffer_load_dwordx4 a[24:27], v0, s[4:7], s48 offen offset:2048 sc1
 s_waitcnt lgkmcnt(8)
 s_barrier
 ds_read_b32 v6, v15 offset:49408
 ds_read_b32 v7, v15 offset:57600
 ds_read_b32 v12, v15 offset:49536
 ds_read_b32 v13, v15 offset:57728
 s_waitcnt lgkmcnt(10)
 v_mfma_f32_32x32x16_bf16 v[192:207], a[240:243], v[96:99], v[192:207]
 ds_read_b64_tr_b16 a[240:241], v29 offset:12288
 ds_read_b64_tr_b16 a[242:243], v29 offset:12544
 v_mov_b32 v240, 0x3f803f80
 s_waitcnt lgkmcnt(10)
 v_mfma_f32_32x32x16_bf16 v[192:207], a[244:247], v[100:103], v[192:207]
 ds_read_b64_tr_b16 a[244:245], v29 offset:15360
 ds_read_b64_tr_b16 a[246:247], v29 offset:15616
 buffer_load_dwordx4 a[28:31], v0, s[4:7], s49 offen offset:2048 sc1
 s_add_u32 s48, s48, 4096
 s_add_u32 s49, s49, 4096
 v_mov_b32 v241, 0x3f803f80
 s_waitcnt lgkmcnt(10)
 v_mfma_f32_32x32x16_bf16 v[192:207], a[248:251], v[104:107], v[192:207]
 ds_read_b64_tr_b16 a[248:249], v29 offset:18432
 ds_read_b64_tr_b16 a[250:251], v29 offset:18688
 s_waitcnt vmcnt(9)
 s_barrier
 v_mov_b32 v242, 0x3f803f80
 s_waitcnt lgkmcnt(10)
 v_mfma_f32_32x32x16_bf16 v[192:207], a[252:255], v[108:111], v[192:207]
 ds_read_b64_tr_b16 a[252:253], v29 offset:21504
 ds_read_b64_tr_b16 a[254:255], v29 offset:21760
 v_bfe_u32 v23, v0, 6, 2
 v_lshrrev_b32 v2, 9, v0
 v_mad_u32_u24 v23, v2, 4, v23
 v_mul_u32_u24 v23, 128, v23
 v_bfe_u32 v2, v0, 8, 1
 v_mul_u32_u24 v2, 2048, v2
 v_add_u32 v23, v23, v2
 v_bfe_u32 v2, v0, 4, 2
 v_lshl_add_u32 v23, v2, 3, v23
 s_lshl_b32 s3, s50, 5
 v_add_u32 v23, s3, v23
 buffer_load_dwordx4 a[32:35], v0, s[4:7], s48 offen sc1
 v_mov_b32 v243, 0x3f803f80
 s_waitcnt lgkmcnt(6)
 v_mfma_f32_32x32x16_bf16 v[192:207], a[240:243], v[112:115], v[192:207]
 ds_read_b64_tr_b16 a[240:241], v29 offset:24576
 ds_read_b64_tr_b16 a[242:243], v29 offset:24832
 ds_read_b64_tr_b16 v[160:161], v23 offset:0
 ds_read_b64_tr_b16 v[162:163], v23 offset:1024
 s_lshl2_add_u32 s32, s72, s50
 s_mul_i32 s38, s32, 52429
 s_lshr_b32 s38, s38, 18
 s_mul_i32 s34, s38, 5
 s_sub_u32 s34, s32, s34
 s_sub_u32 s39, s32, 80
 buffer_load_dwordx4 a[36:39], v0, s[4:7], s49 offen sc1
 v_mov_b32 v244, 0x3f803f80
 s_waitcnt lgkmcnt(8)
 v_mfma_f32_32x32x16_bf16 v[192:207], a[244:247], v[116:119], v[192:207]
 ds_read_b64_tr_b16 a[244:245], v29 offset:27648
 ds_read_b64_tr_b16 a[246:247], v29 offset:27904
 ds_read_b64_tr_b16 v[164:165], v23 offset:4096
 ds_read_b64_tr_b16 v[166:167], v23 offset:5120
 s_cmp_lt_u32 s32, 80
 s_cselect_b32 s38, s38, s39
 s_cselect_b32 s34, s34, 165
 s_cselect_b32 s39, 5, 1
 s_lshl_b32 s39, s39, 10
 s_mul_i32 s38, s38, 204800
 v_or_b32 v12, v12, v13
 v_cmp_ne_u32 vcc, 0, v12
 s_nop 0
 s_or_b32 s68, vcc_lo, vcc_hi
 v_mov_b32 v245, 0x3f803f80
 s_waitcnt lgkmcnt(10)
 v_mfma_f32_32x32x16_bf16 v[192:207], a[248:251], v[120:123], v[192:207]
 ds_read_b64_tr_b16 a[248:249], v29 offset:30720
 ds_read_b64_tr_b16 a[250:251], v29 offset:30976
 ds_read_b64_tr_b16 v[168:169], v23 offset:8192
 ds_read_b64_tr_b16 v[170:171], v23 offset:9216
 s_lshl_b32 s34, s34, 10
 s_add_u32 s38, s38, s34
 s_add_u32 s38, s38, 18874368
 s_cmp_lt_u32 s32, 86
 s_cselect_b32 s38, s38, 2146435072
 s_lshl_b32 s33, s39, 5
 buffer_load_dwordx4 a[40:43], v0, s[4:7], s48 offen offset:2048 sc1
 v_mov_b32 v246, 0x3f803f80
 s_waitcnt lgkmcnt(12)
 v_mfma_f32_32x32x16_bf16 v[192:207], a[252:255], v[124:127], v[192:207]
 ds_read_b64_tr_b16 a[252:253], v29 offset:33792
 ds_read_b64_tr_b16 a[254:255], v29 offset:34048
 ds_read_b64_tr_b16 v[172:173], v23 offset:12288
 ds_read_b64_tr_b16 v[174:175], v23 offset:13312
 s_add_u32 s33, s33, s38
 s_lshl_b32 s34, s53, 7
 s_add_u32 s33, s33, s34
 s_lshl_b32 s34, s53, 2
 s_mul_i32 s34, s34, s39
 s_add_u32 s38, s38, s34
 buffer_load_dwordx4 a[44:47], v0, s[4:7], s49 offen offset:2048 sc1
 s_add_u32 s48, s48, 4096
 s_add_u32 s49, s49, 4096
 v_mov_b32 v247, 0x3f803f80
 s_waitcnt lgkmcnt(14)
 v_mfma_f32_32x32x16_bf16 v[192:207], a[240:243], v[128:131], v[192:207]
 ds_read_b64_tr_b16 a[240:241], v29 offset:36864
 ds_read_b64_tr_b16 a[242:243], v29 offset:37120
 s_waitcnt lgkmcnt(14)
 v_mfma_f32_32x32x16_bf16 v[176:191], v[16:19], v[160:163], 0
 buffer_store_dwordx4 v[160:163], v0, s[4:7], s38 offen sc1
 s_add_u32 s38, s38, s39
 v_mov_b32 v248, 0x3f803f80
 s_waitcnt lgkmcnt(12)
 v_mfma_f32_32x32x16_bf16 v[192:207], a[244:247], v[132:135], v[192:207]
 ds_read_b64_tr_b16 a[244:245], v29 offset:39936
 ds_read_b64_tr_b16 a[246:247], v29 offset:40192
 s_waitcnt lgkmcnt(12)
 v_mfma_f32_32x32x16_bf16 v[176:191], v[16:19], v[164:167], v[176:191]
 buffer_store_dwordx4 v[164:167], v0, s[4:7], s38 offen sc1
 s_add_u32 s38, s38, s39
 buffer_load_dwordx4 a[48:51], v0, s[4:7], s48 offen sc1
 v_mov_b32 v249, 0x3f803f80
 s_waitcnt lgkmcnt(10)
 v_mfma_f32_32x32x16_bf16 v[192:207], a[248:251], v[136:139], v[192:207]
 ds_read_b64_tr_b16 a[248:249], v29 offset:43008
 ds_read_b64_tr_b16 a[250:251], v29 offset:43264
 s_lshl4_add_u32 s35, s58, s52
 s_lshl_b32 s35, s35, 7
 s_add_u32 s35, s35, 245760
 s_cmp_ge_u32 s51, 2
 s_cselect_b32 s3, 0, 8192
 v_and_b32 v30, 0x200, v0
 v_lshlrev_b32 v30, 4, v30
 v_or_b32 v30, s3, v30
 s_lshl_b32 s36, s52, 6
 s_add_u32 s36, s36, s58
 s_lshl_b32 s36, s36, 12
 s_add_u32 s36, s36, 10469376
 s_cmp_eq_u32 s51, 0
 s_cselect_b32 s35, 2146435072, s35
 s_cselect_b32 s36, 2146435072, s36
 buffer_load_dword v25, v30, s[4:7], s35 offen sc1
 s_waitcnt lgkmcnt(10)
 v_mfma_f32_32x32x16_bf16 v[176:191], v[16:19], v[168:171], v[176:191]
 buffer_store_dwordx4 v[168:171], v0, s[4:7], s38 offen sc1
 s_add_u32 s38, s38, s39
 v_mov_b32 v250, 0x3f803f80
 s_waitcnt lgkmcnt(8)
 v_mfma_f32_32x32x16_bf16 v[192:207], a[252:255], v[140:143], v[192:207]
 ds_read_b64_tr_b16 a[252:253], v29 offset:46080
 ds_read_b64_tr_b16 a[254:255], v29 offset:46336
 s_waitcnt lgkmcnt(8)
 v_mfma_f32_32x32x16_bf16 v[176:191], v[16:19], v[172:175], v[176:191]
 buffer_store_dwordx4 v[172:175], v0, s[4:7], s38 offen sc1
 s_add_u32 s38, s38, s39
 buffer_load_dwordx4 a[52:55], v0, s[4:7], s49 offen sc1
 v_mov_b32 v251, 0x3f803f80
 s_waitcnt lgkmcnt(6)
 v_mfma_f32_32x32x16_bf16 v[192:207], a[240:243], v[144:147], v[192:207]
 s_mul_i32 s48, s50, 20
 s_add_u32 s48, s48, 32
 s_lshl_b32 s48, s48, 11
 s_add_u32 s48, s48, s41
 s_xor_b32 s49, s48, 1024
 buffer_load_dwordx4 a[56:59], v0, s[4:7], s48 offen sc1
 v_mov_b32 v252, 0x3f803f80
 s_waitcnt lgkmcnt(4)
 v_mfma_f32_32x32x16_bf16 v[192:207], a[244:247], v[148:151], v[192:207]
 v_mov_b32 v253, 0x3f803f80
 s_waitcnt lgkmcnt(2)
 v_mfma_f32_32x32x16_bf16 v[192:207], a[248:251], v[152:155], v[192:207]
 v_lshrrev_b32 v23, 2, v0
 v_cvt_pk_bf16_f32 v2, v176, v176
 v_lshlrev_b32 v2, 16, v2
 v_sub_f32 v2, v176, v2
 v_cvt_pk_bf16_f32 v2, v176, v2
 s_mov_b32 exec_hi, 0
 buffer_store_dword v2, v23, s[4:7], s33 offen sc1
 s_mov_b32 exec_hi, -1
 buffer_load_dwordx4 a[60:63], v0, s[4:7], s49 offen sc1
 v_mov_b32 v254, 0x3f803f80
 s_waitcnt lgkmcnt(0)
 v_mfma_f32_32x32x16_bf16 v[192:207], a[252:255], v[156:159], v[192:207]
 v_mov_b32 v255, 0x3f803f80
 v_mfma_f32_32x32x16_bf16 v[192:207], v[4:7], v[8:11], v[192:207]
 v_mul_f32 v3, 0x3eb8aa3b, v3
 s_and_b32 s28, s50, 1
 s_lshl_b32 s29, s28, 10
 s_lshl_b32 s28, s28, 8
 v_add_u32 v28, s29, v0
 v_add_u32 v29, s28, v0
 s_nop 5
 v_pk_mul_f32 v[192:193], v[2:3], v[192:193] op_sel:[1,0]
 v_pk_mul_f32 v[194:195], v[2:3], v[194:195] op_sel:[1,0]
 v_pk_mul_f32 v[196:197], v[2:3], v[196:197] op_sel:[1,0]
 v_pk_mul_f32 v[198:199], v[2:3], v[198:199] op_sel:[1,0]
 v_cvt_pk_bf16_f32 v192, v192, v193
 v_cvt_pk_bf16_f32 v193, v194, v195
 v_cvt_pk_bf16_f32 v194, v196, v197
 v_cvt_pk_bf16_f32 v195, v198, v199
 ds_write_b128 v31, v[192:195] offset:51200
 v_pk_mul_f32 v[200:201], v[2:3], v[200:201] op_sel:[1,0]
 v_pk_mul_f32 v[202:203], v[2:3], v[202:203] op_sel:[1,0]
 v_pk_mul_f32 v[204:205], v[2:3], v[204:205] op_sel:[1,0]
 v_pk_mul_f32 v[206:207], v[2:3], v[206:207] op_sel:[1,0]
 v_cvt_pk_bf16_f32 v200, v200, v201
 v_cvt_pk_bf16_f32 v201, v202, v203
 v_cvt_pk_bf16_f32 v202, v204, v205
 v_cvt_pk_bf16_f32 v203, v206, v207
 ds_write_b128 v31, v[200:203] offset:52224
 s_cmp_lg_u32 s70, 0
 s_waitcnt lgkmcnt(0)
 s_barrier
 s_cbranch_scc1 L5_p1
 ds_read_b128 v[104:107], v28 offset:32768
 s_mov_b64 exec, s[66:67]
 ds_read_b128 v[240:243], v29 offset:34816
 ds_read_b128 v[244:247], v29 offset:35840
 s_mov_b64 exec, -1
 ds_read_b128 v[112:115], v28 offset:51200
 ds_read_b128 v[116:119], v28 offset:63488
 s_waitcnt lgkmcnt(1)
 v_mfma_f32_32x32x16_bf16 v[32:47], v[104:107], v[112:115], v[208:223]
 s_waitcnt lgkmcnt(0)
 v_mfma_f32_32x32x16_bf16 v[48:63], v[104:107], v[116:119], 0
 s_nop 9
 v_exp_f32 v32, v32
 v_exp_f32 v33, v33
 v_exp_f32 v34, v34
 v_cvt_pk_bf16_f32 v96, v32, v33
 v_exp_f32 v35, v35
 s_add_u32 m0, s65, 16384
 s_cmp_eq_u32 s51, 0
 s_waitcnt vmcnt(6)
 s_cbranch_scc1 L12_g0
 v_cmp_ne_u32 vcc, s55, v25
 s_cbranch_vccnz L13_spin
L14_got:
L12_g0:
 buffer_load_dwordx4 v0, s[4:7], s36 offen sc1 nt lds
 buffer_load_dwordx4 v0, s[4:7], s36 offen offset:1024 sc1 nt lds
 buffer_load_dwordx4 v0, s[4:7], s36 offen offset:2048 sc1 nt lds
 buffer_load_dwordx4 v0, s[4:7], s36 offen offset:3072 sc1 nt lds
 v_exp_f32 v36, v36
 v_cvt_pk_bf16_f32 v97, v34, v35
 v_exp_f32 v37, v37
 v_exp_f32 v38, v38
 v_cvt_pk_bf16_f32 v98, v36, v37
 v_exp_f32 v39, v39
 v_exp_f32 v40, v40
 v_cvt_pk_bf16_f32 v99, v38, v39
 s_sub_u32 s28, s36, 16384
 s_cmp_ge_u32 s51, 2
 s_cselect_b32 s28, s28, 2146435072
 s_add_u32 m0, s65, 0
 s_nop 0
 buffer_load_dwordx4 v0, s[4:7], s28 offen sc1 nt lds
 buffer_load_dwordx4 v0, s[4:7], s28 offen offset:1024 sc1 nt lds
 buffer_load_dwordx4 v0, s[4:7], s28 offen offset:2048 sc1 nt lds
 buffer_load_dwordx4 v0, s[4:7], s28 offen offset:3072 sc1 nt lds
 v_exp_f32 v41, v41
 v_exp_f32 v42, v42
 v_mfma_f32_32x32x16_bf16 v[64:79], v[240:243], v[96:99], 0
 v_cvt_pk_bf16_f32 v100, v40, v41
 v_exp_f32 v43, v43
 v_exp_f32 v44, v44
 v_cvt_pk_bf16_f32 v101, v42, v43
 v_exp_f32 v45, v45
 ds_read_b128 v[108:111], v28 offset:36864
 s_mov_b64 exec, s[66:67]
 ds_read_b128 v[248:251], v29 offset:38912
 ds_read_b128 v[252:255], v29 offset:39936
 s_mov_b64 exec, -1
 ds_read_b128 v[104:107], v28 offset:40960
 v_bfe_u32 v1, v0, 4, 5
 v_lshrrev_b32 v2, 9, v0
 v_lshlrev_b32 v2, 4, v2
 v_lshl_add_u32 v1, v1, 10, v2
 s_lshl_b32 s28, s62, 15
 s_lshl_b32 s29, s64, 6
 s_add_u32 s28, s28, s29
 buffer_load_dwordx4 v[20:23], v1, s[8:11], s28 offen offset:0
 buffer_load_dwordx4 v[24:27], v1, s[8:11], s28 offen offset:32
 v_exp_f32 v46, v46
 v_exp_f32 v47, v47
 v_cvt_pk_bf16_f32 v102, v44, v45
 v_cvt_pk_bf16_f32 v103, v46, v47
 v_exp_f32 v48, v48
 v_exp_f32 v49, v49
 v_mfma_f32_32x32x16_bf16 v[64:79], v[244:247], v[100:103], v[64:79]
 v_exp_f32 v50, v50
 v_cvt_pk_bf16_f32 v96, v48, v49
 v_exp_f32 v51, v51
 v_exp_f32 v52, v52
 v_cvt_pk_bf16_f32 v97, v50, v51
 s_waitcnt lgkmcnt(1)
 v_mfma_f32_32x32x16_bf16 v[32:47], v[108:111], v[116:119], 0
 ds_read_b128 v[108:111], v28 offset:45056
 v_exp_f32 v53, v53
 v_exp_f32 v54, v54
 v_cvt_pk_bf16_f32 v98, v52, v53
 v_exp_f32 v55, v55
 v_exp_f32 v56, v56
 v_cvt_pk_bf16_f32 v99, v54, v55
 v_exp_f32 v57, v57
 v_exp_f32 v58, v58
 v_mfma_f32_32x32x16_bf16 v[80:95], v[240:243], v[96:99], 0
 v_cvt_pk_bf16_f32 v100, v56, v57
 v_exp_f32 v59, v59
 v_exp_f32 v60, v60
 v_cvt_pk_bf16_f32 v101, v58, v59
 v_exp_f32 v61, v61
 v_exp_f32 v62, v62
 v_exp_f32 v63, v63
 v_cvt_pk_bf16_f32 v102, v60, v61
 v_cvt_pk_bf16_f32 v103, v62, v63
 v_exp_f32 v32, v32
 v_exp_f32 v33, v33
 v_mfma_f32_32x32x16_bf16 v[80:95], v[244:247], v[100:103], v[80:95]
 s_mov_b64 exec, s[66:67]
 ds_read_b128 v[240:243], v29 offset:43008
 ds_read_b128 v[244:247], v29 offset:44032
 s_mov_b64 exec, -1
 v_exp_f32 v34, v34
 v_cvt_pk_bf16_f32 v96, v32, v33
 v_exp_f32 v35, v35
 v_exp_f32 v36, v36
 v_cvt_pk_bf16_f32 v97, v34, v35
 s_waitcnt lgkmcnt(3)
 v_mfma_f32_32x32x16_bf16 v[48:63], v[104:107], v[116:119], 0
 v_exp_f32 v37, v37
 v_exp_f32 v38, v38
 v_cvt_pk_bf16_f32 v98, v36, v37
 v_exp_f32 v39, v39
 v_exp_f32 v40, v40
 v_cvt_pk_bf16_f32 v99, v38, v39
 v_exp_f32 v41, v41
 v_exp_f32 v42, v42
 v_mfma_f32_32x32x16_bf16 v[80:95], v[248:251], v[96:99], v[80:95]
 v_cvt_pk_bf16_f32 v100, v40, v41
 v_exp_f32 v43, v43
 v_exp_f32 v44, v44
 v_cvt_pk_bf16_f32 v101, v42, v43
 v_exp_f32 v45, v45
 v_exp_f32 v46, v46
 v_exp_f32 v47, v47
 v_cvt_pk_bf16_f32 v102, v44, v45
 v_cvt_pk_bf16_f32 v103, v46, v47
 v_exp_f32 v48, v48
 v_exp_f32 v49, v49
 v_mfma_f32_32x32x16_bf16 v[80:95], v[252:255], v[100:103], v[80:95]
 s_mov_b64 exec, s[66:67]
 ds_read_b128 v[248:251], v29 offset:47104
 ds_read_b128 v[252:255], v29 offset:48128
 s_mov_b64 exec, -1
 v_exp_f32 v50, v50
 v_cvt_pk_bf16_f32 v96, v48, v49
 v_exp_f32 v51, v51
 v_exp_f32 v52, v52
 v_cvt_pk_bf16_f32 v97, v50, v51
 s_waitcnt lgkmcnt(4)
 v_mfma_f32_32x32x16_bf16 v[32:47], v[108:111], v[116:119], v[208:223]
 v_exp_f32 v53, v53
 v_exp_f32 v54, v54
 v_cvt_pk_bf16_f32 v98, v52, v53
 v_exp_f32 v55, v55
 v_exp_f32 v56, v56
 v_cvt_pk_bf16_f32 v99, v54, v55
 v_exp_f32 v57, v57
 v_exp_f32 v58, v58
 s_waitcnt lgkmcnt(2)
 v_mfma_f32_32x32x16_bf16 v[80:95], v[240:243], v[96:99], v[80:95]
 v_cvt_pk_bf16_f32 v100, v56, v57
 v_exp_f32 v59, v59
 v_exp_f32 v60, v60
 v_cvt_pk_bf16_f32 v101, v58, v59
 v_exp_f32 v61, v61
 v_exp_f32 v62, v62
 v_exp_f32 v63, v63
 v_cvt_pk_bf16_f32 v102, v60, v61
 v_cvt_pk_bf16_f32 v103, v62, v63
 v_exp_f32 v32, v32
 v_exp_f32 v33, v33
 v_mfma_f32_32x32x16_bf16 v[80:95], v[244:247], v[100:103], v[80:95]
 v_exp_f32 v34, v34
 v_cvt_pk_bf16_f32 v96, v32, v33
 v_exp_f32 v35, v35
 v_exp_f32 v36, v36
 v_cvt_pk_bf16_f32 v97, v34, v35
 v_exp_f32 v37, v37
 v_exp_f32 v38, v38
 v_cvt_pk_bf16_f32 v98, v36, v37
 v_exp_f32 v39, v39
 v_exp_f32 v40, v40
 v_cvt_pk_bf16_f32 v99, v38, v39
 s_and_b32 s28, s50, 1
 s_lshl1_add_u32 s28, s52, s28
 s_lshl2_add_u32 s20, s51, s70
 s_mul_i32 s22, s20, 88
 s_add_u32 s22, s22, s28
 s_lshl_b32 s22, s22, 10
 s_add_u32 s22, s22, 4194304
 s_lshl_b32 s24, s20, 11
 s_lshl2_add_u32 s24, s28, s24
 s_add_u32 s24, s24, 3407872
 s_lshl2_add_u32 s21, s51, s71
 s_mul_i32 s23, s21, 88
 s_add_u32 s23, s23, s28
 s_lshl_b32 s23, s23, 10
 s_add_u32 s23, s23, 4194304
 s_lshl_b32 s25, s21, 11
 s_lshl2_add_u32 s25, s28, s25
 s_add_u32 s25, s25, 3407872
 s_and_b32 s26, s62, 0xfffffffe
 s_lshl_b32 s26, s26, 11
 v_and_b32 v8, 0x200, v0
 v_lshlrev_b32 v8, 2, v8
 s_lshl_b32 s3, s50, 5
 s_add_u32 s26, s26, s3
 s_add_u32 s26, s26, 3407872
 v_bfe_u32 v2, v0, 2, 5
 v_add_u32 v8, v8, v2
 s_mul_i32 s3, s50, 8192
 s_add_u32 s3, s3, 4194304
 s_mul_i32 s44, s63, 90112
 s_add_u32 s42, s44, s3
 s_mul_i32 s44, s62, 90112
 s_add_u32 s43, s44, s3
 s_waitcnt vmcnt(6)
 s_barrier
 s_lshl3_add_u32 s28, s72, s53
 s_lshl_b32 s28, s28, 7
 s_add_u32 s28, s28, 131072
 s_cmp_eq_u32 s50, 0
 s_cselect_b32 s28, s28, 2146435072
 v_lshrrev_b32 v1, 2, v0
 v_mov_b32 v2, s55
 s_mov_b32 exec_hi, 0
 buffer_store_dword v2, v1, s[4:7], s28 offen sc1
 s_mov_b32 exec_hi, -1
 ds_read_b128 v[104:107], v28 offset:28672
 s_mov_b64 exec, s[66:67]
 ds_read_b128 v[240:243], v29 offset:30720
 ds_read_b128 v[244:247], v29 offset:31744
 s_mov_b64 exec, -1
 v_exp_f32 v41, v41
 v_exp_f32 v42, v42
 s_waitcnt lgkmcnt(3)
 v_mfma_f32_32x32x16_bf16 v[80:95], v[248:251], v[96:99], v[80:95]
 v_cvt_pk_bf16_f32 v100, v40, v41
 v_exp_f32 v43, v43
 v_exp_f32 v44, v44
 v_cvt_pk_bf16_f32 v101, v42, v43
 v_exp_f32 v45, v45
 s_waitcnt lgkmcnt(2)
 v_mfma_f32_32x32x16_bf16 v[48:63], v[104:107], v[112:115], 0
 v_exp_f32 v46, v46
 v_exp_f32 v47, v47
 v_cvt_pk_bf16_f32 v102, v44, v45
 v_cvt_pk_bf16_f32 v103, v46, v47
 s_cmp_eq_u32 s51, 0
 s_cbranch_scc1 L15_x
 s_nop 5
 v_exp_f32 v48, v48
 v_exp_f32 v49, v49
 v_mfma_f32_32x32x16_bf16 v[80:95], v[252:255], v[100:103], v[80:95]
 v_exp_f32 v50, v50
 v_cvt_pk_bf16_f32 v96, v48, v49
 v_exp_f32 v51, v51
 buffer_load_dwordx4 a[64:67], v0, s[4:7], s48 offen offset:2048 sc1
 v_exp_f32 v52, v52
 v_cvt_pk_bf16_f32 v97, v50, v51
 v_mfma_f32_32x32x16_bf16 v[32:47], v[104:107], v[116:119], 0
 v_exp_f32 v53, v53
 v_exp_f32 v54, v54
 v_cvt_pk_bf16_f32 v98, v52, v53
 v_exp_f32 v55, v55
 v_exp_f32 v56, v56
 v_cvt_pk_bf16_f32 v99, v54, v55
 buffer_load_dwordx4 a[68:71], v0, s[4:7], s49 offen offset:2048 sc1
 s_add_u32 s48, s48, 4096
 s_add_u32 s49, s49, 4096
 v_exp_f32 v57, v57
 v_exp_f32 v58, v58
 s_waitcnt lgkmcnt(0)
 v_mfma_f32_32x32x16_bf16 v[64:79], v[240:243], v[96:99], v[64:79]
 v_cvt_pk_bf16_f32 v100, v56, v57
 v_exp_f32 v59, v59
 v_exp_f32 v60, v60
 v_cvt_pk_bf16_f32 v101, v58, v59
 v_exp_f32 v61, v61
 ds_read_b128 v[108:111], v28 offset:24576
 s_mov_b64 exec, s[66:67]
 ds_read_b128 v[248:251], v29 offset:26624
 ds_read_b128 v[252:255], v29 offset:27648
 s_mov_b64 exec, -1
 v_exp_f32 v62, v62
 v_exp_f32 v63, v63
 v_cvt_pk_bf16_f32 v102, v60, v61
 v_cvt_pk_bf16_f32 v103, v62, v63
 v_exp_f32 v32, v32
 v_exp_f32 v33, v33
 v_mfma_f32_32x32x16_bf16 v[64:79], v[244:247], v[100:103], v[64:79]
 v_exp_f32 v34, v34
 v_cvt_pk_bf16_f32 v96, v32, v33
 v_exp_f32 v35, v35
 buffer_load_dwordx4 a[72:75], v0, s[4:7], s48 offen sc1
 v_exp_f32 v36, v36
 v_cvt_pk_bf16_f32 v97, v34, v35
 s_waitcnt lgkmcnt(0)
 v_mfma_f32_32x32x16_bf16 v[48:63], v[108:111], v[112:115], 0
 v_exp_f32 v37, v37
 v_exp_f32 v38, v38
 v_cvt_pk_bf16_f32 v98, v36, v37
 v_exp_f32 v39, v39
 v_exp_f32 v40, v40
 v_cvt_pk_bf16_f32 v99, v38, v39
 buffer_load_dwordx4 a[76:79], v0, s[4:7], s49 offen sc1
 v_exp_f32 v41, v41
 v_exp_f32 v42, v42
 v_mfma_f32_32x32x16_bf16 v[80:95], v[240:243], v[96:99], v[80:95]
 v_cvt_pk_bf16_f32 v100, v40, v41
 v_exp_f32 v43, v43
 v_exp_f32 v44, v44
 v_cvt_pk_bf16_f32 v101, v42, v43
 v_exp_f32 v45, v45
 s_lshl_b32 s28, s50, 14
 s_add_u32 s28, s28, s41
 s_add_u32 s28, s28, 14336
 s_xor_b32 s29, s28, 1024
 buffer_load_dwordx4 v[144:147], v0, s[4:7], s28 offen sc1
 buffer_load_dwordx4 v[148:151], v0, s[4:7], s29 offen sc1
 v_exp_f32 v46, v46
 v_exp_f32 v47, v47
 v_cvt_pk_bf16_f32 v102, v44, v45
 v_cvt_pk_bf16_f32 v103, v46, v47
 v_exp_f32 v48, v48
 v_exp_f32 v49, v49
 v_mfma_f32_32x32x16_bf16 v[80:95], v[244:247], v[100:103], v[80:95]
 v_exp_f32 v50, v50
 v_cvt_pk_bf16_f32 v96, v48, v49
 v_exp_f32 v51, v51
 buffer_load_dwordx4 a[80:83], v0, s[4:7], s48 offen offset:2048 sc1
 v_exp_f32 v52, v52
 v_cvt_pk_bf16_f32 v97, v50, v51
 v_mfma_f32_32x32x16_bf16 v[32:47], v[108:111], v[116:119], 0
 v_exp_f32 v53, v53
 v_exp_f32 v54, v54
 v_cvt_pk_bf16_f32 v98, v52, v53
 v_exp_f32 v55, v55
 v_exp_f32 v56, v56
 v_cvt_pk_bf16_f32 v99, v54, v55
 buffer_load_dwordx4 a[84:87], v0, s[4:7], s49 offen offset:2048 sc1
 s_add_u32 s48, s48, 4096
 s_add_u32 s49, s49, 4096
 v_exp_f32 v57, v57
 v_exp_f32 v58, v58
 v_mfma_f32_32x32x16_bf16 v[64:79], v[248:251], v[96:99], v[64:79]
 v_cvt_pk_bf16_f32 v100, v56, v57
 v_exp_f32 v59, v59
 v_exp_f32 v60, v60
 v_cvt_pk_bf16_f32 v101, v58, v59
 v_exp_f32 v61, v61
 ds_read_b128 v[104:107], v28 offset:20480
 s_mov_b64 exec, s[66:67]
 ds_read_b128 v[240:243], v29 offset:22528
 ds_read_b128 v[244:247], v29 offset:23552
 s_mov_b64 exec, -1
 v_exp_f32 v62, v62
 v_exp_f32 v63, v63
 v_cvt_pk_bf16_f32 v102, v60, v61
 v_cvt_pk_bf16_f32 v103, v62, v63
 v_exp_f32 v32, v32
 v_exp_f32 v33, v33
 v_mfma_f32_32x32x16_bf16 v[64:79], v[252:255], v[100:103], v[64:79]
 v_exp_f32 v34, v34
 v_cvt_pk_bf16_f32 v96, v32, v33
 v_exp_f32 v35, v35
 buffer_load_dwordx4 a[88:91], v0, s[4:7], s48 offen sc1
 v_exp_f32 v36, v36
 v_cvt_pk_bf16_f32 v97, v34, v35
 s_waitcnt lgkmcnt(0)
 v_mfma_f32_32x32x16_bf16 v[48:63], v[104:107], v[112:115], 0
 v_exp_f32 v37, v37
 v_exp_f32 v38, v38
 v_cvt_pk_bf16_f32 v98, v36, v37
 v_exp_f32 v39, v39
 v_exp_f32 v40, v40
 v_cvt_pk_bf16_f32 v99, v38, v39
 buffer_load_dwordx4 a[92:95], v0, s[4:7], s49 offen sc1
 v_exp_f32 v41, v41
 v_exp_f32 v42, v42
 v_mfma_f32_32x32x16_bf16 v[80:95], v[248:251], v[96:99], v[80:95]
 v_cvt_pk_bf16_f32 v100, v40, v41
 v_exp_f32 v43, v43
 v_exp_f32 v44, v44
 v_cvt_pk_bf16_f32 v101, v42, v43
 v_exp_f32 v45, v45
 v_exp_f32 v46, v46
 v_exp_f32 v47, v47
 v_cvt_pk_bf16_f32 v102, v44, v45
 v_cvt_pk_bf16_f32 v103, v46, v47
 v_exp_f32 v48, v48
 v_exp_f32 v49, v49
 v_mfma_f32_32x32x16_bf16 v[80:95], v[252:255], v[100:103], v[80:95]
 v_exp_f32 v50, v50
 v_cvt_pk_bf16_f32 v96, v48, v49
 v_exp_f32 v51, v51
 s_and_b32 s28, s50, 1
 s_lshl1_add_u32 s28, s52, s28
 s_lshl2_add_u32 s3, s51, s70
 s_mul_i32 s3, s3, 88
 s_add_u32 s3, s3, s28
 s_lshl_b32 s3, s3, 10
 s_add_u32 s29, s3, 4194304
 s_lshl2_add_u32 s3, s51, s71
 s_mul_i32 s3, s3, 88
 s_add_u32 s3, s3, s28
 s_lshl_b32 s3, s3, 10
 s_add_u32 s30, s3, 4193280
 s_mul_i32 s31, s62, 36864
 s_lshl_b32 s3, s64, 11
 s_add_u32 s31, s31, s3
 s_add_u32 s31, s31, 1046528
 v_mov_b32 v1, s29
 v_mov_b32 v2, s30
 v_cmp_gt_u32 vcc, 128, v0
 s_nop 1
 v_cndmask_b32 v1, v2, v1, vcc
 v_mov_b32 v2, s31
 v_cmp_gt_u32 vcc, 256, v0
 s_nop 1
 v_cndmask_b32 v1, v2, v1, vcc
 v_lshl_add_u32 v1, v0, 3, v1
 s_mov_b32 exec_hi, 0
 buffer_load_dword a239, v1, s[4:7], 0 offen
 s_mov_b32 exec_hi, -1
 v_exp_f32 v52, v52
 v_cvt_pk_bf16_f32 v97, v50, v51
 v_mfma_f32_32x32x16_bf16 v[32:47], v[104:107], v[116:119], 0
 v_exp_f32 v53, v53
 v_exp_f32 v54, v54
 v_cvt_pk_bf16_f32 v98, v52, v53
 v_exp_f32 v55, v55
 v_exp_f32 v56, v56
 v_cvt_pk_bf16_f32 v99, v54, v55
 buffer_load_dwordx4 a[96:99], v0, s[4:7], s48 offen offset:2048 sc1
 v_exp_f32 v57, v57
 v_exp_f32 v58, v58
 v_mfma_f32_32x32x16_bf16 v[64:79], v[240:243], v[96:99], v[64:79]
 v_cvt_pk_bf16_f32 v100, v56, v57
 v_exp_f32 v59, v59
 v_exp_f32 v60, v60
 v_cvt_pk_bf16_f32 v101, v58, v59
 v_exp_f32 v61, v61
 ds_read_b128 v[108:111], v28 offset:16384
 s_mov_b64 exec, s[66:67]
 ds_read_b128 v[248:251], v29 offset:18432
 ds_read_b128 v[252:255], v29 offset:19456
 s_mov_b64 exec, -1
 buffer_load_dwordx4 a[100:103], v0, s[4:7], s49 offen offset:2048 sc1
 s_add_u32 s48, s48, 4096
 s_add_u32 s49, s49, 4096
 v_exp_f32 v62, v62
 v_exp_f32 v63, v63
 v_cvt_pk_bf16_f32 v102, v60, v61
 v_cvt_pk_bf16_f32 v103, v62, v63
 v_exp_f32 v32, v32
 v_exp_f32 v33, v33
 v_mfma_f32_32x32x16_bf16 v[64:79], v[244:247], v[100:103], v[64:79]
 v_exp_f32 v34, v34
 v_cvt_pk_bf16_f32 v96, v32, v33
 v_exp_f32 v35, v35
 buffer_load_dwordx4 a[104:107], v0, s[4:7], s48 offen sc1
 v_exp_f32 v36, v36
 v_cvt_pk_bf16_f32 v97, v34, v35
 s_waitcnt lgkmcnt(0)
 v_mfma_f32_32x32x16_bf16 v[48:63], v[108:111], v[112:115], 0
 v_exp_f32 v37, v37
 v_exp_f32 v38, v38
 v_cvt_pk_bf16_f32 v98, v36, v37
 v_exp_f32 v39, v39
 v_exp_f32 v40, v40
 v_cvt_pk_bf16_f32 v99, v38, v39
 buffer_load_dwordx4 a[108:111], v0, s[4:7], s49 offen sc1
 v_exp_f32 v41, v41
 v_exp_f32 v42, v42
 v_mfma_f32_32x32x16_bf16 v[80:95], v[240:243], v[96:99], v[80:95]
 v_cvt_pk_bf16_f32 v100, v40, v41
 v_exp_f32 v43, v43
 v_exp_f32 v44, v44
 v_cvt_pk_bf16_f32 v101, v42, v43
 v_exp_f32 v45, v45
 v_exp_f32 v46, v46
 v_exp_f32 v47, v47
 v_cvt_pk_bf16_f32 v102, v44, v45
 v_cvt_pk_bf16_f32 v103, v46, v47
 v_exp_f32 v48, v48
 v_exp_f32 v49, v49
 v_mfma_f32_32x32x16_bf16 v[80:95], v[244:247], v[100:103], v[80:95]
 v_exp_f32 v50, v50
 v_cvt_pk_bf16_f32 v96, v48, v49
 v_exp_f32 v51, v51
 buffer_load_dwordx4 a[112:115], v0, s[4:7], s48 offen offset:2048 sc1
 v_exp_f32 v52, v52
 v_cvt_pk_bf16_f32 v97, v50, v51
 v_mfma_f32_32x32x16_bf16 v[32:47], v[108:111], v[116:119], 0
 v_exp_f32 v53, v53
 v_exp_f32 v54, v54
 v_cvt_pk_bf16_f32 v98, v52, v53
 v_exp_f32 v55, v55
 v_exp_f32 v56, v56
 v_cvt_pk_bf16_f32 v99, v54, v55
 buffer_load_dwordx4 a[116:119], v0, s[4:7], s49 offen offset:2048 sc1
 s_add_u32 s48, s48, 4096
 s_add_u32 s49, s49, 4096
 v_exp_f32 v57, v57
 v_exp_f32 v58, v58
 v_mfma_f32_32x32x16_bf16 v[64:79], v[248:251], v[96:99], v[64:79]
 v_cvt_pk_bf16_f32 v100, v56, v57
 v_exp_f32 v59, v59
 v_exp_f32 v60, v60
 v_cvt_pk_bf16_f32 v101, v58, v59
 v_exp_f32 v61, v61
 s_waitcnt vmcnt(20)
 s_barrier
 ds_read_b128 v[104:107], v28 offset:12288
 s_mov_b64 exec, s[66:67]
 ds_read_b128 v[240:243], v29 offset:14336
 ds_read_b128 v[244:247], v29 offset:15360
 s_mov_b64 exec, -1
 v_exp_f32 v62, v62
 v_exp_f32 v63, v63
 v_cvt_pk_bf16_f32 v102, v60, v61
 v_cvt_pk_bf16_f32 v103, v62, v63
 v_exp_f32 v32, v32
 v_exp_f32 v33, v33
 v_mfma_f32_32x32x16_bf16 v[64:79], v[252:255], v[100:103], v[64:79]
 v_exp_f32 v34, v34
 v_cvt_pk_bf16_f32 v96, v32, v33
 v_exp_f32 v35, v35
 buffer_load_dwordx4 a[120:123], v0, s[4:7], s48 offen sc1
 v_exp_f32 v36, v36
 v_cvt_pk_bf16_f32 v97, v34, v35
 s_waitcnt lgkmcnt(0)
 v_mfma_f32_32x32x16_bf16 v[48:63], v[104:107], v[112:115], 0
 v_exp_f32 v37, v37
 v_exp_f32 v38, v38
 v_cvt_pk_bf16_f32 v98, v36, v37
 v_exp_f32 v39, v39
 v_exp_f32 v40, v40
 v_cvt_pk_bf16_f32 v99, v38, v39
 buffer_load_dwordx4 a[124:127], v0, s[4:7], s49 offen sc1
 v_exp_f32 v41, v41
 v_exp_f32 v42, v42
 v_mfma_f32_32x32x16_bf16 v[80:95], v[248:251], v[96:99], v[80:95]
 v_cvt_pk_bf16_f32 v100, v40, v41
 v_exp_f32 v43, v43
 v_exp_f32 v44, v44
 v_cvt_pk_bf16_f32 v101, v42, v43
 v_exp_f32 v45, v45
 v_exp_f32 v46, v46
 v_exp_f32 v47, v47
 v_cvt_pk_bf16_f32 v102, v44, v45
 v_cvt_pk_bf16_f32 v103, v46, v47
 s_cmp_eq_u32 s51, 1
 s_cbranch_scc1 L16_x
 v_exp_f32 v48, v48
 v_exp_f32 v49, v49
 v_mfma_f32_32x32x16_bf16 v[80:95], v[252:255], v[100:103], v[80:95]
 v_exp_f32 v50, v50
 v_cvt_pk_bf16_f32 v96, v48, v49
 v_exp_f32 v51, v51
 buffer_load_dwordx4 a[128:131], v0, s[4:7], s48 offen offset:2048 sc1
 v_exp_f32 v52, v52
 v_cvt_pk_bf16_f32 v97, v50, v51
 v_mfma_f32_32x32x16_bf16 v[32:47], v[104:107], v[116:119], v[224:239]
 v_exp_f32 v53, v53
 v_exp_f32 v54, v54
 v_cvt_pk_bf16_f32 v98, v52, v53
 v_exp_f32 v55, v55
 v_exp_f32 v56, v56
 v_cvt_pk_bf16_f32 v99, v54, v55
 buffer_load_dwordx4 a[132:135], v0, s[4:7], s49 offen offset:2048 sc1
 s_add_u32 s48, s48, 4096
 s_add_u32 s49, s49, 4096
 v_exp_f32 v57, v57
 v_exp_f32 v58, v58
 v_mfma_f32_32x32x16_bf16 v[64:79], v[240:243], v[96:99], v[64:79]
 v_cvt_pk_bf16_f32 v100, v56, v57
 v_exp_f32 v59, v59
 v_exp_f32 v60, v60
 v_cvt_pk_bf16_f32 v101, v58, v59
 v_exp_f32 v61, v61
 ds_read_b128 v[108:111], v28 offset:8192
 s_mov_b64 exec, s[66:67]
 ds_read_b128 v[248:251], v29 offset:10240
 ds_read_b128 v[252:255], v29 offset:11264
 s_mov_b64 exec, -1
 ds_read_b128 v[104:107], v28 offset:4096
 v_exp_f32 v62, v62
 v_exp_f32 v63, v63
 v_cvt_pk_bf16_f32 v102, v60, v61
 v_cvt_pk_bf16_f32 v103, v62, v63
 v_exp_f32 v32, v32
 v_exp_f32 v33, v33
 v_mfma_f32_32x32x16_bf16 v[64:79], v[244:247], v[100:103], v[64:79]
 v_exp_f32 v34, v34
 v_cvt_pk_bf16_f32 v96, v32, v33
 v_exp_f32 v35, v35
 buffer_load_dwordx4 a[136:139], v0, s[4:7], s48 offen sc1
 v_exp_f32 v36, v36
 v_cvt_pk_bf16_f32 v97, v34, v35
 s_waitcnt lgkmcnt(1)
 v_mfma_f32_32x32x16_bf16 v[48:63], v[108:111], v[112:115], 0
 ds_read_b128 v[108:111], v28 offset:0
 v_exp_f32 v37, v37
 v_exp_f32 v38, v38
 v_cvt_pk_bf16_f32 v98, v36, v37
 v_exp_f32 v39, v39
 v_exp_f32 v40, v40
 v_cvt_pk_bf16_f32 v99, v38, v39
 buffer_load_dwordx4 a[140:143], v0, s[4:7], s49 offen sc1
 v_exp_f32 v41, v41
 v_exp_f32 v42, v42
 v_mfma_f32_32x32x16_bf16 v[80:95], v[240:243], v[96:99], v[80:95]
 v_cvt_pk_bf16_f32 v100, v40, v41
 v_exp_f32 v43, v43
 v_exp_f32 v44, v44
 v_cvt_pk_bf16_f32 v101, v42, v43
 v_exp_f32 v45, v45
 v_exp_f32 v46, v46
 v_exp_f32 v47, v47
 v_cvt_pk_bf16_f32 v102, v44, v45
 v_cvt_pk_bf16_f32 v103, v46, v47
 v_exp_f32 v48, v48
 v_exp_f32 v49, v49
 v_mfma_f32_32x32x16_bf16 v[80:95], v[244:247], v[100:103], v[80:95]
 s_mov_b64 exec, s[66:67]
 ds_read_b128 v[240:243], v29 offset:6144
 ds_read_b128 v[244:247], v29 offset:7168
 s_mov_b64 exec, -1
 v_exp_f32 v50, v50
 v_cvt_pk_bf16_f32 v96, v48, v49
 v_exp_f32 v51, v51
 s_mul_i32 s28, s52, 5
 s_lshr_b32 s28, s28, 2
 s_lshl_b32 s28, s28, 10
 s_min_u32 s29, s52, 5
 s_add_u32 s29, s29, 80
 s_lshr_b32 s29, s29, 2
 s_lshl_b32 s29, s29, 10
 v_and_b32 v9, 0xf0, v0
 v_lshl_add_u32 v9, v9, 3, s28
 v_cmp_gt_u32 vcc, 256, v0
 v_and_b32 v10, 0x70, v0
 v_lshl_add_u32 v10, v10, 3, s29
 v_cndmask_b32 v9, v10, v9, vcc
 s_mov_b32 s36, 131072
 buffer_load_dword v10, v9, s[4:7], s36 offen sc1
 v_exp_f32 v52, v52
 v_cvt_pk_bf16_f32 v97, v50, v51
 s_waitcnt lgkmcnt(3)
 v_mfma_f32_32x32x16_bf16 v[32:47], v[104:107], v[112:115], 0
 v_exp_f32 v53, v53
 v_exp_f32 v54, v54
 v_cvt_pk_bf16_f32 v98, v52, v53
 v_exp_f32 v55, v55
 v_exp_f32 v56, v56
 v_cvt_pk_bf16_f32 v99, v54, v55
 buffer_load_dwordx4 a[144:147], v0, s[4:7], s48 offen offset:2048 sc1
 v_exp_f32 v57, v57
 v_exp_f32 v58, v58
 v_mfma_f32_32x32x16_bf16 v[64:79], v[248:251], v[96:99], v[64:79]
 v_cvt_pk_bf16_f32 v100, v56, v57
 v_exp_f32 v59, v59
 v_exp_f32 v60, v60
 v_cvt_pk_bf16_f32 v101, v58, v59
 v_exp_f32 v61, v61
 buffer_load_dwordx4 a[148:151], v0, s[4:7], s49 offen offset:2048 sc1
 s_add_u32 s48, s48, 4096
 s_add_u32 s49, s49, 4096
 v_exp_f32 v62, v62
 v_exp_f32 v63, v63
 v_cvt_pk_bf16_f32 v102, v60, v61
 v_cvt_pk_bf16_f32 v103, v62, v63
 v_exp_f32 v32, v32
 v_exp_f32 v33, v33
 v_mfma_f32_32x32x16_bf16 v[64:79], v[252:255], v[100:103], v[64:79]
 s_mov_b64 exec, s[66:67]
 ds_read_b128 v[248:251], v29 offset:2048
 ds_read_b128 v[252:255], v29 offset:3072
 s_mov_b64 exec, -1
 v_exp_f32 v34, v34
 v_cvt_pk_bf16_f32 v96, v32, v33
 v_exp_f32 v35, v35
 buffer_load_dwordx4 a[152:155], v0, s[4:7], s48 offen sc1
 v_exp_f32 v36, v36
 v_cvt_pk_bf16_f32 v97, v34, v35
 s_waitcnt lgkmcnt(4)
 v_mfma_f32_32x32x16_bf16 v[48:63], v[108:111], v[112:115], v[224:239]
 v_exp_f32 v37, v37
 v_exp_f32 v38, v38
 v_cvt_pk_bf16_f32 v98, v36, v37
 v_exp_f32 v39, v39
 v_exp_f32 v40, v40
 v_cvt_pk_bf16_f32 v99, v38, v39
 buffer_load_dwordx4 a[156:159], v0, s[4:7], s49 offen sc1
 v_exp_f32 v41, v41
 v_exp_f32 v42, v42
 s_waitcnt lgkmcnt(2)
 v_mfma_f32_32x32x16_bf16 v[64:79], v[240:243], v[96:99], v[64:79]
 v_cvt_pk_bf16_f32 v100, v40, v41
 v_exp_f32 v43, v43
 v_exp_f32 v44, v44
 v_cvt_pk_bf16_f32 v101, v42, v43
 v_exp_f32 v45, v45
 v_exp_f32 v46, v46
 v_exp_f32 v47, v47
 v_cvt_pk_bf16_f32 v102, v44, v45
 v_cvt_pk_bf16_f32 v103, v46, v47
 v_exp_f32 v48, v48
 v_exp_f32 v49, v49
 v_mfma_f32_32x32x16_bf16 v[64:79], v[244:247], v[100:103], v[64:79]
 v_exp_f32 v50, v50
 v_cvt_pk_bf16_f32 v96, v48, v49
 v_exp_f32 v51, v51
 v_exp_f32 v52, v52
 v_cvt_pk_bf16_f32 v97, v50, v51
 v_exp_f32 v53, v53
 v_exp_f32 v54, v54
 v_cvt_pk_bf16_f32 v98, v52, v53
 v_exp_f32 v55, v55
 v_exp_f32 v56, v56
 v_cvt_pk_bf16_f32 v99, v54, v55
 v_exp_f32 v57, v57
 v_exp_f32 v58, v58
 s_waitcnt lgkmcnt(0)
 v_mfma_f32_32x32x16_bf16 v[64:79], v[248:251], v[96:99], v[64:79]
 v_cvt_pk_bf16_f32 v100, v56, v57
 v_exp_f32 v59, v59
 v_exp_f32 v60, v60
 v_cvt_pk_bf16_f32 v101, v58, v59
 v_exp_f32 v61, v61
 v_exp_f32 v62, v62
 v_exp_f32 v63, v63
 v_cvt_pk_bf16_f32 v102, v60, v61
 v_cvt_pk_bf16_f32 v103, v62, v63
 s_nop 1
 v_mfma_f32_32x32x16_bf16 v[64:79], v[252:255], v[100:103], v[64:79]
L6_aepi:
 v_subrev_u32 v3, 0x2b800000, v88
 v_cmp_lt_u32 vcc, 671088640, v3
 s_cbranch_vccnz L17_fb
L18_fbret:
 v_rcp_f32 v3, v88
 s_nop 0
 v_pk_mul_f32 v[80:81], v[2:3], v[80:81] op_sel:[1,0]
 v_pk_mul_f32 v[82:83], v[2:3], v[82:83] op_sel:[1,0]
 v_pk_mul_f32 v[84:85], v[2:3], v[84:85] op_sel:[1,0]
 v_pk_mul_f32 v[86:87], v[2:3], v[86:87] op_sel:[1,0]
 v_cvt_pk_bf16_f32 v80, v80, v81
 v_cvt_pk_bf16_f32 v81, v82, v83
 v_cvt_pk_bf16_f32 v82, v84, v85
 v_cvt_pk_bf16_f32 v83, v86, v87
 buffer_store_dwordx4 v[80:83], v0, s[4:7], s23 offen
 v_subrev_u32 v3, 0x2b800000, v72
 v_cmp_lt_u32 vcc, 671088640, v3
 s_cbranch_vccnz L19_fb
L20_fbret:
 v_rcp_f32 v3, v72
 s_nop 0
 v_pk_mul_f32 v[64:65], v[2:3], v[64:65] op_sel:[1,0]
 v_pk_mul_f32 v[66:67], v[2:3], v[66:67] op_sel:[1,0]
 v_pk_mul_f32 v[68:69], v[2:3], v[68:69] op_sel:[1,0]
 v_pk_mul_f32 v[70:71], v[2:3], v[70:71] op_sel:[1,0]
 v_cvt_pk_bf16_f32 v64, v64, v65
 v_cvt_pk_bf16_f32 v65, v66, v67
 v_cvt_pk_bf16_f32 v66, v68, v69
 v_cvt_pk_bf16_f32 v67, v70, v71
 buffer_store_dwordx4 v[64:67], v0, s[4:7], s22 offen
 v_mov_b32 v2, s55
 s_cmp_lg_u32 s68, 0
 s_mov_b64 exec, 1
 s_waitcnt vmcnt(0)
 s_cbranch_scc1 L21_rel
 buffer_store_dword v2, v0, s[4:7], s24 offen
 buffer_store_dword v2, v0, s[4:7], s25 offen
L22_relb:
 s_mov_b64 exec, -1
 buffer_load_dword v255, v8, s[4:7], s26 offen sc1
 s_xor_b32 s3, s65, 8192
 v_add_u32 v28, s3, v0
 s_xor_b32 s3, s65, 12288
 v_add_u32 v29, s3, v0
 s_xor_b32 s3, s65, 4096
 v_add_u32 v30, s3, v0
 v_add_u32 v31, s65, v0
 v_permlane32_swap_b32 v20, v22
 v_permlane32_swap_b32 v21, v23
 v_permlane32_swap_b32 v24, v26
 v_permlane32_swap_b32 v25, v27
 v_lshlrev_b32 v12, 16, v20
 v_and_b32 v13, 0xffff0000, v20
 v_lshlrev_b32 v14, 16, v21
 v_and_b32 v15, 0xffff0000, v21
 v_lshlrev_b32 v16, 16, v22
 v_and_b32 v17, 0xffff0000, v22
 v_lshlrev_b32 v18, 16, v23
 v_and_b32 v19, 0xffff0000, v23
 v_lshlrev_b32 v20, 16, v24
 v_and_b32 v21, 0xffff0000, v24
 v_lshlrev_b32 v22, 16, v25
 v_and_b32 v23, 0xffff0000, v25
 v_lshlrev_b32 v24, 16, v26
 v_and_b32 v25, 0xffff0000, v26
 v_lshlrev_b32 v26, 16, v27
 v_and_b32 v27, 0xffff0000, v27
L23_pt:
 s_waitcnt vmcnt(0)
 v_cmp_ne_u32 vcc, s55, v255
 s_cbranch_vccz L24_pd
 buffer_load_dword v255, v8, s[4:7], s26 offen sc1
 s_sub_u32 s57, s57, 1
 s_cbranch_scc0 L23_pt
 s_mov_b32 s57, 0
L24_pd:
 buffer_load_dwordx4 v[160:163], v0, s[4:7], s42 offen sc1
 buffer_load_dwordx4 v[164:167], v0, s[4:7], s42 offen offset:1024 sc1
 buffer_load_dwordx4 v[168:171], v0, s[4:7], s42 offen offset:2048 sc1
 buffer_load_dwordx4 v[172:175], v0, s[4:7], s42 offen offset:3072 sc1
 s_add_u32 s46, s42, 4096
 buffer_load_dwordx4 v[176:179], v0, s[4:7], s46 offen sc1
 buffer_load_dwordx4 v[180:183], v0, s[4:7], s46 offen offset:1024 sc1
 s_waitcnt vmcnt(5)
 v_mfma_f32_32x32x16_bf16 v[32:47], a[0:3], v[160:163], 0
 s_mul_i32 s29, s62, 36864
 s_add_u32 s29, s29, 1048576
 s_lshl_b32 s31, s64, 11
 s_add_u32 s31, s31, s29
 buffer_load_dwordx4 v[184:187], v0, s[4:7], s46 offen offset:2048 sc1
 v_mfma_f32_32x32x16_bf16 v[48:63], a[4:7], v[160:163], 0
 s_lshr_b32 s30, s64, 2
 s_lshl_b32 s30, s30, 10
 s_add_u32 s29, s29, s30
 s_and_b32 s30, s64, 3
 s_waitcnt vmcnt(5)
 v_mfma_f32_32x32x16_bf16 v[32:47], a[8:11], v[164:167], v[32:47]
 s_lshl2_add_u32 s29, s30, s29
 s_add_u32 s29, s29, 32768
 s_lshl_b32 s30, s62, 11
 s_lshl2_add_u32 s30, s64, s30
 buffer_load_dwordx4 v[188:191], v0, s[4:7], s46 offen offset:3072 sc1
 v_mfma_f32_32x32x16_bf16 v[48:63], a[12:15], v[164:167], v[48:63]
 s_add_u32 s30, s30, 3408000
 s_barrier
 s_waitcnt vmcnt(5)
 v_mfma_f32_32x32x16_bf16 v[32:47], a[16:19], v[168:171], v[32:47]
 buffer_load_dwordx4 v[192:195], v0, s[4:7], s43 offen sc1
 v_mfma_f32_32x32x16_bf16 v[48:63], a[20:23], v[168:171], v[48:63]
 s_waitcnt vmcnt(5)
 v_mfma_f32_32x32x16_bf16 v[32:47], a[24:27], v[172:175], v[32:47]
 buffer_load_dwordx4 v[196:199], v0, s[4:7], s43 offen offset:1024 sc1
 v_mfma_f32_32x32x16_bf16 v[48:63], a[28:31], v[172:175], v[48:63]
 s_waitcnt vmcnt(5)
 v_mfma_f32_32x32x16_bf16 v[32:47], a[32:35], v[176:179], v[32:47]
 buffer_load_dwordx4 v[200:203], v0, s[4:7], s43 offen offset:2048 sc1
 v_mfma_f32_32x32x16_bf16 v[48:63], a[36:39], v[176:179], v[48:63]
 s_waitcnt vmcnt(5)
 v_mfma_f32_32x32x16_bf16 v[32:47], a[40:43], v[180:183], v[32:47]
 buffer_load_dwordx4 v[204:207], v0, s[4:7], s43 offen offset:3072 sc1
 v_mfma_f32_32x32x16_bf16 v[48:63], a[44:47], v[180:183], v[48:63]
 s_waitcnt vmcnt(5)
 v_mfma_f32_32x32x16_bf16 v[32:47], a[48:51], v[184:187], v[32:47]
 s_add_u32 s46, s43, 4096
 buffer_load_dwordx4 v[208:211], v0, s[4:7], s46 offen sc1
 v_mfma_f32_32x32x16_bf16 v[48:63], a[52:55], v[184:187], v[48:63]
 s_waitcnt vmcnt(5)
 v_mfma_f32_32x32x16_bf16 v[32:47], v[144:147], v[188:191], v[32:47]
 buffer_load_dwordx4 v[212:215], v0, s[4:7], s46 offen offset:1024 sc1
 v_mfma_f32_32x32x16_bf16 v[48:63], v[148:151], v[188:191], v[48:63]
 s_waitcnt vmcnt(5)
 v_mfma_f32_32x32x16_bf16 v[64:79], a[4:7], v[192:195], 0
 buffer_load_dwordx4 v[216:219], v0, s[4:7], s46 offen offset:2048 sc1
 v_mfma_f32_32x32x16_bf16 v[12:27], a[0:3], v[192:195], v[12:27]
 s_waitcnt vmcnt(5)
 v_mfma_f32_32x32x16_bf16 v[64:79], a[12:15], v[196:199], v[64:79]
 buffer_load_dwordx4 v[220:223], v0, s[4:7], s46 offen offset:3072 sc1
 v_mfma_f32_32x32x16_bf16 v[12:27], a[8:11], v[196:199], v[12:27]
 s_nop 1
 ds_write_b128 v28, v[32:35] offset:0
 s_waitcnt vmcnt(5)
 v_mfma_f32_32x32x16_bf16 v[64:79], a[20:23], v[200:203], v[64:79]
 ds_write_b128 v28, v[36:39] offset:1024
 v_cmp_ne_u32 vcc, s55, v10
 s_cbranch_vccnz L25_spin
L26_got:
 s_mul_i32 s37, s52, 204800
 s_lshl1_add_u32 s3, s50, s70
 s_lshl_b32 s3, s3, 10
 s_add_u32 s37, s37, s3
 s_add_u32 s37, s37, 18874368
 s_add_u32 m0, s65, 49152
 s_nop 0
 buffer_load_dwordx4 v0, s[4:7], s37 offen sc1 lds
 buffer_load_dwordx4 v0, s[4:7], s37 offen offset:1024 sc1 lds
 s_add_u32 s37, s37, 10240
 v_mfma_f32_32x32x16_bf16 v[12:27], a[16:19], v[200:203], v[12:27]
 ds_write_b128 v28, v[40:43] offset:2048
 s_waitcnt vmcnt(6)
 v_mfma_f32_32x32x16_bf16 v[64:79], a[28:31], v[204:207], v[64:79]
 ds_write_b128 v28, v[44:47] offset:3072
 s_add_u32 m0, s65, 51200
 s_nop 0
 buffer_load_dwordx4 v0, s[4:7], s37 offen sc1 lds
 buffer_load_dwordx4 v0, s[4:7], s37 offen offset:1024 sc1 lds
 s_add_u32 s37, s37, 10240
 v_mfma_f32_32x32x16_bf16 v[12:27], a[24:27], v[204:207], v[12:27]
 ds_write_b128 v29, v[48:51] offset:16384
 s_waitcnt vmcnt(7)
 v_mfma_f32_32x32x16_bf16 v[64:79], a[36:39], v[208:211], v[64:79]
 ds_write_b128 v29, v[52:55] offset:17408
 buffer_load_dwordx4 a[160:163], v0, s[4:7], s48 offen offset:2048 sc1
 buffer_load_dwordx4 a[164:167], v0, s[4:7], s49 offen offset:2048 sc1
 s_add_u32 s48, s48, 4096
 s_add_u32 s49, s49, 4096
 s_waitcnt vmcnt(8)
 v_mfma_f32_32x32x16_bf16 v[64:79], a[44:47], v[212:215], v[64:79]
 ds_write_b128 v29, v[56:59] offset:18432
 buffer_load_dwordx4 a[168:171], v0, s[4:7], s48 offen sc1
 buffer_load_dwordx4 a[172:175], v0, s[4:7], s49 offen sc1
 s_waitcnt vmcnt(9)
 v_mfma_f32_32x32x16_bf16 v[64:79], a[52:55], v[216:219], v[64:79]
 ds_write_b128 v29, v[60:63] offset:19456
 s_waitcnt vmcnt(8)
 v_mfma_f32_32x32x16_bf16 v[64:79], v[148:151], v[220:223], v[64:79]
 v_mfma_f32_32x32x16_bf16 v[12:27], a[32:35], v[208:211], v[12:27]
 v_mfma_f32_32x32x16_bf16 v[12:27], a[40:43], v[212:215], v[12:27]
 s_waitcnt lgkmcnt(0)
 s_barrier
 v_mfma_f32_32x32x16_bf16 v[12:27], a[48:51], v[216:219], v[12:27]
 s_nop 6
 ds_write_b128 v30, v[64:67] offset:32768
 v_mfma_f32_32x32x16_bf16 v[12:27], v[144:147], v[220:223], v[12:27]
 ds_write_b128 v30, v[68:71] offset:33792
 ds_write_b128 v30, v[72:75] offset:34816
 ds_write_b128 v30, v[76:79] offset:35840
 ds_read_b128 v[32:35], v31 offset:0
 ds_read_b128 v[36:39], v31 offset:1024
 ds_read_b128 v[40:43], v31 offset:2048
 ds_read_b128 v[44:47], v31 offset:3072
 ds_read_b128 v[48:51], v31 offset:16384
 ds_read_b128 v[52:55], v31 offset:17408
 ds_read_b128 v[56:59], v31 offset:18432
 ds_read_b128 v[60:63], v31 offset:19456
 s_waitcnt lgkmcnt(8)
 s_barrier
 ds_read_b128 v[64:67], v31 offset:32768
 ds_read_b128 v[68:71], v31 offset:33792
 ds_read_b128 v[72:75], v31 offset:34816
 ds_read_b128 v[76:79], v31 offset:35840
 s_waitcnt lgkmcnt(11)
 v_pk_add_f32 v[12:13], v[12:13], v[32:33]
 v_pk_add_f32 v[14:15], v[14:15], v[34:35]
 s_waitcnt lgkmcnt(10)
 v_pk_add_f32 v[16:17], v[16:17], v[36:37]
 v_pk_add_f32 v[18:19], v[18:19], v[38:39]
 s_waitcnt lgkmcnt(9)
 v_pk_add_f32 v[20:21], v[20:21], v[40:41]
 v_pk_add_f32 v[22:23], v[22:23], v[42:43]
 s_waitcnt lgkmcnt(8)
 v_pk_add_f32 v[24:25], v[24:25], v[44:45]
 v_pk_add_f32 v[26:27], v[26:27], v[46:47]
 s_waitcnt lgkmcnt(7)
 v_pk_add_f32 v[12:13], v[12:13], v[48:49]
 v_pk_add_f32 v[14:15], v[14:15], v[50:51]
 s_waitcnt lgkmcnt(6)
 v_pk_add_f32 v[16:17], v[16:17], v[52:53]
 v_pk_add_f32 v[18:19], v[18:19], v[54:55]
 s_waitcnt lgkmcnt(5)
 v_pk_add_f32 v[20:21], v[20:21], v[56:57]
 v_pk_add_f32 v[22:23], v[22:23], v[58:59]
 s_waitcnt lgkmcnt(4)
 v_pk_add_f32 v[24:25], v[24:25], v[60:61]
 v_pk_add_f32 v[26:27], v[26:27], v[62:63]
 s_waitcnt lgkmcnt(3)
 v_pk_add_f32 v[12:13], v[12:13], v[64:65]
 v_pk_add_f32 v[14:15], v[14:15], v[66:67]
 s_waitcnt lgkmcnt(2)
 v_pk_add_f32 v[16:17], v[16:17], v[68:69]
 v_pk_add_f32 v[18:19], v[18:19], v[70:71]
 s_waitcnt lgkmcnt(1)
 v_pk_add_f32 v[20:21], v[20:21], v[72:73]
 v_pk_add_f32 v[22:23], v[22:23], v[74:75]
 s_waitcnt lgkmcnt(0)
 v_pk_add_f32 v[24:25], v[24:25], v[76:77]
 v_pk_add_f32 v[26:27], v[26:27], v[78:79]
 v_cvt_pk_bf16_f32 v32, v12, v13
 v_cvt_pk_bf16_f32 v33, v14, v15
 v_cvt_pk_bf16_f32 v34, v16, v17
 v_cvt_pk_bf16_f32 v35, v18, v19
 buffer_store_dwordx4 v[32:35], v0, s[4:7], s31 offen
 v_cvt_pk_bf16_f32 v36, v20, v21
 v_cvt_pk_bf16_f32 v37, v22, v23
 v_cvt_pk_bf16_f32 v38, v24, v25
 v_cvt_pk_bf16_f32 v39, v26, v27
 buffer_store_dwordx4 v[36:39], v0, s[4:7], s31 offen offset:1024
 v_pk_add_f32 v[40:41], v[12:13], v[14:15]
 v_pk_mul_f32 v[42:43], v[12:13], v[12:13]
 v_pk_fma_f32 v[42:43], v[14:15], v[14:15], v[42:43]
 v_pk_add_f32 v[40:41], v[40:41], v[16:17]
 v_pk_fma_f32 v[42:43], v[16:17], v[16:17], v[42:43]
 v_pk_add_f32 v[40:41], v[40:41], v[18:19]
 v_pk_fma_f32 v[42:43], v[18:19], v[18:19], v[42:43]
 v_pk_add_f32 v[40:41], v[40:41], v[20:21]
 v_pk_fma_f32 v[42:43], v[20:21], v[20:21], v[42:43]
 v_pk_add_f32 v[40:41], v[40:41], v[22:23]
 v_pk_fma_f32 v[42:43], v[22:23], v[22:23], v[42:43]
 v_pk_add_f32 v[40:41], v[40:41], v[24:25]
 v_pk_fma_f32 v[42:43], v[24:25], v[24:25], v[42:43]
 v_pk_add_f32 v[40:41], v[40:41], v[26:27]
 v_pk_fma_f32 v[42:43], v[26:27], v[26:27], v[42:43]
 v_add_f32 v40, v40, v41
 v_add_f32 v42, v42, v43
 v_bfe_u32 v1, v0, 2, 6
 s_add_u32 s28, s61, 128
 v_permlane32_swap_b32 v40, v42
 v_add_f32 v3, v40, v42
 v_mov_b32 v2, s55
 s_cmp_lg_u32 s68, 0
 s_mov_b64 exec, 1
 s_waitcnt vmcnt(0)
 s_cbranch_scc1 L27_rel
 buffer_store_dword v2, v0, s[4:7], s30 offen
L28_relb:
 s_mov_b64 exec, -1
 buffer_store_dword v3, v0, s[4:7], s29 offen
 s_add_u32 m0, s65, 0
 s_nop 0
 buffer_load_dwordx4 v0, s[4:7], s37 offen sc1 lds
 buffer_load_dwordx4 v0, s[4:7], s37 offen offset:1024 sc1 lds
 s_add_u32 s37, s37, 10240
 s_add_u32 m0, s65, 2048
 s_nop 0
 buffer_load_dwordx4 v0, s[4:7], s37 offen sc1 lds
 buffer_load_dwordx4 v0, s[4:7], s37 offen offset:1024 sc1 lds
 s_add_u32 s37, s37, 10240
 s_add_u32 m0, s65, 16384
 s_nop 0
 buffer_load_dwordx4 v0, s[4:7], s37 offen sc1 lds
 buffer_load_dwordx4 v0, s[4:7], s37 offen offset:1024 sc1 lds
 s_add_u32 s37, s37, 10240
 buffer_load_dword v255, v1, s[4:7], s28 offen sc1
 v_bfe_u32 v28, v0, 4, 5
 v_lshlrev_b32 v28, 2, v28
 v_and_b32 v29, 0x200, v0
 v_add_u32 v28, v28, v29
 v_add_u32 v30, 65536, v0
 v_add_u32 v31, 131072, v0
 s_mul_i32 s33, s52, 5120
 s_add_u32 s33, s33, s60
 s_add_u32 s34, s33, 4096
 s_add_u32 s35, s52, 80
 s_lshl_b32 s35, s35, 10
 s_add_u32 s35, s35, s60
 s_lshl2_add_u32 s36, s52, s61
 s_add_u32 s36, s36, 256
 s_add_u32 s38, s36, 64
 s_add_u32 s39, s36, 128
 s_add_u32 s32, s59, 0
L29_pt:
 s_waitcnt vmcnt(0)
 v_cmp_ne_u32 vcc, s55, v255
 s_cbranch_vccz L30_pd
 buffer_load_dword v255, v1, s[4:7], s28 offen sc1
 s_sub_u32 s57, s57, 1
 s_cbranch_scc0 L29_pt
 s_mov_b32 s57, 0
L30_pd:
 buffer_load_dwordx4 v[32:35], v0, s[4:7], s32 offen sc1
 buffer_load_dwordx4 v[36:39], v0, s[4:7], s32 offen offset:1024 sc1
 buffer_load_dwordx4 v[40:43], v0, s[4:7], s32 offen offset:2048 sc1
 buffer_load_dwordx4 v[44:47], v0, s[4:7], s32 offen offset:3072 sc1
 s_add_u32 s32, s59, 4096
 buffer_load_dwordx4 v[48:51], v0, s[4:7], s32 offen sc1
 s_add_u32 s30, s30, 64
 v_mov_b32 v2, s55
 s_cmp_lg_u32 s68, 0
 s_mov_b64 exec, 1
 s_cbranch_scc1 L31_rel
 buffer_store_dword v2, v0, s[4:7], s30 offen
L32_relb:
 s_mov_b64 exec, -1
 buffer_load_dwordx4 v[52:55], v0, s[4:7], s32 offen offset:1024 sc1
 buffer_load_dwordx4 v[56:59], v0, s[4:7], s32 offen offset:2048 sc1
 buffer_load_dwordx4 v[60:63], v0, s[4:7], s32 offen offset:3072 sc1
 s_barrier
 ds_read_b128 a[240:243], v0 offset:49152
 ds_read_b128 a[244:247], v0 offset:50176
 ds_read_b128 a[248:251], v0 offset:53248
 ds_read_b128 a[252:255], v0 offset:54272
 s_waitcnt vmcnt(8) lgkmcnt(3)
 v_mfma_f32_32x32x16_bf16 v[160:175], a[240:243], v[32:35], 0
 s_add_u32 s32, s59, 8192
 buffer_load_dwordx4 v[64:67], v0, s[4:7], s32 offen sc1
 ds_read_b128 a[240:243], v0 offset:57344
 s_waitcnt lgkmcnt(3)
 v_mfma_f32_32x32x16_bf16 v[176:191], a[244:247], v[32:35], 0
 s_add_u32 m0, s65, 18432
 s_nop 0
 buffer_load_dwordx4 v0, s[4:7], s37 offen sc1 lds
 ds_read_b128 a[244:247], v0 offset:58368
 s_waitcnt lgkmcnt(3)
 v_mfma_f32_32x32x16_bf16 v[192:207], a[248:251], v[32:35], 0
 buffer_load_dwordx4 v[68:71], v0, s[4:7], s32 offen offset:1024 sc1
 ds_read_b128 a[248:251], v0 offset:61440
 s_waitcnt lgkmcnt(3)
 v_mfma_f32_32x32x16_bf16 v[208:223], a[252:255], v[32:35], 0
 buffer_load_dwordx4 v0, s[4:7], s37 offen offset:1024 sc1 lds
 s_add_u32 s37, s37, 10240
 ds_read_b128 a[252:255], v0 offset:62464
 s_waitcnt vmcnt(11) lgkmcnt(3)
 v_mfma_f32_32x32x16_bf16 v[160:175], a[240:243], v[36:39], v[160:175]
 buffer_load_dwordx4 v[72:75], v0, s[4:7], s32 offen offset:2048 sc1
 s_barrier
 ds_read_b128 a[240:243], v0 offset:51200
 s_waitcnt lgkmcnt(3)
 v_mfma_f32_32x32x16_bf16 v[176:191], a[244:247], v[36:39], v[176:191]
 s_add_u32 m0, s65, 32768
 s_nop 0
 buffer_load_dwordx4 v0, s[4:7], s37 offen sc1 lds
 ds_read_b128 a[244:247], v0 offset:52224
 s_waitcnt lgkmcnt(3)
 v_mfma_f32_32x32x16_bf16 v[192:207], a[248:251], v[36:39], v[192:207]
 buffer_load_dwordx4 v[76:79], v0, s[4:7], s32 offen offset:3072 sc1
 ds_read_b128 a[248:251], v0 offset:55296
 s_waitcnt lgkmcnt(3)
 v_mfma_f32_32x32x16_bf16 v[208:223], a[252:255], v[36:39], v[208:223]
 buffer_load_dwordx4 v0, s[4:7], s37 offen offset:1024 sc1 lds
 s_add_u32 s37, s37, 10240
 ds_read_b128 a[252:255], v0 offset:56320
 s_waitcnt vmcnt(14) lgkmcnt(3)
 v_mfma_f32_32x32x16_bf16 v[160:175], a[240:243], v[40:43], v[160:175]
 s_add_u32 s32, s59, 12288
 buffer_load_dwordx4 v[80:83], v0, s[4:7], s32 offen sc1
 ds_read_b128 a[240:243], v0 offset:59392
 s_waitcnt lgkmcnt(3)
 v_mfma_f32_32x32x16_bf16 v[176:191], a[244:247], v[40:43], v[176:191]
 s_add_u32 m0, s65, 34816
 s_nop 0
 buffer_load_dwordx4 v0, s[4:7], s37 offen sc1 lds
 ds_read_b128 a[244:247], v0 offset:60416
 s_waitcnt lgkmcnt(3)
 v_mfma_f32_32x32x16_bf16 v[192:207], a[248:251], v[40:43], v[192:207]
 buffer_load_dwordx4 v[84:87], v0, s[4:7], s32 offen offset:1024 sc1
 ds_read_b128 a[248:251], v0 offset:63488
 s_waitcnt lgkmcnt(3)
 v_mfma_f32_32x32x16_bf16 v[208:223], a[252:255], v[40:43], v[208:223]
 ds_read_b128 a[252:255], v0 offset:64512
 s_waitcnt vmcnt(16) lgkmcnt(3)
 v_mfma_f32_32x32x16_bf16 v[160:175], a[240:243], v[44:47], v[160:175]
 buffer_load_dwordx4 v[88:91], v0, s[4:7], s32 offen offset:2048 sc1
 s_barrier
 ds_read_b128 a[240:243], v0 offset:0
 s_waitcnt lgkmcnt(3)
 v_mfma_f32_32x32x16_bf16 v[176:191], a[244:247], v[44:47], v[176:191]
 buffer_load_dwordx4 v0, s[4:7], s37 offen offset:1024 sc1 lds
 s_add_u32 s37, s37, 10240
 ds_read_b128 a[244:247], v0 offset:1024
 s_waitcnt lgkmcnt(3)
 v_mfma_f32_32x32x16_bf16 v[192:207], a[248:251], v[44:47], v[192:207]
 buffer_load_dwordx4 v[92:95], v0, s[4:7], s32 offen offset:3072 sc1
 ds_read_b128 a[248:251], v0 offset:4096
 s_waitcnt lgkmcnt(3)
 v_mfma_f32_32x32x16_bf16 v[208:223], a[252:255], v[44:47], v[208:223]
 s_add_u32 m0, s65, 49152
 s_nop 0
 buffer_load_dwordx4 v0, s[4:7], s37 offen sc1 lds
 ds_read_b128 a[252:255], v0 offset:5120
 s_waitcnt vmcnt(19) lgkmcnt(3)
 v_mfma_f32_32x32x16_bf16 v[160:175], a[240:243], v[48:51], v[160:175]
 s_add_u32 s32, s59, 16384
 buffer_load_dwordx4 v[96:99], v0, s[4:7], s32 offen sc1
 ds_read_b128 a[240:243], v0 offset:8192
 s_waitcnt lgkmcnt(3)
 v_mfma_f32_32x32x16_bf16 v[176:191], a[244:247], v[48:51], v[176:191]
 buffer_load_dwordx4 v0, s[4:7], s37 offen offset:1024 sc1 lds
 s_add_u32 s37, s37, 10240
 ds_read_b128 a[244:247], v0 offset:9216
 s_waitcnt lgkmcnt(3)
 v_mfma_f32_32x32x16_bf16 v[192:207], a[248:251], v[48:51], v[192:207]
 ds_read_b128 a[248:251], v0 offset:12288
 s_waitcnt lgkmcnt(3)
 v_mfma_f32_32x32x16_bf16 v[208:223], a[252:255], v[48:51], v[208:223]
 ds_read_b128 a[252:255], v0 offset:13312
 s_waitcnt vmcnt(19) lgkmcnt(3)
 v_mfma_f32_32x32x16_bf16 v[160:175], a[240:243], v[52:55], v[160:175]
 buffer_load_dwordx4 v[100:103], v0, s[4:7], s32 offen offset:1024 sc1
 s_barrier
 ds_read_b128 a[240:243], v0 offset:2048
 s_waitcnt lgkmcnt(3)
 v_mfma_f32_32x32x16_bf16 v[176:191], a[244:247], v[52:55], v[176:191]
 s_add_u32 m0, s65, 51200
 s_nop 0
 buffer_load_dwordx4 v0, s[4:7], s37 offen sc1 lds
 ds_read_b128 a[244:247], v0 offset:3072
 s_waitcnt lgkmcnt(3)
 v_mfma_f32_32x32x16_bf16 v[192:207], a[248:251], v[52:55], v[192:207]
 ds_read_b128 a[248:251], v0 offset:6144
 s_waitcnt lgkmcnt(3)
 v_mfma_f32_32x32x16_bf16 v[208:223], a[252:255], v[52:55], v[208:223]
 ds_read_b128 a[252:255], v0 offset:7168
 s_waitcnt vmcnt(20) lgkmcnt(3)
 v_mfma_f32_32x32x16_bf16 v[160:175], a[240:243], v[56:59], v[160:175]
 buffer_load_dwordx4 v[104:107], v0, s[4:7], s32 offen offset:2048 sc1
 ds_read_b128 a[240:243], v0 offset:10240
 s_waitcnt lgkmcnt(3)
 v_mfma_f32_32x32x16_bf16 v[176:191], a[244:247], v[56:59], v[176:191]
 buffer_load_dwordx4 v0, s[4:7], s37 offen offset:1024 sc1 lds
 s_add_u32 s37, s37, 10240
 ds_read_b128 a[244:247], v0 offset:11264
 s_waitcnt lgkmcnt(3)
 v_mfma_f32_32x32x16_bf16 v[192:207], a[248:251], v[56:59], v[192:207]
 ds_read_b128 a[248:251], v0 offset:14336
 s_waitcnt lgkmcnt(3)
 v_mfma_f32_32x32x16_bf16 v[208:223], a[252:255], v[56:59], v[208:223]
 ds_read_b128 a[252:255], v0 offset:15360
 s_waitcnt vmcnt(21) lgkmcnt(3)
 v_mfma_f32_32x32x16_bf16 v[160:175], a[240:243], v[60:63], v[160:175]
 buffer_load_dwordx4 v[108:111], v0, s[4:7], s32 offen offset:3072 sc1
 s_barrier
 ds_read_b128 a[240:243], v0 offset:16384
 s_waitcnt lgkmcnt(3)
 v_mfma_f32_32x32x16_bf16 v[176:191], a[244:247], v[60:63], v[176:191]
 s_add_u32 m0, s65, 0
 s_nop 0
 buffer_load_dwordx4 v0, s[4:7], s37 offen sc1 lds
 ds_read_b128 a[244:247], v0 offset:17408
 s_waitcnt lgkmcnt(3)
 v_mfma_f32_32x32x16_bf16 v[192:207], a[248:251], v[60:63], v[192:207]
 ds_read_b128 a[248:251], v0 offset:20480
 s_waitcnt lgkmcnt(3)
 v_mfma_f32_32x32x16_bf16 v[208:223], a[252:255], v[60:63], v[208:223]
 ds_read_b128 a[252:255], v0 offset:21504
 s_waitcnt vmcnt(22) lgkmcnt(3)
 v_mfma_f32_32x32x16_bf16 v[160:175], a[240:243], v[64:67], v[160:175]
 s_add_u32 s32, s59, 20480
 buffer_load_dwordx4 v[112:115], v0, s[4:7], s32 offen sc1
 ds_read_b128 a[240:243], v0 offset:24576
 s_waitcnt lgkmcnt(3)
 v_mfma_f32_32x32x16_bf16 v[176:191], a[244:247], v[64:67], v[176:191]
 buffer_load_dwordx4 v0, s[4:7], s37 offen offset:1024 sc1 lds
 s_add_u32 s37, s37, 10240
 ds_read_b128 a[244:247], v0 offset:25600
 s_waitcnt lgkmcnt(3)
 v_mfma_f32_32x32x16_bf16 v[192:207], a[248:251], v[64:67], v[192:207]
 ds_read_b128 a[248:251], v0 offset:28672
 s_waitcnt lgkmcnt(3)
 v_mfma_f32_32x32x16_bf16 v[208:223], a[252:255], v[64:67], v[208:223]
 ds_read_b128 a[252:255], v0 offset:29696
 s_waitcnt vmcnt(22) lgkmcnt(3)
 v_mfma_f32_32x32x16_bf16 v[160:175], a[240:243], v[68:71], v[160:175]
 buffer_load_dwordx4 v[116:119], v0, s[4:7], s32 offen offset:1024 sc1
 s_waitcnt vmcnt(22)
 s_barrier
 ds_read_b128 a[240:243], v0 offset:18432
 s_waitcnt lgkmcnt(3)
 v_mfma_f32_32x32x16_bf16 v[176:191], a[244:247], v[68:71], v[176:191]
 s_add_u32 m0, s65, 2048
 s_nop 0
 buffer_load_dwordx4 v0, s[4:7], s37 offen sc1 lds
 ds_read_b128 a[244:247], v0 offset:19456
 s_waitcnt lgkmcnt(3)
 v_mfma_f32_32x32x16_bf16 v[192:207], a[248:251], v[68:71], v[192:207]
 ds_read_b128 a[248:251], v0 offset:22528
 s_waitcnt lgkmcnt(3)
 v_mfma_f32_32x32x16_bf16 v[208:223], a[252:255], v[68:71], v[208:223]
 ds_read_b128 a[252:255], v0 offset:23552
 s_waitcnt vmcnt(22) lgkmcnt(3)
 v_mfma_f32_32x32x16_bf16 v[160:175], a[240:243], v[72:75], v[160:175]
 buffer_load_dwordx4 v[120:123], v0, s[4:7], s32 offen offset:2048 sc1
 buffer_load_dword v240, v1, s[4:7], s28 offen offset:64 sc1
 ds_read_b128 a[240:243], v0 offset:26624
 s_waitcnt lgkmcnt(3)
 v_mfma_f32_32x32x16_bf16 v[176:191], a[244:247], v[72:75], v[176:191]
 buffer_load_dwordx4 v0, s[4:7], s37 offen offset:1024 sc1 lds
 s_add_u32 s37, s37, 10240
 ds_read_b128 a[244:247], v0 offset:27648
 s_waitcnt lgkmcnt(3)
 v_mfma_f32_32x32x16_bf16 v[192:207], a[248:251], v[72:75], v[192:207]
 ds_read_b128 a[248:251], v0 offset:30720
 s_waitcnt lgkmcnt(3)
 v_mfma_f32_32x32x16_bf16 v[208:223], a[252:255], v[72:75], v[208:223]
 ds_read_b128 a[252:255], v0 offset:31744
 s_waitcnt vmcnt(23) lgkmcnt(3)
 v_mfma_f32_32x32x16_bf16 v[160:175], a[240:243], v[76:79], v[160:175]
 buffer_load_dwordx4 v[124:127], v0, s[4:7], s32 offen offset:3072 sc1
 s_waitcnt vmcnt(23)
 s_barrier
 ds_read_b128 a[240:243], v0 offset:32768
 s_waitcnt lgkmcnt(3)
 v_mfma_f32_32x32x16_bf16 v[176:191], a[244:247], v[76:79], v[176:191]
 s_add_u32 m0, s65, 16384
 s_nop 0
 buffer_load_dwordx4 v0, s[4:7], s37 offen sc1 lds
 ds_read_b128 a[244:247], v0 offset:33792
 s_waitcnt lgkmcnt(3)
 v_mfma_f32_32x32x16_bf16 v[192:207], a[248:251], v[76:79], v[192:207]
 ds_read_b128 a[248:251], v0 offset:36864
 s_waitcnt lgkmcnt(3)
 v_mfma_f32_32x32x16_bf16 v[208:223], a[252:255], v[76:79], v[208:223]
 ds_read_b128 a[252:255], v0 offset:37888
 s_waitcnt vmcnt(23) lgkmcnt(3)
 v_mfma_f32_32x32x16_bf16 v[160:175], a[240:243], v[80:83], v[160:175]
 s_add_u32 s32, s59, 24576
 buffer_load_dwordx4 v[128:131], v0, s[4:7], s32 offen sc1
 ds_read_b128 a[240:243], v0 offset:40960
 s_waitcnt lgkmcnt(3)
 v_mfma_f32_32x32x16_bf16 v[176:191], a[244:247], v[80:83], v[176:191]
 buffer_load_dwordx4 v0, s[4:7], s37 offen offset:1024 sc1 lds
 s_add_u32 s37, s37, 10240
 ds_read_b128 a[244:247], v0 offset:41984
 s_waitcnt lgkmcnt(3)
 v_mfma_f32_32x32x16_bf16 v[192:207], a[248:251], v[80:83], v[192:207]
 ds_read_b128 a[248:251], v0 offset:45056
 s_waitcnt lgkmcnt(3)
 v_mfma_f32_32x32x16_bf16 v[208:223], a[252:255], v[80:83], v[208:223]
 ds_read_b128 a[252:255], v0 offset:46080
 s_waitcnt vmcnt(23) lgkmcnt(3)
 v_mfma_f32_32x32x16_bf16 v[160:175], a[240:243], v[84:87], v[160:175]
 buffer_load_dwordx4 v[132:135], v0, s[4:7], s32 offen offset:1024 sc1
 s_waitcnt vmcnt(22)
 s_barrier
 ds_read_b128 a[240:243], v0 offset:34816
 s_waitcnt lgkmcnt(3)
 v_mfma_f32_32x32x16_bf16 v[176:191], a[244:247], v[84:87], v[176:191]
 s_add_u32 m0, s65, 18432
 s_nop 0
 buffer_load_dwordx4 v0, s[4:7], s37 offen sc1 lds
 ds_read_b128 a[244:247], v0 offset:35840
 s_waitcnt lgkmcnt(3)
 v_mfma_f32_32x32x16_bf16 v[192:207], a[248:251], v[84:87], v[192:207]
 ds_read_b128 a[248:251], v0 offset:38912
 s_waitcnt lgkmcnt(3)
 v_mfma_f32_32x32x16_bf16 v[208:223], a[252:255], v[84:87], v[208:223]
 ds_read_b128 a[252:255], v0 offset:39936
 s_waitcnt lgkmcnt(3)
 v_mfma_f32_32x32x16_bf16 v[160:175], a[240:243], v[88:91], v[160:175]
 buffer_load_dwordx4 v[136:139], v0, s[4:7], s32 offen offset:2048 sc1
 ds_read_b128 a[240:243], v0 offset:43008
 s_waitcnt lgkmcnt(3)
 v_mfma_f32_32x32x16_bf16 v[176:191], a[244:247], v[88:91], v[176:191]
 buffer_load_dwordx4 v0, s[4:7], s37 offen offset:1024 sc1 lds
 s_add_u32 s37, s37, 10240
 ds_read_b128 a[244:247], v0 offset:44032
 s_waitcnt lgkmcnt(3)
 v_mfma_f32_32x32x16_bf16 v[192:207], a[248:251], v[88:91], v[192:207]
 ds_read_b128 a[248:251], v0 offset:47104
 s_waitcnt lgkmcnt(3)
 v_mfma_f32_32x32x16_bf16 v[208:223], a[252:255], v[88:91], v[208:223]
 ds_read_b128 a[252:255], v0 offset:48128
 s_waitcnt vmcnt(24) lgkmcnt(3)
 v_mfma_f32_32x32x16_bf16 v[160:175], a[240:243], v[92:95], v[160:175]
 buffer_load_dwordx4 v[140:143], v0, s[4:7], s32 offen offset:3072 sc1
 s_waitcnt vmcnt(22)
 s_barrier
 ds_read_b128 a[240:243], v0 offset:49152
 s_waitcnt lgkmcnt(3)
 v_mfma_f32_32x32x16_bf16 v[176:191], a[244:247], v[92:95], v[176:191]
 s_add_u32 m0, s65, 32768
 s_nop 0
 buffer_load_dwordx4 v0, s[4:7], s37 offen sc1 lds
 ds_read_b128 a[244:247], v0 offset:50176
 s_waitcnt lgkmcnt(3)
 v_mfma_f32_32x32x16_bf16 v[192:207], a[248:251], v[92:95], v[192:207]
 ds_read_b128 a[248:251], v0 offset:53248
 s_waitcnt lgkmcnt(3)
 v_mfma_f32_32x32x16_bf16 v[208:223], a[252:255], v[92:95], v[208:223]
 ds_read_b128 a[252:255], v0 offset:54272
 s_waitcnt lgkmcnt(3)
 v_mfma_f32_32x32x16_bf16 v[160:175], a[240:243], v[96:99], v[160:175]
 s_add_u32 s32, s59, 28672
 buffer_load_dwordx4 v[144:147], v0, s[4:7], s32 offen sc1
 ds_read_b128 a[240:243], v0 offset:57344
 s_waitcnt lgkmcnt(3)
 v_mfma_f32_32x32x16_bf16 v[176:191], a[244:247], v[96:99], v[176:191]
 buffer_load_dwordx4 v0, s[4:7], s37 offen offset:1024 sc1 lds
 s_add_u32 s37, s37, 10240
 ds_read_b128 a[244:247], v0 offset:58368
 s_waitcnt lgkmcnt(3)
 v_mfma_f32_32x32x16_bf16 v[192:207], a[248:251], v[96:99], v[192:207]
 ds_read_b128 a[248:251], v0 offset:61440
 s_waitcnt lgkmcnt(3)
 v_mfma_f32_32x32x16_bf16 v[208:223], a[252:255], v[96:99], v[208:223]
 ds_read_b128 a[252:255], v0 offset:62464
 s_waitcnt vmcnt(24) lgkmcnt(3)
 v_mfma_f32_32x32x16_bf16 v[160:175], a[240:243], v[100:103], v[160:175]
 buffer_load_dwordx4 v[148:151], v0, s[4:7], s32 offen offset:1024 sc1
 s_waitcnt vmcnt(22)
 s_barrier
 ds_read_b128 a[240:243], v0 offset:51200
 s_waitcnt lgkmcnt(3)
 v_mfma_f32_32x32x16_bf16 v[176:191], a[244:247], v[100:103], v[176:191]
 s_add_u32 m0, s65, 34816
 s_nop 0
 buffer_load_dwordx4 v0, s[4:7], s37 offen sc1 lds
 ds_read_b128 a[244:247], v0 offset:52224
 s_waitcnt lgkmcnt(3)
 v_mfma_f32_32x32x16_bf16 v[192:207], a[248:251], v[100:103], v[192:207]
 ds_read_b128 a[248:251], v0 offset:55296
 s_waitcnt lgkmcnt(3)
 v_mfma_f32_32x32x16_bf16 v[208:223], a[252:255], v[100:103], v[208:223]
 ds_read_b128 a[252:255], v0 offset:56320
 s_waitcnt lgkmcnt(3)
 v_mfma_f32_32x32x16_bf16 v[160:175], a[240:243], v[104:107], v[160:175]
 buffer_load_dwordx4 v[152:155], v0, s[4:7], s32 offen offset:2048 sc1
 ds_read_b128 a[240:243], v0 offset:59392
 s_waitcnt lgkmcnt(3)
 v_mfma_f32_32x32x16_bf16 v[176:191], a[244:247], v[104:107], v[176:191]
 buffer_load_dwordx4 v0, s[4:7], s37 offen offset:1024 sc1 lds
 s_add_u32 s37, s37, 10240
 ds_read_b128 a[244:247], v0 offset:60416
 s_waitcnt lgkmcnt(3)
 v_mfma_f32_32x32x16_bf16 v[192:207], a[248:251], v[104:107], v[192:207]
 ds_read_b128 a[248:251], v0 offset:63488
 s_waitcnt lgkmcnt(3)
 v_mfma_f32_32x32x16_bf16 v[208:223], a[252:255], v[104:107], v[208:223]
 ds_read_b128 a[252:255], v0 offset:64512
 s_waitcnt vmcnt(24) lgkmcnt(3)
 v_mfma_f32_32x32x16_bf16 v[160:175], a[240:243], v[108:111], v[160:175]
 buffer_load_dwordx4 v[156:159], v0, s[4:7], s32 offen offset:3072 sc1
 s_waitcnt vmcnt(22)
 s_barrier
 ds_read_b128 a[240:243], v0 offset:0
 s_waitcnt lgkmcnt(3)
 v_mfma_f32_32x32x16_bf16 v[176:191], a[244:247], v[108:111], v[176:191]
 s_mul_i32 s37, s52, 204800
 s_mul_i32 s3, s50, 2048
 s_add_u32 s37, s37, s3
 s_add_u32 s37, s37, 19038208
 s_add_u32 m0, s65, 49152
 s_nop 0
 buffer_load_dwordx4 v0, s[4:7], s37 offen sc1 lds
 ds_read_b128 a[244:247], v0 offset:1024
 s_waitcnt lgkmcnt(3)
 v_mfma_f32_32x32x16_bf16 v[192:207], a[248:251], v[108:111], v[192:207]
 ds_read_b128 a[248:251], v0 offset:4096
 s_waitcnt lgkmcnt(3)
 v_mfma_f32_32x32x16_bf16 v[208:223], a[252:255], v[108:111], v[208:223]
 ds_read_b128 a[252:255], v0 offset:5120
 s_waitcnt lgkmcnt(3)
 v_mfma_f32_32x32x16_bf16 v[160:175], a[240:243], v[112:115], v[160:175]
 s_waitcnt vmcnt(19)
 v_cmp_ne_u32 vcc, s55, v240
 s_cbranch_vccnz L33_spin
L34_got:
 s_add_u32 s32, s59, 32768
 buffer_load_dwordx4 v[240:243], v0, s[4:7], s32 offen sc1
 ds_read_b128 a[240:243], v0 offset:8192
 s_waitcnt lgkmcnt(3)
 v_mfma_f32_32x32x16_bf16 v[176:191], a[244:247], v[112:115], v[176:191]
 s_cmp_eq_u32 s50, 2
 s_cselect_b32 s3, 32768, 0
 s_add_u32 s37, s37, s3
 buffer_load_dwordx4 v0, s[4:7], s37 offen offset:1024 sc1 lds
 s_add_u32 s37, s37, 40960
 ds_read_b128 a[244:247], v0 offset:9216
 s_waitcnt lgkmcnt(3)
 v_mfma_f32_32x32x16_bf16 v[192:207], a[248:251], v[112:115], v[192:207]
 ds_read_b128 a[248:251], v0 offset:12288
 s_waitcnt lgkmcnt(3)
 v_mfma_f32_32x32x16_bf16 v[208:223], a[252:255], v[112:115], v[208:223]
 ds_read_b128 a[252:255], v0 offset:13312
 s_waitcnt lgkmcnt(3)
 v_mfma_f32_32x32x16_bf16 v[160:175], a[240:243], v[116:119], v[160:175]
 buffer_load_dwordx4 v[244:247], v0, s[4:7], s32 offen offset:1024 sc1
 s_waitcnt vmcnt(21)
 s_barrier
 ds_read_b128 a[240:243], v0 offset:2048
 s_waitcnt lgkmcnt(3)
 v_mfma_f32_32x32x16_bf16 v[176:191], a[244:247], v[116:119], v[176:191]
 s_mul_i32 s37, s52, 204800
 s_mul_i32 s3, s50, 10240
 s_add_u32 s37, s37, s3
 s_add_u32 s37, s37, 18878464
 s_add_u32 m0, s65, 51200
 s_nop 0
 buffer_load_dwordx4 v0, s[4:7], s37 offen sc1 lds
 ds_read_b128 a[244:247], v0 offset:3072
 s_waitcnt lgkmcnt(3)
 v_mfma_f32_32x32x16_bf16 v[192:207], a[248:251], v[116:119], v[192:207]
 ds_read_b128 a[248:251], v0 offset:6144
 s_waitcnt lgkmcnt(3)
 v_mfma_f32_32x32x16_bf16 v[208:223], a[252:255], v[116:119], v[208:223]
 ds_read_b128 a[252:255], v0 offset:7168
 s_waitcnt lgkmcnt(3)
 v_mfma_f32_32x32x16_bf16 v[160:175], a[240:243], v[120:123], v[160:175]
 buffer_load_dwordx4 v[248:251], v0, s[4:7], s32 offen offset:2048 sc1
 ds_read_b128 a[240:243], v0 offset:10240
 s_waitcnt lgkmcnt(3)
 v_mfma_f32_32x32x16_bf16 v[176:191], a[244:247], v[120:123], v[176:191]
 s_add_u32 s40, s37, 4096
 buffer_load_dwordx4 v0, s[4:7], s40 offen offset:1024 sc1 lds
 s_add_u32 s37, s37, 40960
 ds_read_b128 a[244:247], v0 offset:11264
 s_waitcnt lgkmcnt(3)
 v_mfma_f32_32x32x16_bf16 v[192:207], a[248:251], v[120:123], v[192:207]
 ds_read_b128 a[248:251], v0 offset:14336
 s_waitcnt lgkmcnt(3)
 v_mfma_f32_32x32x16_bf16 v[208:223], a[252:255], v[120:123], v[208:223]
 ds_read_b128 a[252:255], v0 offset:15360
 s_waitcnt vmcnt(23) lgkmcnt(3)
 v_mfma_f32_32x32x16_bf16 v[160:175], a[240:243], v[124:127], v[160:175]
 buffer_load_dwordx4 v[252:255], v0, s[4:7], s32 offen offset:3072 sc1
 s_waitcnt vmcnt(21)
 s_barrier
 ds_read_b128 a[240:243], v0 offset:16384
 s_waitcnt lgkmcnt(3)
 v_mfma_f32_32x32x16_bf16 v[176:191], a[244:247], v[124:127], v[176:191]
 s_add_u32 m0, s65, 0
 s_nop 0
 buffer_load_dwordx4 v0, s[4:7], s37 offen sc1 lds
 ds_read_b128 a[244:247], v0 offset:17408
 s_waitcnt lgkmcnt(3)
 v_mfma_f32_32x32x16_bf16 v[192:207], a[248:251], v[124:127], v[192:207]
 ds_read_b128 a[248:251], v0 offset:20480
 s_waitcnt lgkmcnt(3)
 v_mfma_f32_32x32x16_bf16 v[208:223], a[252:255], v[124:127], v[208:223]
 ds_read_b128 a[252:255], v0 offset:21504
 s_waitcnt lgkmcnt(3)
 v_mfma_f32_32x32x16_bf16 v[160:175], a[240:243], v[128:131], v[160:175]
 ds_read_b128 a[240:243], v0 offset:24576
 s_waitcnt lgkmcnt(3)
 v_mfma_f32_32x32x16_bf16 v[176:191], a[244:247], v[128:131], v[176:191]
 s_add_u32 s40, s37, 4096
 buffer_load_dwordx4 v0, s[4:7], s40 offen offset:1024 sc1 lds
 s_add_u32 s37, s37, 40960
 ds_read_b128 a[244:247], v0 offset:25600
 s_waitcnt lgkmcnt(3)
 v_mfma_f32_32x32x16_bf16 v[192:207], a[248:251], v[128:131], v[192:207]
 ds_read_b128 a[248:251], v0 offset:28672
 s_waitcnt lgkmcnt(3)
 v_mfma_f32_32x32x16_bf16 v[208:223], a[252:255], v[128:131], v[208:223]
 ds_read_b128 a[252:255], v0 offset:29696
 s_waitcnt vmcnt(22) lgkmcnt(3)
 v_mfma_f32_32x32x16_bf16 v[160:175], a[240:243], v[132:135], v[160:175]
 s_waitcnt vmcnt(19)
 s_barrier
 ds_read_b128 a[240:243], v0 offset:18432
 s_waitcnt lgkmcnt(3)
 v_mfma_f32_32x32x16_bf16 v[176:191], a[244:247], v[132:135], v[176:191]
 s_add_u32 m0, s65, 2048
 s_nop 0
 buffer_load_dwordx4 v0, s[4:7], s37 offen sc1 lds
 ds_read_b128 a[244:247], v0 offset:19456
 s_waitcnt lgkmcnt(3)
 v_mfma_f32_32x32x16_bf16 v[192:207], a[248:251], v[132:135], v[192:207]
 ds_read_b128 a[248:251], v0 offset:22528
 s_waitcnt lgkmcnt(3)
 v_mfma_f32_32x32x16_bf16 v[208:223], a[252:255], v[132:135], v[208:223]
 ds_read_b128 a[252:255], v0 offset:23552
 s_waitcnt lgkmcnt(3)
 v_mfma_f32_32x32x16_bf16 v[160:175], a[240:243], v[136:139], v[160:175]
 ds_read_b128 a[240:243], v0 offset:26624
 s_waitcnt lgkmcnt(3)
 v_mfma_f32_32x32x16_bf16 v[176:191], a[244:247], v[136:139], v[176:191]
 s_add_u32 s40, s37, 4096
 buffer_load_dwordx4 v0, s[4:7], s40 offen offset:1024 sc1 lds
 s_add_u32 s37, s37, 40960
 ds_read_b128 a[244:247], v0 offset:27648
 s_waitcnt lgkmcnt(3)
 v_mfma_f32_32x32x16_bf16 v[192:207], a[248:251], v[136:139], v[192:207]
 ds_read_b128 a[248:251], v0 offset:30720
 s_waitcnt lgkmcnt(3)
 v_mfma_f32_32x32x16_bf16 v[208:223], a[252:255], v[136:139], v[208:223]
 ds_read_b128 a[252:255], v0 offset:31744
 s_waitcnt vmcnt(20) lgkmcnt(3)
 v_mfma_f32_32x32x16_bf16 v[160:175], a[240:243], v[140:143], v[160:175]
 s_waitcnt vmcnt(17)
 s_barrier
 ds_read_b128 a[240:243], v0 offset:32768
 s_waitcnt lgkmcnt(3)
 v_mfma_f32_32x32x16_bf16 v[176:191], a[244:247], v[140:143], v[176:191]
 s_add_u32 m0, s65, 16384
 s_nop 0
 buffer_load_dwordx4 v0, s[4:7], s37 offen sc1 lds
 ds_read_b128 a[244:247], v0 offset:33792
 s_waitcnt lgkmcnt(3)
 v_mfma_f32_32x32x16_bf16 v[192:207], a[248:251], v[140:143], v[192:207]
 ds_read_b128 a[248:251], v0 offset:36864
 s_waitcnt lgkmcnt(3)
 v_mfma_f32_32x32x16_bf16 v[208:223], a[252:255], v[140:143], v[208:223]
 ds_read_b128 a[252:255], v0 offset:37888
 s_waitcnt lgkmcnt(3)
 v_mfma_f32_32x32x16_bf16 v[160:175], a[240:243], v[144:147], v[160:175]
 s_getpc_b64 s[30:31]
L_pc2:
 s_lshl2_add_u32 s3, s54, s50
 s_mul_i32 s3, s3, 384
 v_lshl_add_u32 v2, v0, 3, s3
 v_min_u32 v2, L_codeend-L_pc2-4, v2
 s_mov_b64 exec, 7
 global_load_dword v31, v2, s[30:31]
 s_mov_b64 exec, -1
 ds_read_b128 a[240:243], v0 offset:40960
 s_waitcnt lgkmcnt(3)
 v_mfma_f32_32x32x16_bf16 v[176:191], a[244:247], v[144:147], v[176:191]
 s_add_u32 s40, s37, 4096
 buffer_load_dwordx4 v0, s[4:7], s40 offen offset:1024 sc1 lds
 s_add_u32 s37, s37, 40960
 ds_read_b128 a[244:247], v0 offset:41984
 s_waitcnt lgkmcnt(3)
 v_mfma_f32_32x32x16_bf16 v[192:207], a[248:251], v[144:147], v[192:207]
 ds_read_b128 a[248:251], v0 offset:45056
 s_waitcnt vmcnt(9)
 v_add_f32 v240, v240, v248
 v_add_f32 v241, v241, v249
 s_waitcnt lgkmcnt(3)
 v_mfma_f32_32x32x16_bf16 v[208:223], a[252:255], v[144:147], v[208:223]
 ds_read_b128 a[252:255], v0 offset:46080
 v_add_f32 v242, v242, v250
 v_add_f32 v243, v243, v251
 s_waitcnt lgkmcnt(3)
 v_mfma_f32_32x32x16_bf16 v[160:175], a[240:243], v[148:151], v[160:175]
 s_barrier
 ds_read_b128 a[240:243], v0 offset:34816
 s_waitcnt vmcnt(7)
 v_add_f32 v244, v244, v252
 v_add_f32 v245, v245, v253
 s_waitcnt lgkmcnt(3)
 v_mfma_f32_32x32x16_bf16 v[176:191], a[244:247], v[148:151], v[176:191]
 s_mul_i32 s37, s52, 204800
 s_mul_i32 s3, s50, 2048
 s_add_u32 s37, s37, s3
 s_add_u32 s37, s37, 19043328
 s_cmp_lt_u32 s52, 6
 s_cselect_b32 s37, s37, 2146435072
 s_add_u32 m0, s65, 18432
 s_nop 0
 buffer_load_dwordx4 v0, s[4:7], s37 offen sc1 lds
 ds_read_b128 a[244:247], v0 offset:35840
 v_add_f32 v246, v246, v254
 v_add_f32 v247, v247, v255
 s_waitcnt lgkmcnt(3)
 v_mfma_f32_32x32x16_bf16 v[192:207], a[248:251], v[148:151], v[192:207]
 ds_read_b128 a[248:251], v0 offset:38912
 v_add_f32 v240, v240, v244
 v_add_f32 v241, v241, v245
 s_waitcnt lgkmcnt(3)
 v_mfma_f32_32x32x16_bf16 v[208:223], a[252:255], v[148:151], v[208:223]
 ds_read_b128 a[252:255], v0 offset:39936
 v_add_f32 v242, v242, v246
 v_add_f32 v243, v243, v247
 s_waitcnt lgkmcnt(3)
 v_mfma_f32_32x32x16_bf16 v[160:175], a[240:243], v[152:155], v[160:175]
 buffer_load_dwordx4 a[176:179], v0, s[4:7], s48 offen offset:2048 sc1
 ds_read_b128 a[240:243], v0 offset:43008
 v_add_f32 v240, v240, v242
 v_add_f32 v241, v241, v243
 s_waitcnt lgkmcnt(3)
 v_mfma_f32_32x32x16_bf16 v[176:191], a[244:247], v[152:155], v[176:191]
 buffer_load_dwordx4 v0, s[4:7], s37 offen offset:1024 sc1 lds
 s_add_u32 s37, s37, 8192
 ds_read_b128 a[244:247], v0 offset:44032
 v_add_f32 v240, v240, v241
 v_mov_b32 v241, v240
 s_waitcnt lgkmcnt(3)
 v_mfma_f32_32x32x16_bf16 v[192:207], a[248:251], v[152:155], v[192:207]
 buffer_load_dwordx4 a[180:183], v0, s[4:7], s49 offen offset:2048 sc1
 s_add_u32 s48, s48, 4096
 s_add_u32 s49, s49, 4096
 ds_read_b128 a[248:251], v0 offset:47104
 v_permlane32_swap_b32 v240, v241
 v_mul_f32 v240, 0xbb000000, v240
 s_waitcnt lgkmcnt(3)
 v_mfma_f32_32x32x16_bf16 v[208:223], a[252:255], v[152:155], v[208:223]
 ds_read_b128 a[252:255], v0 offset:48128
 v_mul_f32 v241, 0x3b000000, v241
 v_fma_f32 v241, -v240, v240, v241
 s_waitcnt lgkmcnt(3)
 v_mfma_f32_32x32x16_bf16 v[160:175], a[240:243], v[156:159], v[160:175]
 s_barrier
 v_add_u32 v29, 49152, v28
 ds_read2_b32 a[240:241], v29 offset0:0 offset1:32
 ds_read2_b32 a[242:243], v29 offset0:64 offset1:96
 v_max_f32 v241, 0, v241
 v_add_f32 v241, 0x3727c5ac, v241
 s_waitcnt lgkmcnt(4)
 v_mfma_f32_32x32x16_bf16 v[176:191], a[244:247], v[156:159], v[176:191]
 s_add_u32 m0, s65, 32768
 s_nop 0
 buffer_load_dwordx4 v0, s[4:7], s37 offen sc1 lds
 buffer_load_dwordx4 a[184:187], v0, s[4:7], s48 offen sc1
 v_add_u32 v29, 50176, v28
 ds_read2_b32 a[244:245], v29 offset0:0 offset1:32
 ds_read2_b32 a[246:247], v29 offset0:64 offset1:96
 v_rsq_f32 v3, v241
 v_cvt_pk_bf16_f32 v8, v240, v240
 s_waitcnt lgkmcnt(5)
 v_mfma_f32_32x32x16_bf16 v[192:207], a[248:251], v[156:159], v[192:207]
 v_add_u32 v29, 53248, v28
 ds_read2_b32 a[248:249], v29 offset0:0 offset1:32
 ds_read2_b32 a[250:251], v29 offset0:64 offset1:96
 v_mov_b32 v9, v8
 v_mov_b32 v10, v8
 s_waitcnt lgkmcnt(6)
 v_mfma_f32_32x32x16_bf16 v[208:223], a[252:255], v[156:159], v[208:223]
 v_add_u32 v29, 54272, v28
 ds_read2_b32 a[252:253], v29 offset0:0 offset1:32
 ds_read2_b32 a[254:255], v29 offset0:64 offset1:96
 v_mov_b32 v11, v8
 v_mul_f32 v3, v3, v3
 s_waitcnt lgkmcnt(6)
 v_mfma_f32_32x32x16_bf16 v[160:175], a[240:243], v[8:11], v[160:175]
 buffer_load_dwordx4 a[188:191], v0, s[4:7], s49 offen sc1
 v_add_u32 v29, 57344, v28
 ds_read2_b32 a[240:241], v29 offset0:0 offset1:32
 ds_read2_b32 a[242:243], v29 offset0:64 offset1:96
 s_waitcnt lgkmcnt(6)
 v_mfma_f32_32x32x16_bf16 v[176:191], a[244:247], v[8:11], v[176:191]
 buffer_load_dwordx4 v0, s[4:7], s37 offen offset:1024 sc1 lds
 s_add_u32 s37, s37, 8192
 v_add_u32 v29, 58368, v28
 ds_read2_b32 a[244:245], v29 offset0:0 offset1:32
 ds_read2_b32 a[246:247], v29 offset0:64 offset1:96
 s_waitcnt lgkmcnt(6)
 v_mfma_f32_32x32x16_bf16 v[192:207], a[248:251], v[8:11], v[192:207]
 s_barrier
 ds_read_b128 a[248:251], v0 offset:51200
 s_waitcnt lgkmcnt(5)
 v_mfma_f32_32x32x16_bf16 v[208:223], a[252:255], v[8:11], v[208:223]
 s_add_u32 m0, s65, 34816
 s_nop 0
 buffer_load_dwordx4 v0, s[4:7], s37 offen sc1 lds
 buffer_load_dwordx4 a[192:195], v0, s[4:7], s48 offen offset:2048 sc1
 ds_read_b128 a[252:255], v0 offset:52224
 s_waitcnt lgkmcnt(4)
 v_mfma_f32_32x32x16_bf16 v[224:239], a[240:243], v[8:11], 0
 ds_read_b128 a[240:243], v0 offset:55296
 s_waitcnt lgkmcnt(3)
 v_mfma_f32_32x32x16_bf16 v[240:255], a[244:247], v[8:11], 0
 buffer_load_dwordx4 v0, s[4:7], s37 offen offset:1024 sc1 lds
 s_add_u32 s37, s37, 8192
 ds_read_b128 a[244:247], v0 offset:56320
 v_mul_f32 v160, v3, v160
 v_mul_f32 v161, v3, v161
 v_mul_f32 v162, v3, v162
 v_mul_f32 v163, v3, v163
 v_mul_f32 v164, v3, v164
 s_waitcnt lgkmcnt(3)
 v_mfma_f32_32x32x16_bf16 v[224:239], a[248:251], v[32:35], v[224:239]
 buffer_load_dwordx4 a[196:199], v0, s[4:7], s49 offen offset:2048 sc1
 s_add_u32 s48, s48, 4096
 s_add_u32 s49, s49, 4096
 ds_read_b128 a[248:251], v0 offset:59392
 v_mul_f32 v165, v3, v165
 v_mul_f32 v166, v3, v166
 v_mul_f32 v167, v3, v167
 v_mul_f32 v160, v160, v168
 v_mul_f32 v161, v161, v169
 s_waitcnt lgkmcnt(3)
 v_mfma_f32_32x32x16_bf16 v[224:239], a[252:255], v[36:39], v[224:239]
 ds_read_b128 a[252:255], v0 offset:60416
 v_mul_f32 v162, v162, v170
 v_mul_f32 v163, v163, v171
 v_mul_f32 v164, v164, v172
 v_mul_f32 v165, v165, v173
 v_mul_f32 v166, v166, v174
 s_waitcnt lgkmcnt(3)
 v_mfma_f32_32x32x16_bf16 v[224:239], a[240:243], v[40:43], v[224:239]
 ds_read_b128 a[240:243], v0 offset:63488
 v_mul_f32 v167, v167, v175
 v_cvt_pk_bf16_f32 v160, v160, v161
 v_cvt_pk_bf16_f32 v161, v162, v163
 v_cvt_pk_bf16_f32 v162, v164, v165
 v_cvt_pk_bf16_f32 v163, v166, v167
 s_waitcnt lgkmcnt(3)
 v_mfma_f32_32x32x16_bf16 v[224:239], a[244:247], v[44:47], v[224:239]
 buffer_load_dwordx4 a[200:203], v0, s[4:7], s48 offen sc1
 ds_read_b128 a[244:247], v0 offset:64512
 buffer_store_dwordx4 v[160:163], v0, s[4:7], s33 offen sc1
 v_mul_f32 v176, v3, v176
 v_mul_f32 v177, v3, v177
 v_mul_f32 v178, v3, v178
 v_mul_f32 v179, v3, v179
 s_waitcnt lgkmcnt(3)
 v_mfma_f32_32x32x16_bf16 v[224:239], a[248:251], v[48:51], v[224:239]
 s_waitcnt vmcnt(19)
 s_barrier
 ds_read_b128 a[248:251], v0 offset:0
 v_mul_f32 v180, v3, v180
 v_mul_f32 v181, v3, v181
 v_mul_f32 v182, v3, v182
 v_mul_f32 v183, v3, v183
 v_mul_f32 v176, v176, v184
 s_waitcnt lgkmcnt(3)
 v_mfma_f32_32x32x16_bf16 v[224:239], a[252:255], v[52:55], v[224:239]
 s_add_u32 m0, s65, 49152
 s_nop 0
 buffer_load_dwordx4 v0, s[4:7], s37 offen sc1 lds
 ds_read_b128 a[252:255], v0 offset:1024
 v_mul_f32 v177, v177, v185
 v_mul_f32 v178, v178, v186
 v_mul_f32 v179, v179, v187
 v_mul_f32 v180, v180, v188
 v_mul_f32 v181, v181, v189
 s_waitcnt lgkmcnt(3)
 v_mfma_f32_32x32x16_bf16 v[224:239], a[240:243], v[56:59], v[224:239]
 buffer_load_dwordx4 a[204:207], v0, s[4:7], s49 offen sc1
 ds_read_b128 a[240:243], v0 offset:4096
 v_mul_f32 v182, v182, v190
 v_mul_f32 v183, v183, v191
 v_cvt_pk_bf16_f32 v176, v176, v177
 v_cvt_pk_bf16_f32 v177, v178, v179
 v_cvt_pk_bf16_f32 v178, v180, v181
 s_waitcnt lgkmcnt(3)
 v_mfma_f32_32x32x16_bf16 v[224:239], a[244:247], v[60:63], v[224:239]
 buffer_load_dwordx4 v0, s[4:7], s37 offen offset:1024 sc1 lds
 s_add_u32 s37, s37, 8192
 ds_read_b128 a[244:247], v0 offset:5120
 v_cvt_pk_bf16_f32 v179, v182, v183
 buffer_store_dwordx4 v[176:179], v0, s[4:7], s33 offen offset:1024 sc1
 v_mul_f32 v192, v3, v192
 v_mul_f32 v193, v3, v193
 v_mul_f32 v194, v3, v194
 s_waitcnt lgkmcnt(3)
 v_mfma_f32_32x32x16_bf16 v[224:239], a[248:251], v[64:67], v[224:239]
 ds_read_b128 a[248:251], v0 offset:8192
 v_mul_f32 v195, v3, v195
 v_mul_f32 v196, v3, v196
 v_mul_f32 v197, v3, v197
 v_mul_f32 v198, v3, v198
 v_mul_f32 v199, v3, v199
 s_waitcnt lgkmcnt(3)
 v_mfma_f32_32x32x16_bf16 v[224:239], a[252:255], v[68:71], v[224:239]
 buffer_load_dwordx4 a[208:211], v0, s[4:7], s48 offen offset:2048 sc1
 ds_read_b128 a[252:255], v0 offset:9216
 v_mul_f32 v192, v192, v200
 v_mul_f32 v193, v193, v201
 v_mul_f32 v194, v194, v202
 v_mul_f32 v195, v195, v203
 v_mul_f32 v196, v196, v204
 s_waitcnt lgkmcnt(3)
 v_mfma_f32_32x32x16_bf16 v[224:239], a[240:243], v[72:75], v[224:239]
 ds_read_b128 a[240:243], v0 offset:12288
 v_mul_f32 v197, v197, v205
 v_mul_f32 v198, v198, v206
 v_mul_f32 v199, v199, v207
 v_cvt_pk_bf16_f32 v192, v192, v193
 v_cvt_pk_bf16_f32 v193, v194, v195
 s_waitcnt lgkmcnt(3)
 v_mfma_f32_32x32x16_bf16 v[224:239], a[244:247], v[76:79], v[224:239]
 buffer_load_dwordx4 a[212:215], v0, s[4:7], s49 offen offset:2048 sc1
 s_add_u32 s48, s48, 4096
 s_add_u32 s49, s49, 4096
 ds_read_b128 a[244:247], v0 offset:13312
 v_cvt_pk_bf16_f32 v194, v196, v197
 v_cvt_pk_bf16_f32 v195, v198, v199
 buffer_store_dwordx4 v[192:195], v0, s[4:7], s33 offen offset:2048 sc1
 v_mul_f32 v208, v3, v208
 v_mul_f32 v209, v3, v209
 s_waitcnt lgkmcnt(3)
 v_mfma_f32_32x32x16_bf16 v[224:239], a[248:251], v[80:83], v[224:239]
 s_waitcnt vmcnt(24)
 s_barrier
 ds_read_b128 a[248:251], v0 offset:2048
 v_mul_f32 v210, v3, v210
 v_mul_f32 v211, v3, v211
 v_mul_f32 v212, v3, v212
 v_mul_f32 v213, v3, v213
 v_mul_f32 v214, v3, v214
 s_waitcnt lgkmcnt(3)
 v_mfma_f32_32x32x16_bf16 v[224:239], a[252:255], v[84:87], v[224:239]
 ds_read_b128 a[252:255], v0 offset:3072
 v_mul_f32 v215, v3, v215
 v_mul_f32 v208, v208, v216
 v_mul_f32 v209, v209, v217
 v_mul_f32 v210, v210, v218
 v_mul_f32 v211, v211, v219
 s_waitcnt lgkmcnt(3)
 v_mfma_f32_32x32x16_bf16 v[224:239], a[240:243], v[88:91], v[224:239]
 s_add_u32 s48, s41, 229376
 buffer_load_dwordx4 a[216:219], v0, s[4:7], s48 offen sc1
 ds_read_b128 a[240:243], v0 offset:6144
 v_mul_f32 v212, v212, v220
 v_mul_f32 v213, v213, v221
 v_mul_f32 v214, v214, v222
 v_mul_f32 v215, v215, v223
 v_cvt_pk_bf16_f32 v208, v208, v209
 s_waitcnt lgkmcnt(3)
 v_mfma_f32_32x32x16_bf16 v[224:239], a[244:247], v[92:95], v[224:239]
 ds_read_b128 a[244:247], v0 offset:7168
 v_cvt_pk_bf16_f32 v209, v210, v211
 v_cvt_pk_bf16_f32 v210, v212, v213
 v_cvt_pk_bf16_f32 v211, v214, v215
 buffer_store_dwordx4 v[208:211], v0, s[4:7], s33 offen offset:3072 sc1
 s_mul_i32 s3, s50, 20480
 s_add_u32 s3, s3, 4194304
 s_mul_i32 s44, s63, 90112
 s_add_u32 s42, s44, s3
 s_mul_i32 s44, s62, 90112
 s_add_u32 s43, s44, s3
 s_add_u32 s44, s44, 4276224
 s_waitcnt lgkmcnt(3)
 v_mfma_f32_32x32x16_bf16 v[224:239], a[248:251], v[96:99], v[224:239]
 ds_read_b128 a[248:251], v0 offset:10240
 s_waitcnt lgkmcnt(3)
 v_mfma_f32_32x32x16_bf16 v[224:239], a[252:255], v[100:103], v[224:239]
 buffer_load_dwordx4 a[220:223], v0, s[4:7], s48 offen offset:2048 sc1
 s_add_u32 s48, s48, 4096
 ds_read_b128 a[252:255], v0 offset:11264
 s_and_b32 s28, s62, 0xfffffffe
 s_lshl_b32 s28, s28, 11
 v_and_b32 v1, 0x200, v0
 v_lshlrev_b32 v1, 2, v1
 s_lshl4_add_u32 s28, s50, s28
 s_add_u32 s28, s28, 3408128
 v_bfe_u32 v2, v0, 2, 4
 v_add_u32 v1, v1, v2
 s_waitcnt lgkmcnt(3)
 v_mfma_f32_32x32x16_bf16 v[224:239], a[240:243], v[104:107], v[224:239]
 ds_read_b128 a[240:243], v0 offset:14336
 s_waitcnt lgkmcnt(3)
 v_mfma_f32_32x32x16_bf16 v[224:239], a[244:247], v[108:111], v[224:239]
 ds_read_b128 a[244:247], v0 offset:15360
 s_waitcnt lgkmcnt(3)
 v_mfma_f32_32x32x16_bf16 v[224:239], a[248:251], v[112:115], v[224:239]
 buffer_load_dwordx4 a[224:227], v0, s[4:7], s48 offen sc1
 s_waitcnt vmcnt(25)
 s_barrier
 ds_read_b128 a[248:251], v0 offset:16384
 s_waitcnt lgkmcnt(3)
 v_mfma_f32_32x32x16_bf16 v[224:239], a[252:255], v[116:119], v[224:239]
 ds_read_b128 a[252:255], v0 offset:17408
 s_waitcnt lgkmcnt(3)
 v_mfma_f32_32x32x16_bf16 v[224:239], a[240:243], v[120:123], v[224:239]
 ds_read_b128 a[240:243], v0 offset:20480
 s_waitcnt lgkmcnt(3)
 v_mfma_f32_32x32x16_bf16 v[224:239], a[244:247], v[124:127], v[224:239]
 buffer_load_dwordx4 a[228:231], v0, s[4:7], s48 offen offset:2048 sc1
 s_add_u32 s48, s48, 4096
 ds_read_b128 a[244:247], v0 offset:21504
 s_waitcnt lgkmcnt(3)
 v_mfma_f32_32x32x16_bf16 v[224:239], a[248:251], v[128:131], v[224:239]
 ds_read_b128 a[248:251], v0 offset:24576
 s_waitcnt lgkmcnt(3)
 v_mfma_f32_32x32x16_bf16 v[224:239], a[252:255], v[132:135], v[224:239]
 ds_read_b128 a[252:255], v0 offset:25600
 s_waitcnt lgkmcnt(3)
 v_mfma_f32_32x32x16_bf16 v[224:239], a[240:243], v[136:139], v[224:239]
 buffer_load_dwordx4 a[232:235], v0, s[4:7], s48 offen sc1
 ds_read_b128 a[240:243], v0 offset:28672
 s_waitcnt lgkmcnt(3)
 v_mfma_f32_32x32x16_bf16 v[224:239], a[244:247], v[140:143], v[224:239]
 ds_read_b128 a[244:247], v0 offset:29696
 s_waitcnt lgkmcnt(3)
 v_mfma_f32_32x32x16_bf16 v[224:239], a[248:251], v[144:147], v[224:239]
 s_waitcnt lgkmcnt(2)
 v_mfma_f32_32x32x16_bf16 v[224:239], a[252:255], v[148:151], v[224:239]
 buffer_load_dwordx4 a[236:239], v0, s[4:7], s48 offen offset:2048 sc1
 s_add_u32 s48, s48, 4096
 s_waitcnt lgkmcnt(1)
 v_mfma_f32_32x32x16_bf16 v[224:239], a[240:243], v[152:155], v[224:239]
 s_waitcnt lgkmcnt(0)
 v_mfma_f32_32x32x16_bf16 v[224:239], a[244:247], v[156:159], v[224:239]
 s_cmp_ge_u32 s52, 6
 s_cbranch_scc1 L35_five
 s_waitcnt vmcnt(25)
 s_barrier
 ds_read_b128 a[248:251], v0 offset:18432
 ds_read_b128 a[252:255], v0 offset:19456
 ds_read_b128 a[240:243], v0 offset:22528
 ds_read_b128 a[244:247], v0 offset:23552
 s_waitcnt lgkmcnt(3)
 v_mfma_f32_32x32x16_bf16 v[240:255], a[248:251], v[32:35], v[240:255]
 ds_read_b128 a[248:251], v0 offset:26624
 s_waitcnt lgkmcnt(3)
 v_mfma_f32_32x32x16_bf16 v[240:255], a[252:255], v[36:39], v[240:255]
 ds_read_b128 a[252:255], v0 offset:27648
 v_mul_f32 v224, v3, v224
 v_mul_f32 v225, v3, v225
 v_mul_f32 v226, v3, v226
 v_mul_f32 v227, v3, v227
 s_waitcnt lgkmcnt(3)
 v_mfma_f32_32x32x16_bf16 v[240:255], a[240:243], v[40:43], v[240:255]
 ds_read_b128 a[240:243], v0 offset:30720
 v_mul_f32 v228, v3, v228
 v_mul_f32 v229, v3, v229
 v_mul_f32 v230, v3, v230
 v_mul_f32 v231, v3, v231
 s_waitcnt lgkmcnt(3)
 v_mfma_f32_32x32x16_bf16 v[240:255], a[244:247], v[44:47], v[240:255]
 ds_read_b128 a[244:247], v0 offset:31744
 v_mul_f32 v224, v224, v232
 v_mul_f32 v225, v225, v233
 v_mul_f32 v226, v226, v234
 v_mul_f32 v227, v227, v235
 s_waitcnt lgkmcnt(3)
 v_mfma_f32_32x32x16_bf16 v[240:255], a[248:251], v[48:51], v[240:255]
 s_waitcnt vmcnt(20)
 s_barrier
 ds_read_b128 a[248:251], v0 offset:32768
 v_mul_f32 v228, v228, v236
 v_mul_f32 v229, v229, v237
 v_mul_f32 v230, v230, v238
 v_mul_f32 v231, v231, v239
 s_waitcnt lgkmcnt(3)
 v_mfma_f32_32x32x16_bf16 v[240:255], a[252:255], v[52:55], v[240:255]
 ds_read_b128 a[252:255], v0 offset:33792
 v_cvt_pk_bf16_f32 v224, v224, v225
 v_cvt_pk_bf16_f32 v225, v226, v227
 v_cvt_pk_bf16_f32 v226, v228, v229
 v_cvt_pk_bf16_f32 v227, v230, v231
 s_waitcnt lgkmcnt(3)
 v_mfma_f32_32x32x16_bf16 v[240:255], a[240:243], v[56:59], v[240:255]
 ds_read_b128 a[240:243], v0 offset:36864
 buffer_store_dwordx4 v[224:227], v0, s[4:7], s34 offen sc1
 s_waitcnt lgkmcnt(3)
 v_mfma_f32_32x32x16_bf16 v[240:255], a[244:247], v[60:63], v[240:255]
 ds_read_b128 a[244:247], v0 offset:37888
 s_waitcnt lgkmcnt(3)
 v_mfma_f32_32x32x16_bf16 v[240:255], a[248:251], v[64:67], v[240:255]
 ds_read_b128 a[248:251], v0 offset:40960
 s_waitcnt lgkmcnt(3)
 v_mfma_f32_32x32x16_bf16 v[240:255], a[252:255], v[68:71], v[240:255]
 ds_read_b128 a[252:255], v0 offset:41984
 s_waitcnt lgkmcnt(3)
 v_mfma_f32_32x32x16_bf16 v[240:255], a[240:243], v[72:75], v[240:255]
 ds_read_b128 a[240:243], v0 offset:45056
 s_waitcnt lgkmcnt(3)
 v_mfma_f32_32x32x16_bf16 v[240:255], a[244:247], v[76:79], v[240:255]
 ds_read_b128 a[244:247], v0 offset:46080
 s_waitcnt lgkmcnt(3)
 v_mfma_f32_32x32x16_bf16 v[240:255], a[248:251], v[80:83], v[240:255]
 s_waitcnt vmcnt(18)
 s_barrier
 ds_read_b128 a[248:251], v0 offset:34816
 s_waitcnt lgkmcnt(3)
 v_mfma_f32_32x32x16_bf16 v[240:255], a[252:255], v[84:87], v[240:255]
 ds_read_b128 a[252:255], v0 offset:35840
 s_waitcnt lgkmcnt(3)
 v_mfma_f32_32x32x16_bf16 v[240:255], a[240:243], v[88:91], v[240:255]
 ds_read_b128 a[240:243], v0 offset:38912
 s_waitcnt lgkmcnt(3)
 v_mfma_f32_32x32x16_bf16 v[240:255], a[244:247], v[92:95], v[240:255]
 ds_read_b128 a[244:247], v0 offset:39936
 s_waitcnt lgkmcnt(3)
 v_mfma_f32_32x32x16_bf16 v[240:255], a[248:251], v[96:99], v[240:255]
 ds_read_b128 a[248:251], v0 offset:43008
 s_waitcnt lgkmcnt(3)
 v_mfma_f32_32x32x16_bf16 v[240:255], a[252:255], v[100:103], v[240:255]
 ds_read_b128 a[252:255], v0 offset:44032
 s_waitcnt lgkmcnt(3)
 v_mfma_f32_32x32x16_bf16 v[240:255], a[240:243], v[104:107], v[240:255]
 ds_read_b128 a[240:243], v0 offset:47104
 v_mov_b32 v2, s55
 s_cmp_lg_u32 s68, 0
 s_mov_b64 exec, 1
 s_waitcnt vmcnt(6)
 s_cbranch_scc1 L41_rel
 buffer_store_dword v2, v0, s[4:7], s36 offen
L42_relb:
 s_mov_b64 exec, -1
 s_waitcnt lgkmcnt(3)
 v_mfma_f32_32x32x16_bf16 v[240:255], a[244:247], v[108:111], v[240:255]
 ds_read_b128 a[244:247], v0 offset:48128
 s_waitcnt lgkmcnt(3)
 v_mfma_f32_32x32x16_bf16 v[240:255], a[248:251], v[112:115], v[240:255]
 s_barrier
 ds_read_b128 a[248:251], v0 offset:49152
 s_waitcnt lgkmcnt(3)
 v_mfma_f32_32x32x16_bf16 v[240:255], a[252:255], v[116:119], v[240:255]
 ds_read_b128 a[252:255], v0 offset:50176
 s_waitcnt lgkmcnt(3)
 v_mfma_f32_32x32x16_bf16 v[240:255], a[240:243], v[120:123], v[240:255]
 ds_read_b128 a[240:243], v0 offset:53248
 s_waitcnt lgkmcnt(3)
 v_mfma_f32_32x32x16_bf16 v[240:255], a[244:247], v[124:127], v[240:255]
 ds_read_b128 a[244:247], v0 offset:54272
 s_waitcnt lgkmcnt(3)
 v_mfma_f32_32x32x16_bf16 v[240:255], a[248:251], v[128:131], v[240:255]
 ds_read_b128 a[248:251], v0 offset:57344
 s_waitcnt lgkmcnt(3)
 v_mfma_f32_32x32x16_bf16 v[240:255], a[252:255], v[132:135], v[240:255]
 ds_read_b128 a[252:255], v0 offset:58368
 s_waitcnt lgkmcnt(3)
 v_mfma_f32_32x32x16_bf16 v[240:255], a[240:243], v[136:139], v[240:255]
 ds_read_b128 a[240:243], v0 offset:61440
 s_waitcnt lgkmcnt(3)
 v_mfma_f32_32x32x16_bf16 v[240:255], a[244:247], v[140:143], v[240:255]
 ds_read_b128 a[244:247], v0 offset:62464
 buffer_load_dword v160, v1, s[4:7], s28 offen sc1
 s_waitcnt lgkmcnt(3)
 v_mfma_f32_32x32x16_bf16 v[240:255], a[248:251], v[144:147], v[240:255]
 s_waitcnt lgkmcnt(2)
 v_mfma_f32_32x32x16_bf16 v[240:255], a[252:255], v[148:151], v[240:255]
 s_waitcnt lgkmcnt(1)
 v_mfma_f32_32x32x16_bf16 v[240:255], a[240:243], v[152:155], v[240:255]
 s_waitcnt lgkmcnt(0)
 v_mfma_f32_32x32x16_bf16 v[240:255], a[244:247], v[156:159], v[240:255]
 s_nop 11
 v_pk_mul_f32 v[240:241], v[2:3], v[240:241] op_sel:[1,0]
 v_pk_mul_f32 v[242:243], v[2:3], v[242:243] op_sel:[1,0]
 v_pk_mul_f32 v[244:245], v[2:3], v[244:245] op_sel:[1,0]
 v_pk_mul_f32 v[246:247], v[2:3], v[246:247] op_sel:[1,0]
 v_pk_mul_f32 v[240:241], v[240:241], v[248:249]
 v_pk_mul_f32 v[242:243], v[242:243], v[250:251]
 v_pk_mul_f32 v[244:245], v[244:245], v[252:253]
 v_pk_mul_f32 v[246:247], v[246:247], v[254:255]
 v_cvt_pk_bf16_f32 v240, v240, v241
 v_cvt_pk_bf16_f32 v241, v242, v243
 v_cvt_pk_bf16_f32 v242, v244, v245
 v_cvt_pk_bf16_f32 v243, v246, v247
 v_mov_b32 v2, s55
 s_cmp_lg_u32 s68, 0
 s_mov_b64 exec, 1
 s_waitcnt vmcnt(2)
 s_cbranch_scc1 L43_rel
 buffer_store_dword v2, v0, s[4:7], s38 offen
L44_relb:
 s_mov_b64 exec, -1
 s_waitcnt vmcnt(1)
 buffer_store_dwordx4 v[240:243], v0, s[4:7], s35 offen sc1
 s_branch L45_gujoin2
L36_gujoin:
 s_waitcnt vmcnt(0)
L45_gujoin2:
 v_cmp_ne_u32 vcc, s55, v160
 s_cbranch_vccnz L46_spin
L47_got:
 buffer_load_dwordx4 v[160:163], v0, s[4:7], s42 offen sc1
 buffer_load_dwordx4 v[164:167], v0, s[4:7], s42 offen offset:1024 sc1
 buffer_load_dwordx4 v[168:171], v0, s[4:7], s42 offen offset:2048 sc1
 buffer_load_dwordx4 v[172:175], v0, s[4:7], s42 offen offset:3072 sc1
 s_add_u32 s46, s42, 4096
 buffer_load_dwordx4 v[176:179], v0, s[4:7], s46 offen offset:1024 sc1
 buffer_load_dwordx4 v[180:183], v0, s[4:7], s46 offen offset:2048 sc1
 buffer_load_dwordx4 v[184:187], v0, s[4:7], s46 offen offset:3072 sc1
 s_add_u32 s46, s42, 8192
 buffer_load_dwordx4 v[188:191], v0, s[4:7], s46 offen sc1
 buffer_load_dwordx4 v[192:195], v0, s[4:7], s46 offen offset:2048 sc1
 buffer_load_dwordx4 v[196:199], v0, s[4:7], s46 offen offset:3072 sc1
 s_add_u32 s46, s42, 12288
 buffer_load_dwordx4 v[200:203], v0, s[4:7], s46 offen sc1
 buffer_load_dwordx4 v[204:207], v0, s[4:7], s46 offen offset:1024 sc1
 s_waitcnt vmcnt(11)
 v_mfma_f32_32x32x16_bf16 v[32:47], a[56:59], v[160:163], 0
 s_xor_b32 s3, s65, 8192
 v_add_u32 v28, s3, v0
 s_xor_b32 s3, s65, 12288
 v_add_u32 v29, s3, v0
 buffer_load_dwordx4 v[208:211], v0, s[4:7], s46 offen offset:3072 sc1
 buffer_load_dword v3, v1, s[4:7], s28 offen offset:64 sc1
 v_mfma_f32_32x32x16_bf16 v[48:63], a[60:63], v[160:163], 0
 s_xor_b32 s3, s65, 4096
 v_add_u32 v30, s3, v0
 v_add_u32 v31, s65, v0
 s_mul_i32 s29, s62, 36864
 s_waitcnt vmcnt(12)
 v_mfma_f32_32x32x16_bf16 v[32:47], a[64:67], v[164:167], v[32:47]
 s_add_u32 s29, s29, 1048576
 s_lshl_b32 s31, s64, 11
 s_add_u32 s31, s31, s29
 s_lshr_b32 s30, s64, 2
 s_add_u32 s46, s42, 16384
 buffer_load_dwordx4 v[212:215], v0, s[4:7], s46 offen sc1
 v_mfma_f32_32x32x16_bf16 v[48:63], a[68:71], v[164:167], v[48:63]
 s_lshl_b32 s30, s30, 10
 s_add_u32 s29, s29, s30
 s_and_b32 s30, s64, 3
 s_lshl2_add_u32 s29, s30, s29
 s_waitcnt vmcnt(12)
 v_mfma_f32_32x32x16_bf16 v[32:47], a[72:75], v[168:171], v[32:47]
 s_add_u32 s29, s29, 32768
 s_lshl_b32 s30, s62, 11
 s_lshl2_add_u32 s30, s64, s30
 s_add_u32 s30, s30, 3408384
 buffer_load_dwordx4 v[216:219], v0, s[4:7], s46 offen offset:1024 sc1
 v_mfma_f32_32x32x16_bf16 v[48:63], a[76:79], v[168:171], v[48:63]
 v_bfe_u32 v8, v0, 2, 5
 v_min_u32 v8, 20, v8
 s_lshl_b32 s32, s62, 11
 s_add_u32 s32, s32, 3408256
 s_waitcnt vmcnt(12)
 v_mfma_f32_32x32x16_bf16 v[32:47], a[80:83], v[172:175], v[32:47]
 buffer_load_dwordx4 v[220:223], v0, s[4:7], s46 offen offset:2048 sc1
 v_mfma_f32_32x32x16_bf16 v[48:63], a[84:87], v[172:175], v[48:63]
 s_waitcnt vmcnt(12)
 v_mfma_f32_32x32x16_bf16 v[32:47], a[96:99], v[176:179], v[32:47]
 buffer_load_dwordx4 v[80:83], v0, s[4:7], s43 offen sc1
 v_mfma_f32_32x32x16_bf16 v[48:63], a[100:103], v[176:179], v[48:63]
 v_mov_b32 v2, s55
 s_cmp_lg_u32 s68, 0
 s_mov_b64 exec, 1
 s_cbranch_scc1 L48_rel
 buffer_store_dword v2, v0, s[4:7], s39 offen
L49_relb:
 s_mov_b64 exec, -1
 s_waitcnt vmcnt(13)
 v_mfma_f32_32x32x16_bf16 v[32:47], a[104:107], v[180:183], v[32:47]
 buffer_load_dwordx4 v[84:87], v0, s[4:7], s43 offen offset:1024 sc1
 v_mfma_f32_32x32x16_bf16 v[48:63], a[108:111], v[180:183], v[48:63]
 s_waitcnt vmcnt(13)
 v_mfma_f32_32x32x16_bf16 v[32:47], a[112:115], v[184:187], v[32:47]
 buffer_load_dwordx4 v[88:91], v0, s[4:7], s43 offen offset:2048 sc1
 v_mfma_f32_32x32x16_bf16 v[48:63], a[116:119], v[184:187], v[48:63]
 s_waitcnt vmcnt(13)
 v_mfma_f32_32x32x16_bf16 v[32:47], a[120:123], v[188:191], v[32:47]
 buffer_load_dwordx4 v[92:95], v0, s[4:7], s43 offen offset:3072 sc1
 v_mfma_f32_32x32x16_bf16 v[48:63], a[124:127], v[188:191], v[48:63]
 s_waitcnt vmcnt(13)
 v_mfma_f32_32x32x16_bf16 v[32:47], a[136:139], v[192:195], v[32:47]
 s_add_u32 s46, s43, 4096
 buffer_load_dwordx4 v[96:99], v0, s[4:7], s46 offen offset:1024 sc1
 v_mfma_f32_32x32x16_bf16 v[48:63], a[140:143], v[192:195], v[48:63]
 s_waitcnt vmcnt(13)
 v_mfma_f32_32x32x16_bf16 v[32:47], a[144:147], v[196:199], v[32:47]
 buffer_load_dwordx4 v[100:103], v0, s[4:7], s46 offen offset:2048 sc1
 v_mfma_f32_32x32x16_bf16 v[48:63], a[148:151], v[196:199], v[48:63]
 s_waitcnt vmcnt(13)
 v_mfma_f32_32x32x16_bf16 v[32:47], a[152:155], v[200:203], v[32:47]
 s_waitcnt vmcnt(10)
 v_cmp_ne_u32 vcc, s55, v3
 s_cbranch_vccnz L50_spin
L51_got:
 s_add_u32 s46, s42, 4096
 buffer_load_dwordx4 v[104:107], v0, s[4:7], s46 offen sc1
 v_mfma_f32_32x32x16_bf16 v[48:63], a[156:159], v[200:203], v[48:63]
 v_mfma_f32_32x32x16_bf16 v[32:47], a[160:163], v[204:207], v[32:47]
 s_add_u32 s46, s42, 8192
 buffer_load_dwordx4 v[108:111], v0, s[4:7], s46 offen offset:1024 sc1
 v_mfma_f32_32x32x16_bf16 v[48:63], a[164:167], v[204:207], v[48:63]
 v_mfma_f32_32x32x16_bf16 v[32:47], a[176:179], v[208:211], v[32:47]
 s_add_u32 s46, s42, 12288
 buffer_load_dwordx4 v[112:115], v0, s[4:7], s46 offen offset:2048 sc1
 v_mfma_f32_32x32x16_bf16 v[48:63], a[180:183], v[208:211], v[48:63]
 s_barrier
 s_waitcnt vmcnt(12)
 v_mfma_f32_32x32x16_bf16 v[32:47], a[184:187], v[212:215], v[32:47]
 s_add_u32 s46, s42, 16384
 buffer_load_dwordx4 v[116:119], v0, s[4:7], s46 offen offset:3072 sc1
 v_mfma_f32_32x32x16_bf16 v[48:63], a[188:191], v[212:215], v[48:63]
 s_waitcnt vmcnt(12)
 v_mfma_f32_32x32x16_bf16 v[32:47], a[192:195], v[216:219], v[32:47]
 s_add_u32 s46, s43, 4096
 buffer_load_dwordx4 v[120:123], v0, s[4:7], s46 offen offset:3072 sc1
 v_mfma_f32_32x32x16_bf16 v[48:63], a[196:199], v[216:219], v[48:63]
 s_waitcnt vmcnt(12)
 v_mfma_f32_32x32x16_bf16 v[32:47], a[200:203], v[220:223], v[32:47]
 s_add_u32 s46, s43, 8192
 buffer_load_dwordx4 v[124:127], v0, s[4:7], s46 offen sc1
 buffer_load_dword v3, v8, s[4:7], s32 offen sc1
 v_mfma_f32_32x32x16_bf16 v[48:63], a[204:207], v[220:223], v[48:63]
 s_waitcnt vmcnt(13)
 v_mfma_f32_32x32x16_bf16 v[64:79], a[60:63], v[80:83], 0
 buffer_load_dwordx4 v[128:131], v0, s[4:7], s46 offen offset:2048 sc1
 v_mfma_f32_32x32x16_bf16 v[12:27], a[56:59], v[80:83], v[12:27]
 s_waitcnt vmcnt(12)
 v_mfma_f32_32x32x16_bf16 v[64:79], a[68:71], v[84:87], v[64:79]
 buffer_load_dwordx4 v[132:135], v0, s[4:7], s46 offen offset:3072 sc1
 v_mfma_f32_32x32x16_bf16 v[12:27], a[64:67], v[84:87], v[12:27]
 s_waitcnt vmcnt(12)
 v_mfma_f32_32x32x16_bf16 v[64:79], a[76:79], v[88:91], v[64:79]
 s_add_u32 s46, s43, 12288
 buffer_load_dwordx4 v[136:139], v0, s[4:7], s46 offen sc1
 v_mfma_f32_32x32x16_bf16 v[12:27], a[72:75], v[88:91], v[12:27]
 s_waitcnt vmcnt(12)
 v_mfma_f32_32x32x16_bf16 v[64:79], a[84:87], v[92:95], v[64:79]
 buffer_load_dwordx4 v[140:143], v0, s[4:7], s46 offen offset:1024 sc1
 v_mfma_f32_32x32x16_bf16 v[12:27], a[80:83], v[92:95], v[12:27]
 s_waitcnt vmcnt(12)
 v_mfma_f32_32x32x16_bf16 v[64:79], a[100:103], v[96:99], v[64:79]
 buffer_load_dwordx4 v[144:147], v0, s[4:7], s46 offen offset:3072 sc1
 v_mfma_f32_32x32x16_bf16 v[12:27], a[96:99], v[96:99], v[12:27]
 s_waitcnt vmcnt(12)
 v_mfma_f32_32x32x16_bf16 v[64:79], a[108:111], v[100:103], v[64:79]
 s_add_u32 s46, s43, 16384
 buffer_load_dwordx4 v[148:151], v0, s[4:7], s46 offen sc1
 v_mfma_f32_32x32x16_bf16 v[12:27], a[104:107], v[100:103], v[12:27]
 s_waitcnt vmcnt(12)
 v_mfma_f32_32x32x16_bf16 v[32:47], a[88:91], v[104:107], v[32:47]
 buffer_load_dwordx4 v[152:155], v0, s[4:7], s46 offen offset:1024 sc1
 v_mfma_f32_32x32x16_bf16 v[48:63], a[92:95], v[104:107], v[48:63]
 s_waitcnt vmcnt(12)
 v_mfma_f32_32x32x16_bf16 v[32:47], a[128:131], v[108:111], v[32:47]
 buffer_load_dwordx4 v[156:159], v0, s[4:7], s46 offen offset:2048 sc1
 v_mfma_f32_32x32x16_bf16 v[48:63], a[132:135], v[108:111], v[48:63]
 s_waitcnt vmcnt(12)
 v_mfma_f32_32x32x16_bf16 v[32:47], a[168:171], v[112:115], v[32:47]
 s_add_u32 s46, s43, 4096
 buffer_load_dwordx4 v[224:227], v0, s[4:7], s46 offen sc1
 v_mfma_f32_32x32x16_bf16 v[48:63], a[172:175], v[112:115], v[48:63]
 s_waitcnt vmcnt(12)
 v_mfma_f32_32x32x16_bf16 v[32:47], a[208:211], v[116:119], v[32:47]
 s_add_u32 s46, s43, 8192
 buffer_load_dwordx4 v[228:231], v0, s[4:7], s46 offen offset:1024 sc1
 v_mfma_f32_32x32x16_bf16 v[48:63], a[212:215], v[116:119], v[48:63]
 s_waitcnt vmcnt(12)
 v_mfma_f32_32x32x16_bf16 v[64:79], a[116:119], v[120:123], v[64:79]
 s_add_u32 s46, s43, 12288
 buffer_load_dwordx4 v[232:235], v0, s[4:7], s46 offen offset:2048 sc1
 v_mfma_f32_32x32x16_bf16 v[12:27], a[112:115], v[120:123], v[12:27]
 s_waitcnt vmcnt(12)
 v_mfma_f32_32x32x16_bf16 v[64:79], a[124:127], v[124:127], v[64:79]
 s_add_u32 s46, s43, 16384
 buffer_load_dwordx4 v[236:239], v0, s[4:7], s46 offen offset:3072 sc1
 v_mfma_f32_32x32x16_bf16 v[12:27], a[120:123], v[124:127], v[12:27]
 ds_write_b128 v28, v[32:35] offset:0
 s_waitcnt vmcnt(11)
 v_mfma_f32_32x32x16_bf16 v[64:79], a[140:143], v[128:131], v[64:79]
 v_cmp_ne_u32 vcc, s55, v3
 s_cbranch_vccnz L52_spin
L53_got:
 buffer_load_dwordx4 v[240:243], v0, s[4:7], s44 offen sc1
 v_mfma_f32_32x32x16_bf16 v[12:27], a[136:139], v[128:131], v[12:27]
 ds_write_b128 v28, v[36:39] offset:1024
 s_waitcnt vmcnt(11)
 v_mfma_f32_32x32x16_bf16 v[64:79], a[148:151], v[132:135], v[64:79]
 buffer_load_dwordx4 v[244:247], v0, s[4:7], s44 offen offset:1024 sc1
 v_mfma_f32_32x32x16_bf16 v[12:27], a[144:147], v[132:135], v[12:27]
 ds_write_b128 v28, v[40:43] offset:2048
 s_waitcnt vmcnt(11)
 v_mfma_f32_32x32x16_bf16 v[64:79], a[156:159], v[136:139], v[64:79]
 buffer_load_dwordx4 v[248:251], v0, s[4:7], s44 offen offset:2048 sc1
 v_mfma_f32_32x32x16_bf16 v[12:27], a[152:155], v[136:139], v[12:27]
 ds_write_b128 v28, v[44:47] offset:3072
 s_waitcnt vmcnt(11)
 v_mfma_f32_32x32x16_bf16 v[64:79], a[164:167], v[140:143], v[64:79]
 buffer_load_dwordx4 v[252:255], v0, s[4:7], s44 offen offset:3072 sc1
 v_mfma_f32_32x32x16_bf16 v[12:27], a[160:163], v[140:143], v[12:27]
 ds_write_b128 v29, v[48:51] offset:16384
 s_waitcnt vmcnt(11)
 v_mfma_f32_32x32x16_bf16 v[64:79], a[180:183], v[144:147], v[64:79]
 s_add_u32 s46, s44, 4096
 buffer_load_dwordx4 v[160:163], v0, s[4:7], s46 offen sc1
 v_mfma_f32_32x32x16_bf16 v[12:27], a[176:179], v[144:147], v[12:27]
 ds_write_b128 v29, v[52:55] offset:17408
 s_waitcnt vmcnt(11)
 v_mfma_f32_32x32x16_bf16 v[64:79], a[188:191], v[148:151], v[64:79]
 buffer_load_dwordx4 v[164:167], v0, s[4:7], s46 offen offset:1024 sc1
 v_mfma_f32_32x32x16_bf16 v[12:27], a[184:187], v[148:151], v[12:27]
 ds_write_b128 v29, v[56:59] offset:18432
 s_waitcnt vmcnt(11)
 v_mfma_f32_32x32x16_bf16 v[64:79], a[196:199], v[152:155], v[64:79]
 v_mfma_f32_32x32x16_bf16 v[12:27], a[192:195], v[152:155], v[12:27]
 ds_write_b128 v29, v[60:63] offset:19456
 s_waitcnt vmcnt(10)
 v_mfma_f32_32x32x16_bf16 v[64:79], a[204:207], v[156:159], v[64:79]
 s_waitcnt vmcnt(9)
 v_mfma_f32_32x32x16_bf16 v[64:79], a[92:95], v[224:227], v[64:79]
 s_waitcnt lgkmcnt(0)
 s_barrier
 s_waitcnt vmcnt(8)
 v_mfma_f32_32x32x16_bf16 v[64:79], a[132:135], v[228:231], v[64:79]
 ds_read_b128 v[32:35], v31 offset:0
 ds_read_b128 v[48:51], v31 offset:16384
 s_waitcnt vmcnt(7)
 v_mfma_f32_32x32x16_bf16 v[64:79], a[172:175], v[232:235], v[64:79]
 ds_read_b128 v[36:39], v31 offset:1024
 ds_read_b128 v[52:55], v31 offset:17408
 s_waitcnt vmcnt(6)
 v_mfma_f32_32x32x16_bf16 v[64:79], a[212:215], v[236:239], v[64:79]
 ds_read_b128 v[40:43], v31 offset:2048
 ds_read_b128 v[56:59], v31 offset:18432
 ds_read_b128 v[44:47], v31 offset:3072
 ds_read_b128 v[60:63], v31 offset:19456
 v_mfma_f32_32x32x16_bf16 v[12:27], a[200:203], v[156:159], v[12:27]
 s_waitcnt lgkmcnt(6)
 v_add_f32 v32, v32, v48
 v_add_f32 v33, v33, v49
 v_add_f32 v34, v34, v50
 v_add_f32 v35, v35, v51
 s_waitcnt lgkmcnt(4)
 v_add_f32 v36, v36, v52
 v_add_f32 v37, v37, v53
 v_add_f32 v38, v38, v54
 v_add_f32 v39, v39, v55
 v_mfma_f32_32x32x16_bf16 v[12:27], a[88:91], v[224:227], v[12:27]
 s_waitcnt lgkmcnt(2)
 v_add_f32 v40, v40, v56
 v_add_f32 v41, v41, v57
 v_add_f32 v42, v42, v58
 v_add_f32 v43, v43, v59
 s_waitcnt lgkmcnt(0)
 v_add_f32 v44, v44, v60
 v_add_f32 v45, v45, v61
 v_add_f32 v46, v46, v62
 v_add_f32 v47, v47, v63
 v_mfma_f32_32x32x16_bf16 v[12:27], a[128:131], v[228:231], v[12:27]
 ds_write_b128 v30, v[64:67] offset:32768
 v_mfma_f32_32x32x16_bf16 v[12:27], a[168:171], v[232:235], v[12:27]
 ds_write_b128 v30, v[68:71] offset:33792
 v_mfma_f32_32x32x16_bf16 v[12:27], a[208:211], v[236:239], v[12:27]
 ds_write_b128 v30, v[72:75] offset:34816
 s_waitcnt vmcnt(5)
 v_mfma_f32_32x32x16_bf16 v[12:27], a[216:219], v[240:243], v[12:27]
 ds_write_b128 v30, v[76:79] offset:35840
 s_waitcnt vmcnt(4)
 v_mfma_f32_32x32x16_bf16 v[12:27], a[220:223], v[244:247], v[12:27]
 s_waitcnt vmcnt(3)
 v_mfma_f32_32x32x16_bf16 v[12:27], a[224:227], v[248:251], v[12:27]
 s_waitcnt vmcnt(2)
 v_mfma_f32_32x32x16_bf16 v[12:27], a[228:231], v[252:255], v[12:27]
 s_waitcnt lgkmcnt(0)
 s_barrier
 ds_read_b128 v[64:67], v31 offset:32768
 ds_read_b128 v[68:71], v31 offset:33792
 ds_read_b128 v[72:75], v31 offset:34816
 ds_read_b128 v[76:79], v31 offset:35840
 s_waitcnt vmcnt(1)
 v_mfma_f32_32x32x16_bf16 v[12:27], a[232:235], v[160:163], v[12:27]
 s_waitcnt vmcnt(0)
 v_mfma_f32_32x32x16_bf16 v[12:27], a[236:239], v[164:167], v[12:27]
 s_waitcnt lgkmcnt(3)
 v_pk_add_f32 v[32:33], v[32:33], v[64:65]
 v_pk_add_f32 v[34:35], v[34:35], v[66:67]
 s_waitcnt lgkmcnt(2)
 v_pk_add_f32 v[36:37], v[36:37], v[68:69]
 v_pk_add_f32 v[38:39], v[38:39], v[70:71]
 s_waitcnt lgkmcnt(1)
 v_pk_add_f32 v[40:41], v[40:41], v[72:73]
 v_pk_add_f32 v[42:43], v[42:43], v[74:75]
 s_waitcnt lgkmcnt(0)
 v_pk_add_f32 v[44:45], v[44:45], v[76:77]
 v_pk_add_f32 v[46:47], v[46:47], v[78:79]
 v_pk_add_f32 v[12:13], v[12:13], v[32:33]
 v_pk_add_f32 v[14:15], v[14:15], v[34:35]
 v_pk_add_f32 v[16:17], v[16:17], v[36:37]
 v_pk_add_f32 v[18:19], v[18:19], v[38:39]
 v_pk_add_f32 v[20:21], v[20:21], v[40:41]
 v_pk_add_f32 v[22:23], v[22:23], v[42:43]
 v_pk_add_f32 v[24:25], v[24:25], v[44:45]
 v_pk_add_f32 v[26:27], v[26:27], v[46:47]
 v_cvt_pk_bf16_f32 v32, v12, v13
 v_cvt_pk_bf16_f32 v33, v14, v15
 v_cvt_pk_bf16_f32 v34, v16, v17
 v_cvt_pk_bf16_f32 v35, v18, v19
 buffer_store_dwordx4 v[32:35], v0, s[4:7], s31 offen
 v_cvt_pk_bf16_f32 v36, v20, v21
 v_cvt_pk_bf16_f32 v37, v22, v23
 v_cvt_pk_bf16_f32 v38, v24, v25
 v_cvt_pk_bf16_f32 v39, v26, v27
 buffer_store_dwordx4 v[36:39], v0, s[4:7], s31 offen offset:1024
 v_pk_add_f32 v[40:41], v[12:13], v[14:15]
 v_pk_mul_f32 v[42:43], v[12:13], v[12:13]
 v_pk_fma_f32 v[42:43], v[14:15], v[14:15], v[42:43]
 v_pk_add_f32 v[40:41], v[40:41], v[16:17]
 v_pk_fma_f32 v[42:43], v[16:17], v[16:17], v[42:43]
 v_pk_add_f32 v[40:41], v[40:41], v[18:19]
 v_pk_fma_f32 v[42:43], v[18:19], v[18:19], v[42:43]
 v_pk_add_f32 v[40:41], v[40:41], v[20:21]
 v_pk_fma_f32 v[42:43], v[20:21], v[20:21], v[42:43]
 v_pk_add_f32 v[40:41], v[40:41], v[22:23]
 v_pk_fma_f32 v[42:43], v[22:23], v[22:23], v[42:43]
 v_pk_add_f32 v[40:41], v[40:41], v[24:25]
 v_pk_fma_f32 v[42:43], v[24:25], v[24:25], v[42:43]
 v_pk_add_f32 v[40:41], v[40:41], v[26:27]
 v_pk_fma_f32 v[42:43], v[26:27], v[26:27], v[42:43]
 v_add_f32 v40, v40, v41
 v_add_f32 v42, v42, v43
 v_bfe_u32 v1, v0, 2, 6
 s_add_u32 s28, s61, 512
 v_permlane32_swap_b32 v40, v42
 v_add_f32 v3, v40, v42
 v_mov_b32 v2, s55
 s_cmp_lg_u32 s68, 0
 s_mov_b64 exec, 1
 s_waitcnt vmcnt(0)
 s_cbranch_scc1 L54_rel
 buffer_store_dword v2, v0, s[4:7], s30 offen
L55_relb:
 s_mov_b64 exec, -1
 buffer_load_dword v30, v1, s[4:7], s28 offen sc1
 buffer_store_dword v3, v0, s[4:7], s29 offen
 s_add_u32 s33, s59, 32768
 v_bfe_u32 v28, v0, 6, 2
 v_lshrrev_b32 v2, 9, v0
 v_mad_u32_u24 v28, v2, 4, v28
 v_mul_u32_u24 v28, 64, v28
 v_bfe_u32 v2, v0, 8, 1
 v_mul_u32_u24 v2, 32, v2
 v_add_u32 v28, v28, v2
 v_bfe_u32 v2, v0, 4, 2
 v_lshl_add_u32 v28, v2, 3, v28
 v_add_u32 v28, 65536, v28
 v_add_u32 v29, 49152, v28
 ds_read_b64_tr_b16 a[240:241], v28 offset:1024
 ds_read_b64_tr_b16 a[242:243], v28 offset:1536
 ds_read_b64_tr_b16 a[244:245], v28 offset:2048
 ds_read_b64_tr_b16 a[246:247], v28 offset:2560
 ds_read_b64_tr_b16 a[248:249], v28 offset:4096
 ds_read_b64_tr_b16 a[250:251], v28 offset:4608
 ds_read_b64_tr_b16 a[252:253], v28 offset:5120
 ds_read_b64_tr_b16 a[254:255], v28 offset:5632
L56_pt:
 s_waitcnt vmcnt(0)
 v_cmp_ne_u32 vcc, s55, v30
 s_cbranch_vccz L57_pd
 buffer_load_dword v30, v1, s[4:7], s28 offen sc1
 s_sub_u32 s57, s57, 1
 s_cbranch_scc0 L56_pt
 s_mov_b32 s57, 0
L57_pd:
 buffer_load_dwordx4 v[32:35], v0, s[4:7], s59 offen sc1
 buffer_load_dwordx4 v[36:39], v0, s[4:7], s59 offen offset:1024 sc1
 buffer_load_dwordx4 v[40:43], v0, s[4:7], s59 offen offset:2048 sc1
 buffer_load_dwordx4 v[44:47], v0, s[4:7], s59 offen offset:3072 sc1
 s_add_u32 s32, s59, 4096
 buffer_load_dwordx4 v[48:51], v0, s[4:7], s32 offen sc1
 s_add_u32 s30, s30, 64
 v_mov_b32 v2, s55
 s_cmp_lg_u32 s68, 0
 s_mov_b64 exec, 1
 s_cbranch_scc1 L58_rel
 buffer_store_dword v2, v0, s[4:7], s30 offen
L59_relb:
 s_mov_b64 exec, -1
 buffer_load_dwordx4 v[52:55], v0, s[4:7], s32 offen offset:1024 sc1
 buffer_load_dwordx4 v[56:59], v0, s[4:7], s32 offen offset:2048 sc1
 buffer_load_dwordx4 v[60:63], v0, s[4:7], s32 offen offset:3072 sc1
 s_add_u32 s32, s59, 8192
 buffer_load_dwordx4 v[64:67], v0, s[4:7], s32 offen sc1
 s_waitcnt vmcnt(9) lgkmcnt(6)
 v_mfma_f32_32x32x16_bf16 v[160:175], a[240:243], v[32:35], 0
 buffer_load_dwordx4 v[68:71], v0, s[4:7], s32 offen offset:1024 sc1
 ds_read_b64_tr_b16 a[240:241], v28 offset:7168
 ds_read_b64_tr_b16 a[242:243], v28 offset:7680
 v_bfe_u32 v223, v0, 4, 5
 v_lshrrev_b32 v239, 9, v0
 s_waitcnt lgkmcnt(6)
 v_mfma_f32_32x32x16_bf16 v[176:191], v[32:35], a[244:247], 0
 ds_read_b64_tr_b16 a[244:245], v28 offset:8192
 ds_read_b64_tr_b16 a[246:247], v28 offset:8704
 v_lshlrev_b32 v239, 2, v239
 v_sub_u32 v223, v223, v239
 s_waitcnt vmcnt(9) lgkmcnt(6)
 v_mfma_f32_32x32x16_bf16 v[160:175], a[248:251], v[36:39], v[160:175]
 buffer_load_dwordx4 v[72:75], v0, s[4:7], s32 offen offset:2048 sc1
 ds_read_b64_tr_b16 a[248:249], v28 offset:10240
 ds_read_b64_tr_b16 a[250:251], v28 offset:10752
 v_mov_b32 v239, 0xf149f2ca
 v_cmp_le_i32 s[42:43], 0, v223
 s_waitcnt lgkmcnt(6)
 v_mfma_f32_32x32x16_bf16 v[176:191], v[36:39], a[252:255], v[176:191]
 ds_read_b64_tr_b16 a[252:253], v28 offset:11264
 ds_read_b64_tr_b16 a[254:255], v28 offset:11776
 v_cmp_le_i32 s[44:45], 1, v223
 v_cndmask_b32 v208, v239, 0, s[42:43]
 s_waitcnt vmcnt(9) lgkmcnt(6)
 v_mfma_f32_32x32x16_bf16 v[160:175], a[240:243], v[40:43], v[160:175]
 buffer_load_dwordx4 v[76:79], v0, s[4:7], s32 offen offset:3072 sc1
 ds_read_b64_tr_b16 a[240:241], v28 offset:13312
 ds_read_b64_tr_b16 a[242:243], v28 offset:13824
 v_cndmask_b32 v224, 0, v239, s[42:43]
 v_cmp_le_i32 s[46:47], 2, v223
 s_waitcnt lgkmcnt(6)
 v_mfma_f32_32x32x16_bf16 v[176:191], v[40:43], a[244:247], v[176:191]
 ds_read_b64_tr_b16 a[244:245], v28 offset:14336
 ds_read_b64_tr_b16 a[246:247], v28 offset:14848
 v_cndmask_b32 v209, v239, 0, s[44:45]
 v_cndmask_b32 v225, 0, v239, s[44:45]
 s_waitcnt vmcnt(9) lgkmcnt(6)
 v_mfma_f32_32x32x16_bf16 v[160:175], a[248:251], v[44:47], v[160:175]
 s_add_u32 s32, s59, 12288
 buffer_load_dwordx4 v[80:83], v0, s[4:7], s32 offen sc1
 buffer_load_dword v30, v1, s[4:7], s28 offen offset:64 sc1
 ds_read_b64_tr_b16 a[248:249], v28 offset:16384
 ds_read_b64_tr_b16 a[250:251], v28 offset:16896
 v_cmp_le_i32 s[42:43], 3, v223
 v_cndmask_b32 v210, v239, 0, s[46:47]
 s_waitcnt lgkmcnt(6)
 v_mfma_f32_32x32x16_bf16 v[176:191], v[44:47], a[252:255], v[176:191]
 ds_read_b64_tr_b16 a[252:253], v28 offset:17408
 ds_read_b64_tr_b16 a[254:255], v28 offset:17920
 v_cndmask_b32 v226, 0, v239, s[46:47]
 v_cmp_le_i32 s[44:45], 8, v223
 s_waitcnt vmcnt(10) lgkmcnt(6)
 v_mfma_f32_32x32x16_bf16 v[160:175], a[240:243], v[48:51], v[160:175]
 buffer_load_dwordx4 v[84:87], v0, s[4:7], s32 offen offset:1024 sc1
 ds_read_b64_tr_b16 a[240:241], v28 offset:19456
 ds_read_b64_tr_b16 a[242:243], v28 offset:19968
 v_cndmask_b32 v211, v239, 0, s[42:43]
 v_cndmask_b32 v227, 0, v239, s[42:43]
 s_waitcnt lgkmcnt(6)
 v_mfma_f32_32x32x16_bf16 v[176:191], v[48:51], a[244:247], v[176:191]
 ds_read_b64_tr_b16 a[244:245], v28 offset:20480
 ds_read_b64_tr_b16 a[246:247], v28 offset:20992
 v_cmp_le_i32 s[46:47], 9, v223
 v_cndmask_b32 v212, v239, 0, s[44:45]
 s_waitcnt vmcnt(9) lgkmcnt(6)
 v_mfma_f32_32x32x16_bf16 v[160:175], a[248:251], v[52:55], v[160:175]
 buffer_load_dwordx4 v[88:91], v0, s[4:7], s32 offen offset:2048 sc1
 ds_read_b64_tr_b16 a[248:249], v28 offset:22528
 ds_read_b64_tr_b16 a[250:251], v28 offset:23040
 v_cndmask_b32 v228, 0, v239, s[44:45]
 v_cmp_le_i32 s[42:43], 10, v223
 s_waitcnt lgkmcnt(6)
 v_mfma_f32_32x32x16_bf16 v[176:191], v[52:55], a[252:255], v[176:191]
 ds_read_b64_tr_b16 a[252:253], v28 offset:23552
 ds_read_b64_tr_b16 a[254:255], v28 offset:24064
 v_cndmask_b32 v213, v239, 0, s[46:47]
 v_cndmask_b32 v229, 0, v239, s[46:47]
 s_waitcnt vmcnt(9) lgkmcnt(6)
 v_mfma_f32_32x32x16_bf16 v[160:175], a[240:243], v[56:59], v[160:175]
 buffer_load_dwordx4 v[92:95], v0, s[4:7], s32 offen offset:3072 sc1
 ds_read_b64_tr_b16 a[240:241], v28 offset:25600
 ds_read_b64_tr_b16 a[242:243], v28 offset:26112
 v_cmp_le_i32 s[44:45], 11, v223
 v_cndmask_b32 v214, v239, 0, s[42:43]
 s_waitcnt lgkmcnt(6)
 v_mfma_f32_32x32x16_bf16 v[176:191], v[56:59], a[244:247], v[176:191]
 ds_read_b64_tr_b16 a[244:245], v28 offset:26624
 ds_read_b64_tr_b16 a[246:247], v28 offset:27136
 v_cndmask_b32 v230, 0, v239, s[42:43]
 v_cmp_le_i32 s[46:47], 16, v223
 s_waitcnt vmcnt(9) lgkmcnt(6)
 v_mfma_f32_32x32x16_bf16 v[160:175], a[248:251], v[60:63], v[160:175]
 s_add_u32 s32, s59, 16384
 buffer_load_dwordx4 v[96:99], v0, s[4:7], s32 offen sc1
 ds_read_b64_tr_b16 a[248:249], v28 offset:28672
 ds_read_b64_tr_b16 a[250:251], v28 offset:29184
 v_cndmask_b32 v215, v239, 0, s[44:45]
 v_cndmask_b32 v231, 0, v239, s[44:45]
 s_waitcnt lgkmcnt(6)
 v_mfma_f32_32x32x16_bf16 v[176:191], v[60:63], a[252:255], v[176:191]
 ds_read_b64_tr_b16 a[252:253], v28 offset:29696
 ds_read_b64_tr_b16 a[254:255], v28 offset:30208
 v_cmp_le_i32 s[42:43], 17, v223
 v_cndmask_b32 v216, v239, 0, s[46:47]
 s_waitcnt vmcnt(9) lgkmcnt(6)
 v_mfma_f32_32x32x16_bf16 v[160:175], a[240:243], v[64:67], v[160:175]
 buffer_load_dwordx4 v[100:103], v0, s[4:7], s32 offen offset:1024 sc1
 ds_read_b64_tr_b16 a[240:241], v28 offset:31744
 ds_read_b64_tr_b16 a[242:243], v28 offset:32256
 v_cndmask_b32 v232, 0, v239, s[46:47]
 v_cmp_le_i32 s[44:45], 18, v223
 s_waitcnt lgkmcnt(6)
 v_mfma_f32_32x32x16_bf16 v[176:191], v[64:67], a[244:247], v[176:191]
 ds_read_b64_tr_b16 a[244:245], v28 offset:32768
 ds_read_b64_tr_b16 a[246:247], v28 offset:33280
 v_cndmask_b32 v217, v239, 0, s[42:43]
 v_cndmask_b32 v233, 0, v239, s[42:43]
 s_waitcnt vmcnt(9) lgkmcnt(6)
 v_mfma_f32_32x32x16_bf16 v[160:175], a[248:251], v[68:71], v[160:175]
 s_waitcnt vmcnt(5)
 v_cmp_ne_u32 vcc, s55, v30
 s_cbranch_vccnz L60_spin
L61_got:
 buffer_load_dwordx4 v[240:243], v0, s[4:7], s33 offen sc1
 ds_read_b64_tr_b16 a[248:249], v28 offset:34816
 ds_read_b64_tr_b16 a[250:251], v28 offset:35328
 v_cmp_le_i32 s[46:47], 19, v223
 v_cndmask_b32 v218, v239, 0, s[44:45]
 s_waitcnt lgkmcnt(6)
 v_mfma_f32_32x32x16_bf16 v[176:191], v[68:71], a[252:255], v[176:191]
 ds_read_b64_tr_b16 a[252:253], v28 offset:35840
 ds_read_b64_tr_b16 a[254:255], v28 offset:36352
 v_cndmask_b32 v234, 0, v239, s[44:45]
 v_cmp_le_i32 s[42:43], 24, v223
 s_waitcnt lgkmcnt(6)
 v_mfma_f32_32x32x16_bf16 v[160:175], a[240:243], v[72:75], v[160:175]
 buffer_load_dwordx4 v[244:247], v0, s[4:7], s33 offen offset:1024 sc1
 ds_read_b64_tr_b16 a[240:241], v28 offset:37888
 ds_read_b64_tr_b16 a[242:243], v28 offset:38400
 v_cndmask_b32 v219, v239, 0, s[46:47]
 v_cndmask_b32 v235, 0, v239, s[46:47]
 s_waitcnt lgkmcnt(6)
 v_mfma_f32_32x32x16_bf16 v[176:191], v[72:75], a[244:247], v[176:191]
 ds_read_b64_tr_b16 a[244:245], v28 offset:38912
 ds_read_b64_tr_b16 a[246:247], v28 offset:39424
 v_cmp_le_i32 s[44:45], 25, v223
 v_cndmask_b32 v220, v239, 0, s[42:43]
 s_waitcnt lgkmcnt(6)
 v_mfma_f32_32x32x16_bf16 v[160:175], a[248:251], v[76:79], v[160:175]
 buffer_load_dwordx4 v[248:251], v0, s[4:7], s33 offen offset:2048 sc1
 ds_read_b64_tr_b16 a[248:249], v28 offset:40960
 ds_read_b64_tr_b16 a[250:251], v28 offset:41472
 v_cndmask_b32 v236, 0, v239, s[42:43]
 v_cmp_le_i32 s[46:47], 26, v223
 s_waitcnt lgkmcnt(6)
 v_mfma_f32_32x32x16_bf16 v[176:191], v[76:79], a[252:255], v[176:191]
 ds_read_b64_tr_b16 a[252:253], v28 offset:41984
 ds_read_b64_tr_b16 a[254:255], v28 offset:42496
 v_cndmask_b32 v221, v239, 0, s[44:45]
 v_cndmask_b32 v237, 0, v239, s[44:45]
 s_waitcnt lgkmcnt(6)
 v_mfma_f32_32x32x16_bf16 v[160:175], a[240:243], v[80:83], v[160:175]
 buffer_load_dwordx4 v[252:255], v0, s[4:7], s33 offen offset:3072 sc1
 ds_read_b64_tr_b16 a[240:241], v28 offset:44032
 ds_read_b64_tr_b16 a[242:243], v28 offset:44544
 v_cmp_le_i32 s[42:43], 27, v223
 v_cndmask_b32 v222, v239, 0, s[46:47]
 s_waitcnt lgkmcnt(6)
 v_mfma_f32_32x32x16_bf16 v[176:191], v[80:83], a[244:247], v[176:191]
 ds_read_b64_tr_b16 a[244:245], v28 offset:45056
 ds_read_b64_tr_b16 a[246:247], v28 offset:45568
 v_cndmask_b32 v238, 0, v239, s[46:47]
 v_cndmask_b32 v223, v239, 0, s[42:43]
 s_waitcnt vmcnt(8) lgkmcnt(6)
 v_mfma_f32_32x32x16_bf16 v[160:175], a[248:251], v[84:87], v[160:175]
 buffer_load_dwordx4 v[104:107], v0, s[4:7], s32 offen offset:2048 sc1
 ds_read_b64_tr_b16 a[248:249], v28 offset:47104
 ds_read_b64_tr_b16 a[250:251], v28 offset:47616
 v_cndmask_b32 v239, 0, v239, s[42:43]
 s_waitcnt lgkmcnt(6)
 v_mfma_f32_32x32x16_bf16 v[176:191], v[84:87], a[252:255], v[176:191]
 ds_read_b64_tr_b16 a[252:253], v28 offset:48128
 ds_read_b64_tr_b16 a[254:255], v28 offset:48640
 s_waitcnt vmcnt(8) lgkmcnt(6)
 v_mfma_f32_32x32x16_bf16 v[160:175], a[240:243], v[88:91], v[160:175]
 buffer_load_dwordx4 v[108:111], v0, s[4:7], s32 offen offset:3072 sc1
 ds_read_b64_tr_b16 a[240:241], v29 offset:1024
 ds_read_b64_tr_b16 a[242:243], v29 offset:1536
 s_waitcnt lgkmcnt(6)
 v_mfma_f32_32x32x16_bf16 v[176:191], v[88:91], a[244:247], v[176:191]
 ds_read_b64_tr_b16 a[244:245], v29 offset:2048
 ds_read_b64_tr_b16 a[246:247], v29 offset:2560
 s_waitcnt vmcnt(8) lgkmcnt(6)
 v_mfma_f32_32x32x16_bf16 v[160:175], a[248:251], v[92:95], v[160:175]
 s_add_u32 s32, s59, 20480
 buffer_load_dwordx4 v[112:115], v0, s[4:7], s32 offen sc1
 ds_read_b64_tr_b16 a[248:249], v29 offset:4096
 ds_read_b64_tr_b16 a[250:251], v29 offset:4608
 s_waitcnt lgkmcnt(6)
 v_mfma_f32_32x32x16_bf16 v[176:191], v[92:95], a[252:255], v[176:191]
 ds_read_b64_tr_b16 a[252:253], v29 offset:5120
 ds_read_b64_tr_b16 a[254:255], v29 offset:5632
 s_waitcnt vmcnt(8) lgkmcnt(6)
 v_mfma_f32_32x32x16_bf16 v[160:175], a[240:243], v[96:99], v[160:175]
 buffer_load_dwordx4 v[116:119], v0, s[4:7], s32 offen offset:1024 sc1
 ds_read_b64_tr_b16 a[240:241], v29 offset:7168
 ds_read_b64_tr_b16 a[242:243], v29 offset:7680
 s_waitcnt lgkmcnt(6)
 v_mfma_f32_32x32x16_bf16 v[176:191], v[96:99], a[244:247], v[176:191]
 ds_read_b64_tr_b16 a[244:245], v29 offset:8192
 ds_read_b64_tr_b16 a[246:247], v29 offset:8704
 s_waitcnt vmcnt(8) lgkmcnt(6)
 v_mfma_f32_32x32x16_bf16 v[160:175], a[248:251], v[100:103], v[160:175]
 buffer_load_dwordx4 v[120:123], v0, s[4:7], s32 offen offset:2048 sc1
 ds_read_b64_tr_b16 a[248:249], v29 offset:10240
 ds_read_b64_tr_b16 a[250:251], v29 offset:10752
 s_waitcnt lgkmcnt(6)
 v_mfma_f32_32x32x16_bf16 v[176:191], v[100:103], a[252:255], v[176:191]
 ds_read_b64_tr_b16 a[252:253], v29 offset:11264
 ds_read_b64_tr_b16 a[254:255], v29 offset:11776
 s_waitcnt vmcnt(4) lgkmcnt(6)
 v_mfma_f32_32x32x16_bf16 v[160:175], a[240:243], v[104:107], v[160:175]
 buffer_load_dwordx4 v[124:127], v0, s[4:7], s32 offen offset:3072 sc1
 ds_read_b64_tr_b16 a[240:241], v29 offset:13312
 ds_read_b64_tr_b16 a[242:243], v29 offset:13824
 s_waitcnt lgkmcnt(6)
 v_mfma_f32_32x32x16_bf16 v[176:191], v[104:107], a[244:247], v[176:191]
 ds_read_b64_tr_b16 a[244:245], v29 offset:14336
 ds_read_b64_tr_b16 a[246:247], v29 offset:14848
 s_waitcnt vmcnt(4) lgkmcnt(6)
 v_mfma_f32_32x32x16_bf16 v[160:175], a[248:251], v[108:111], v[160:175]
 s_add_u32 s32, s59, 24576
 buffer_load_dwordx4 v[128:131], v0, s[4:7], s32 offen sc1
 ds_read_b64_tr_b16 a[248:249], v29 offset:16384
 ds_read_b64_tr_b16 a[250:251], v29 offset:16896
 s_waitcnt lgkmcnt(6)
 v_mfma_f32_32x32x16_bf16 v[176:191], v[108:111], a[252:255], v[176:191]
 ds_read_b64_tr_b16 a[252:253], v29 offset:17408
 ds_read_b64_tr_b16 a[254:255], v29 offset:17920
 s_waitcnt vmcnt(4) lgkmcnt(6)
 v_mfma_f32_32x32x16_bf16 v[160:175], a[240:243], v[112:115], v[160:175]
 buffer_load_dwordx4 v[132:135], v0, s[4:7], s32 offen offset:1024 sc1
 ds_read_b64_tr_b16 a[240:241], v29 offset:19456
 ds_read_b64_tr_b16 a[242:243], v29 offset:19968
 v_add_f32 v240, v240, v248
 v_add_f32 v241, v241, v249
 s_waitcnt lgkmcnt(6)
 v_mfma_f32_32x32x16_bf16 v[176:191], v[112:115], a[244:247], v[176:191]
 ds_read_b64_tr_b16 a[244:245], v29 offset:20480
 ds_read_b64_tr_b16 a[246:247], v29 offset:20992
 v_add_f32 v242, v242, v250
 v_add_f32 v243, v243, v251
 s_waitcnt vmcnt(4) lgkmcnt(6)
 v_mfma_f32_32x32x16_bf16 v[160:175], a[248:251], v[116:119], v[160:175]
 buffer_load_dwordx4 v[136:139], v0, s[4:7], s32 offen offset:2048 sc1
 ds_read_b64_tr_b16 a[248:249], v29 offset:22528
 ds_read_b64_tr_b16 a[250:251], v29 offset:23040
 v_add_f32 v244, v244, v252
 v_add_f32 v245, v245, v253
 s_waitcnt lgkmcnt(6)
 v_mfma_f32_32x32x16_bf16 v[176:191], v[116:119], a[252:255], v[176:191]
 ds_read_b64_tr_b16 a[252:253], v29 offset:23552
 ds_read_b64_tr_b16 a[254:255], v29 offset:24064
 v_add_f32 v246, v246, v254
 v_add_f32 v247, v247, v255
 s_waitcnt vmcnt(4) lgkmcnt(6)
 v_mfma_f32_32x32x16_bf16 v[160:175], a[240:243], v[120:123], v[160:175]
 buffer_load_dwordx4 v[140:143], v0, s[4:7], s32 offen offset:3072 sc1
 ds_read_b64_tr_b16 a[240:241], v29 offset:25600
 ds_read_b64_tr_b16 a[242:243], v29 offset:26112
 v_add_f32 v240, v240, v244
 v_add_f32 v241, v241, v245
 s_waitcnt lgkmcnt(6)
 v_mfma_f32_32x32x16_bf16 v[176:191], v[120:123], a[244:247], v[176:191]
 ds_read_b64_tr_b16 a[244:245], v29 offset:26624
 ds_read_b64_tr_b16 a[246:247], v29 offset:27136
 v_add_f32 v242, v242, v246
 v_add_f32 v243, v243, v247
 s_waitcnt vmcnt(4) lgkmcnt(6)
 v_mfma_f32_32x32x16_bf16 v[160:175], a[248:251], v[124:127], v[160:175]
 s_add_u32 s32, s59, 28672
 buffer_load_dwordx4 v[144:147], v0, s[4:7], s32 offen sc1
 ds_read_b64_tr_b16 a[248:249], v29 offset:28672
 ds_read_b64_tr_b16 a[250:251], v29 offset:29184
 v_add_f32 v240, v240, v242
 v_add_f32 v241, v241, v243
 s_waitcnt lgkmcnt(6)
 v_mfma_f32_32x32x16_bf16 v[176:191], v[124:127], a[252:255], v[176:191]
 ds_read_b64_tr_b16 a[252:253], v29 offset:29696
 ds_read_b64_tr_b16 a[254:255], v29 offset:30208
 v_add_f32 v240, v240, v241
 v_mov_b32 v241, v240
 s_waitcnt vmcnt(4) lgkmcnt(6)
 v_mfma_f32_32x32x16_bf16 v[160:175], a[240:243], v[128:131], v[160:175]
 buffer_load_dwordx4 v[148:151], v0, s[4:7], s32 offen offset:1024 sc1
 ds_read_b64_tr_b16 a[240:241], v29 offset:31744
 ds_read_b64_tr_b16 a[242:243], v29 offset:32256
 v_permlane32_swap_b32 v240, v241
 v_mul_f32 v240, 0xbb000000, v240
 s_waitcnt lgkmcnt(6)
 v_mfma_f32_32x32x16_bf16 v[176:191], v[128:131], a[244:247], v[176:191]
 ds_read_b64_tr_b16 a[244:245], v29 offset:32768
 ds_read_b64_tr_b16 a[246:247], v29 offset:33280
 v_mul_f32 v241, 0x3b000000, v241
 v_fma_f32 v241, -v240, v240, v241
 s_waitcnt vmcnt(4) lgkmcnt(6)
 v_mfma_f32_32x32x16_bf16 v[160:175], a[248:251], v[132:135], v[160:175]
 buffer_load_dwordx4 v[152:155], v0, s[4:7], s32 offen offset:2048 sc1
 ds_read_b64_tr_b16 a[248:249], v29 offset:34816
 ds_read_b64_tr_b16 a[250:251], v29 offset:35328
 v_max_f32 v241, 0, v241
 v_add_f32 v241, 0x3727c5ac, v241
 s_waitcnt lgkmcnt(6)
 v_mfma_f32_32x32x16_bf16 v[176:191], v[132:135], a[252:255], v[176:191]
 ds_read_b64_tr_b16 a[252:253], v29 offset:35840
 ds_read_b64_tr_b16 a[254:255], v29 offset:36352
 v_rsq_f32 v3, v241
 v_cvt_pk_bf16_f32 v8, v240, v240
 s_waitcnt vmcnt(4) lgkmcnt(6)
 v_mfma_f32_32x32x16_bf16 v[160:175], a[240:243], v[136:139], v[160:175]
 buffer_load_dwordx4 v[156:159], v0, s[4:7], s32 offen offset:3072 sc1
 ds_read_b64_tr_b16 a[240:241], v29 offset:37888
 ds_read_b64_tr_b16 a[242:243], v29 offset:38400
 v_lshrrev_b32 v1, 2, v0
 v_add_u32 v1, s65, v1
 s_waitcnt lgkmcnt(6)
 v_mfma_f32_32x32x16_bf16 v[176:191], v[136:139], a[244:247], v[176:191]
 ds_read_b64_tr_b16 a[244:245], v29 offset:38912
 ds_read_b64_tr_b16 a[246:247], v29 offset:39424
 ds_write_b32 v1, v3 offset:49664
 v_lshrrev_b32 v1, 9, v0
 s_waitcnt vmcnt(4) lgkmcnt(7)
 v_mfma_f32_32x32x16_bf16 v[160:175], a[248:251], v[140:143], v[160:175]
 ds_read_b64_tr_b16 a[248:249], v29 offset:40960
 ds_read_b64_tr_b16 a[250:251], v29 offset:41472
 v_lshl_add_u32 v1, v1, 4, s65
 ds_read_b128 v[240:243], v1 offset:49664
 s_waitcnt lgkmcnt(8)
 v_mfma_f32_32x32x16_bf16 v[176:191], v[140:143], a[252:255], v[176:191]
 ds_read_b64_tr_b16 a[252:253], v29 offset:41984
 ds_read_b64_tr_b16 a[254:255], v29 offset:42496
 ds_read_b128 v[244:247], v1 offset:49696
 ds_read_b128 v[248:251], v1 offset:49728
 s_waitcnt vmcnt(3) lgkmcnt(10)
 v_mfma_f32_32x32x16_bf16 v[160:175], a[240:243], v[144:147], v[160:175]
 ds_read_b64_tr_b16 a[240:241], v29 offset:44032
 ds_read_b64_tr_b16 a[242:243], v29 offset:44544
 ds_read_b128 v[252:255], v1 offset:49760
 v_mov_b32 v9, 0
 s_waitcnt lgkmcnt(11)
 v_mfma_f32_32x32x16_bf16 v[176:191], v[144:147], a[244:247], v[176:191]
 ds_read_b64_tr_b16 a[244:245], v29 offset:45056
 ds_read_b64_tr_b16 a[246:247], v29 offset:45568
 v_mov_b32 v10, 0
 v_mov_b32 v11, 0
 s_waitcnt vmcnt(2) lgkmcnt(10)
 v_mfma_f32_32x32x16_bf16 v[160:175], a[248:251], v[148:151], v[160:175]
 ds_read_b64_tr_b16 a[248:249], v29 offset:47104
 ds_read_b64_tr_b16 a[250:251], v29 offset:47616
 s_waitcnt lgkmcnt(9)
 v_mfma_f32_32x32x16_bf16 v[176:191], v[148:151], a[252:255], v[176:191]
 ds_read_b64_tr_b16 a[252:253], v29 offset:48128
 ds_read_b64_tr_b16 a[254:255], v29 offset:48640
 s_waitcnt vmcnt(1) lgkmcnt(7)
 v_mfma_f32_32x32x16_bf16 v[160:175], a[240:243], v[152:155], v[160:175]
 s_waitcnt lgkmcnt(4)
 v_mfma_f32_32x32x16_bf16 v[176:191], v[152:155], a[244:247], v[176:191]
 s_waitcnt vmcnt(0) lgkmcnt(2)
 v_mfma_f32_32x32x16_bf16 v[160:175], a[248:251], v[156:159], v[160:175]
 s_waitcnt lgkmcnt(0)
 v_mfma_f32_32x32x16_bf16 v[176:191], v[156:159], a[252:255], v[176:191]
 v_mfma_f32_32x32x16_bf16 v[160:175], v[4:7], v[8:11], v[160:175]
 v_mov_b32 v9, v8
 v_mov_b32 v8, 0
 s_nop 1
 v_mfma_f32_32x32x16_bf16 v[176:191], v[8:11], v[4:7], v[176:191]
 ds_read_b64_tr_b16 a[240:241], v28 offset:0
 ds_read_b64_tr_b16 a[242:243], v28 offset:512
 ds_read_b64_tr_b16 a[244:245], v28 offset:3072
 ds_read_b64_tr_b16 a[246:247], v28 offset:3584
 ds_read_b64_tr_b16 a[248:249], v28 offset:6144
 ds_read_b64_tr_b16 a[250:251], v28 offset:6656
 ds_read_b64_tr_b16 a[252:253], v28 offset:9216
 ds_read_b64_tr_b16 a[254:255], v28 offset:9728
 s_waitcnt lgkmcnt(6)
 v_mfma_f32_32x32x16_bf16 v[192:207], a[240:243], v[32:35], 0
 ds_read_b64_tr_b16 a[240:241], v28 offset:12288
 ds_read_b64_tr_b16 a[242:243], v28 offset:12800
 v_mov_b32 v10, v9
 v_mov_b32 v11, v9
 v_mov_b32 v9, 0
 s_lshl_b32 s28, s52, 6
 s_add_u32 s28, s28, s58
 s_lshl_b32 s28, s28, 12
 s_add_u32 s28, s28, 14680064
 v_add_u32 v31, s65, v0
 v_pk_mul_f32 v[160:161], v[2:3], v[160:161] op_sel:[1,0]
 v_pk_mul_f32 v[162:163], v[2:3], v[162:163] op_sel:[1,0]
 v_pk_mul_f32 v[164:165], v[2:3], v[164:165] op_sel:[1,0]
 v_pk_mul_f32 v[166:167], v[2:3], v[166:167] op_sel:[1,0]
 v_cvt_pk_bf16_f32 v160, v160, v161
 v_cvt_pk_bf16_f32 v161, v162, v163
 v_cvt_pk_bf16_f32 v162, v164, v165
 v_cvt_pk_bf16_f32 v163, v166, v167
 buffer_store_dwordx4 v[160:163], v0, s[4:7], s28 offen sc1
 v_pk_mul_f32 v[168:169], v[2:3], v[168:169] op_sel:[1,0]
 v_pk_mul_f32 v[170:171], v[2:3], v[170:171] op_sel:[1,0]
 v_pk_mul_f32 v[172:173], v[2:3], v[172:173] op_sel:[1,0]
 s_waitcnt lgkmcnt(6)
 v_mfma_f32_32x32x16_bf16 v[192:207], a[244:247], v[36:39], v[192:207]
 ds_read_b64_tr_b16 a[244:245], v28 offset:15360
 ds_read_b64_tr_b16 a[246:247], v28 offset:15872
 v_pk_mul_f32 v[174:175], v[2:3], v[174:175] op_sel:[1,0]
 v_cvt_pk_bf16_f32 v168, v168, v169
 v_cvt_pk_bf16_f32 v169, v170, v171
 v_cvt_pk_bf16_f32 v170, v172, v173
 v_cvt_pk_bf16_f32 v171, v174, v175
 buffer_store_dwordx4 v[168:171], v0, s[4:7], s28 offen offset:1024 sc1
 v_pk_mul_f32 v[176:177], v[240:241], v[176:177]
 v_pk_mul_f32 v[178:179], v[242:243], v[178:179]
 v_pk_mul_f32 v[180:181], v[244:245], v[180:181]
 v_pk_mul_f32 v[182:183], v[246:247], v[182:183]
 v_cvt_pk_bf16_f32 v176, v176, v177
 v_cvt_pk_bf16_f32 v177, v178, v179
 v_cvt_pk_bf16_f32 v178, v180, v181
 v_cvt_pk_bf16_f32 v179, v182, v183
 buffer_store_dwordx4 v[176:179], v0, s[4:7], s28 offen offset:2048 sc1
 v_pk_mul_f32 v[184:185], v[248:249], v[184:185]
 v_pk_mul_f32 v[186:187], v[250:251], v[186:187]
 v_pk_mul_f32 v[188:189], v[252:253], v[188:189]
 v_pk_mul_f32 v[190:191], v[254:255], v[190:191]
 v_cvt_pk_bf16_f32 v184, v184, v185
 s_waitcnt lgkmcnt(6)
 v_mfma_f32_32x32x16_bf16 v[192:207], a[248:251], v[40:43], v[192:207]
 ds_read_b64_tr_b16 a[248:249], v28 offset:18432
 ds_read_b64_tr_b16 a[250:251], v28 offset:18944
 v_cvt_pk_bf16_f32 v185, v186, v187
 v_cvt_pk_bf16_f32 v186, v188, v189
 v_cvt_pk_bf16_f32 v187, v190, v191
 buffer_store_dwordx4 v[184:187], v0, s[4:7], s28 offen offset:3072 sc1
 s_waitcnt lgkmcnt(6)
 v_mfma_f32_32x32x16_bf16 v[192:207], a[252:255], v[44:47], v[192:207]
 ds_read_b64_tr_b16 a[252:253], v28 offset:21504
 ds_read_b64_tr_b16 a[254:255], v28 offset:22016
 ds_write_b128 v31, v[160:163] offset:32768
 s_and_b32 s28, s50, 1
 s_lshl1_add_u32 s28, s52, s28
 s_waitcnt lgkmcnt(7)
 v_mfma_f32_32x32x16_bf16 v[192:207], a[240:243], v[48:51], v[192:207]
 ds_read_b64_tr_b16 a[240:241], v28 offset:24576
 ds_read_b64_tr_b16 a[242:243], v28 offset:25088
 s_lshl2_add_u32 s20, s51, s70
 s_mul_i32 s22, s20, 88
 s_add_u32 s22, s22, s28
 s_waitcnt lgkmcnt(7)
 v_mfma_f32_32x32x16_bf16 v[192:207], a[244:247], v[52:55], v[192:207]
 ds_read_b64_tr_b16 a[244:245], v28 offset:27648
 ds_read_b64_tr_b16 a[246:247], v28 offset:28160
 s_lshl_b32 s22, s22, 10
 ds_write_b128 v31, v[168:171] offset:33792
 s_add_u32 s22, s22, 4194304
 s_waitcnt lgkmcnt(8)
 v_mfma_f32_32x32x16_bf16 v[192:207], a[248:251], v[56:59], v[192:207]
 ds_read_b64_tr_b16 a[248:249], v28 offset:30720
 ds_read_b64_tr_b16 a[250:251], v28 offset:31232
 s_lshl_b32 s24, s20, 11
 s_lshl2_add_u32 s24, s28, s24
 s_add_u32 s24, s24, 3408896
 s_waitcnt lgkmcnt(8)
 v_mfma_f32_32x32x16_bf16 v[192:207], a[252:255], v[60:63], v[192:207]
 ds_read_b64_tr_b16 a[252:253], v28 offset:33792
 ds_read_b64_tr_b16 a[254:255], v28 offset:34304
 s_lshl2_add_u32 s21, s51, s71
 s_mul_i32 s23, s21, 88
 ds_write_b128 v31, v[176:179] offset:34816
 s_waitcnt lgkmcnt(8)
 v_mfma_f32_32x32x16_bf16 v[192:207], a[240:243], v[64:67], v[192:207]
 ds_read_b64_tr_b16 a[240:241], v28 offset:36864
 ds_read_b64_tr_b16 a[242:243], v28 offset:37376
 s_add_u32 s23, s23, s28
 s_lshl_b32 s23, s23, 10
 s_add_u32 s23, s23, 4194304
 s_waitcnt lgkmcnt(8)
 v_mfma_f32_32x32x16_bf16 v[192:207], a[244:247], v[68:71], v[192:207]
 ds_read_b64_tr_b16 a[244:245], v28 offset:39936
 ds_read_b64_tr_b16 a[246:247], v28 offset:40448
 s_lshl_b32 s25, s21, 11
 s_lshl2_add_u32 s25, s28, s25
 s_waitcnt lgkmcnt(7)
 v_mfma_f32_32x32x16_bf16 v[192:207], a[248:251], v[72:75], v[192:207]
 ds_read_b64_tr_b16 a[248:249], v28 offset:43008
 ds_read_b64_tr_b16 a[250:251], v28 offset:43520
 s_add_u32 s25, s25, 3408896
 ds_write_b128 v31, v[184:187] offset:35840
 s_waitcnt lgkmcnt(8)
 v_mfma_f32_32x32x16_bf16 v[192:207], a[252:255], v[76:79], v[192:207]
 ds_read_b64_tr_b16 a[252:253], v28 offset:46080
 ds_read_b64_tr_b16 a[254:255], v28 offset:46592
 s_and_b32 s26, s62, 0xfffffffe
 s_lshl_b32 s26, s26, 11
 s_waitcnt lgkmcnt(7)
 v_mfma_f32_32x32x16_bf16 v[192:207], a[240:243], v[80:83], v[192:207]
 ds_read_b64_tr_b16 a[240:241], v29 offset:0
 ds_read_b64_tr_b16 a[242:243], v29 offset:512
 v_and_b32 v166, 0x200, v0
 v_lshlrev_b32 v166, 2, v166
 s_waitcnt lgkmcnt(7)
 v_mfma_f32_32x32x16_bf16 v[192:207], a[244:247], v[84:87], v[192:207]
 ds_read_b64_tr_b16 a[244:245], v29 offset:3072
 ds_read_b64_tr_b16 a[246:247], v29 offset:3584
 s_lshl_b32 s3, s50, 5
 s_add_u32 s26, s26, s3
 s_waitcnt lgkmcnt(7)
 v_mfma_f32_32x32x16_bf16 v[192:207], a[248:251], v[88:91], v[192:207]
 ds_read_b64_tr_b16 a[248:249], v29 offset:6144
 ds_read_b64_tr_b16 a[250:251], v29 offset:6656
 s_add_u32 s26, s26, 3408896
 v_bfe_u32 v2, v0, 2, 5
 v_add_u32 v166, v166, v2
 s_waitcnt lgkmcnt(6)
 v_mfma_f32_32x32x16_bf16 v[192:207], a[252:255], v[92:95], v[192:207]
 ds_read_b64_tr_b16 a[252:253], v29 offset:9216
 ds_read_b64_tr_b16 a[254:255], v29 offset:9728
 s_mul_i32 s3, s50, 8192
 s_add_u32 s3, s3, 4194304
 s_waitcnt lgkmcnt(6)
 v_mfma_f32_32x32x16_bf16 v[192:207], a[240:243], v[96:99], v[192:207]
 ds_read_b64_tr_b16 a[240:241], v29 offset:12288
 ds_read_b64_tr_b16 a[242:243], v29 offset:12800
 s_mul_i32 s44, s63, 90112
 s_add_u32 s42, s44, s3
 s_waitcnt lgkmcnt(6)
 v_mfma_f32_32x32x16_bf16 v[192:207], a[244:247], v[100:103], v[192:207]
 ds_read_b64_tr_b16 a[244:245], v29 offset:15360
 ds_read_b64_tr_b16 a[246:247], v29 offset:15872
 s_mul_i32 s44, s62, 90112
 s_add_u32 s43, s44, s3
 s_waitcnt lgkmcnt(6)
 v_mfma_f32_32x32x16_bf16 v[192:207], a[248:251], v[104:107], v[192:207]
 ds_read_b64_tr_b16 a[248:249], v29 offset:18432
 ds_read_b64_tr_b16 a[250:251], v29 offset:18944
 s_lshl4_add_u32 s35, s58, s52
 s_lshl_b32 s35, s35, 7
 s_waitcnt lgkmcnt(6)
 v_mfma_f32_32x32x16_bf16 v[192:207], a[252:255], v[108:111], v[192:207]
 ds_read_b64_tr_b16 a[252:253], v29 offset:21504
 ds_read_b64_tr_b16 a[254:255], v29 offset:22016
 s_add_u32 s35, s35, 376832
 s_cmp_ge_u32 s51, 2
 s_cselect_b32 s3, 0, 8192
 s_waitcnt lgkmcnt(6)
 v_mfma_f32_32x32x16_bf16 v[192:207], a[240:243], v[112:115], v[192:207]
 ds_read_b64_tr_b16 a[240:241], v29 offset:24576
 ds_read_b64_tr_b16 a[242:243], v29 offset:25088
 v_and_b32 v30, 0x200, v0
 v_lshlrev_b32 v30, 4, v30
 s_waitcnt lgkmcnt(6)
 v_mfma_f32_32x32x16_bf16 v[192:207], a[244:247], v[116:119], v[192:207]
 ds_read_b64_tr_b16 a[244:245], v29 offset:27648
 ds_read_b64_tr_b16 a[246:247], v29 offset:28160
 v_or_b32 v30, s3, v30
 s_lshl_b32 s36, s52, 6
 s_waitcnt lgkmcnt(6)
 v_mfma_f32_32x32x16_bf16 v[192:207], a[248:251], v[120:123], v[192:207]
 ds_read_b64_tr_b16 a[248:249], v29 offset:30720
 ds_read_b64_tr_b16 a[250:251], v29 offset:31232
 s_lshl4_add_u32 s29, s58, s52
 s_lshl_b32 s29, s29, 7
 s_add_u32 s29, s29, 393216
 v_lshrrev_b32 v1, 2, v0
 v_mov_b32 v2, s55
 s_mov_b32 exec_hi, 0
 s_waitcnt vmcnt(0)
 buffer_store_dword v2, v1, s[4:7], s29 offen sc1
 s_mov_b32 exec_hi, -1
 s_add_u32 s36, s36, s58
 s_lshl_b32 s36, s36, 12
 s_waitcnt lgkmcnt(6)
 v_mfma_f32_32x32x16_bf16 v[192:207], a[252:255], v[124:127], v[192:207]
 ds_read_b64_tr_b16 a[252:253], v29 offset:33792
 ds_read_b64_tr_b16 a[254:255], v29 offset:34304
 s_add_u32 s36, s36, 14663680
 s_cmp_eq_u32 s51, 0
 s_cselect_b32 s35, 2146435072, s35
 s_cselect_b32 s36, 2146435072, s36
 s_waitcnt lgkmcnt(6)
 v_mfma_f32_32x32x16_bf16 v[192:207], a[240:243], v[128:131], v[192:207]
 ds_read_b64_tr_b16 a[240:241], v29 offset:36864
 ds_read_b64_tr_b16 a[242:243], v29 offset:37376
 v_mov_b32 v240, 0x3f803f80
 v_mov_b32 v241, 0x3f803f80
 s_waitcnt lgkmcnt(6)
 v_mfma_f32_32x32x16_bf16 v[192:207], a[244:247], v[132:135], v[192:207]
 ds_read_b64_tr_b16 a[244:245], v29 offset:39936
 ds_read_b64_tr_b16 a[246:247], v29 offset:40448
 v_mov_b32 v242, 0x3f803f80
 v_mov_b32 v243, 0x3f803f80
 s_waitcnt lgkmcnt(6)
 v_mfma_f32_32x32x16_bf16 v[192:207], a[248:251], v[136:139], v[192:207]
 ds_read_b64_tr_b16 a[248:249], v29 offset:43008
 ds_read_b64_tr_b16 a[250:251], v29 offset:43520
 v_mov_b32 v244, 0x3f803f80
 v_mov_b32 v245, 0x3f803f80
 s_waitcnt lgkmcnt(6)
 v_mfma_f32_32x32x16_bf16 v[192:207], a[252:255], v[140:143], v[192:207]
 ds_read_b64_tr_b16 a[252:253], v29 offset:46080
 ds_read_b64_tr_b16 a[254:255], v29 offset:46592
 v_mov_b32 v246, 0x3f803f80
 v_mov_b32 v247, 0x3f803f80
 s_waitcnt lgkmcnt(6)
 v_mfma_f32_32x32x16_bf16 v[192:207], a[240:243], v[144:147], v[192:207]
 v_mov_b32 v248, 0x3f803f80
 v_mov_b32 v249, 0x3f803f80
 s_waitcnt lgkmcnt(4)
 v_mfma_f32_32x32x16_bf16 v[192:207], a[244:247], v[148:151], v[192:207]
 v_mov_b32 v250, 0x3f803f80
 v_mov_b32 v251, 0x3f803f80
 s_waitcnt lgkmcnt(2)
 v_mfma_f32_32x32x16_bf16 v[192:207], a[248:251], v[152:155], v[192:207]
 v_mov_b32 v252, 0x3f803f80
 v_mov_b32 v253, 0x3f803f80
 s_waitcnt lgkmcnt(0)
 v_mfma_f32_32x32x16_bf16 v[192:207], a[252:255], v[156:159], v[192:207]
 v_mov_b32 v254, 0x3f803f80
 v_mov_b32 v255, 0x3f803f80
 v_mfma_f32_32x32x16_bf16 v[192:207], v[4:7], v[8:11], v[192:207]
 v_mul_f32 v3, 0x3eb8aa3b, v3
 s_and_b32 s28, s50, 1
 s_lshl_b32 s29, s28, 10
 s_lshl_b32 s28, s28, 8
 v_add_u32 v28, s29, v0
 v_add_u32 v29, s28, v0
 s_nop 5
 v_pk_mul_f32 v[192:193], v[2:3], v[192:193] op_sel:[1,0]
 v_pk_mul_f32 v[194:195], v[2:3], v[194:195] op_sel:[1,0]
 v_pk_mul_f32 v[196:197], v[2:3], v[196:197] op_sel:[1,0]
 v_pk_mul_f32 v[198:199], v[2:3], v[198:199] op_sel:[1,0]
 v_cvt_pk_bf16_f32 v192, v192, v193
 v_cvt_pk_bf16_f32 v193, v194, v195
 v_cvt_pk_bf16_f32 v194, v196, v197
 v_cvt_pk_bf16_f32 v195, v198, v199
 ds_write_b128 v31, v[192:195] offset:51200
 v_pk_mul_f32 v[200:201], v[2:3], v[200:201] op_sel:[1,0]
 v_pk_mul_f32 v[202:203], v[2:3], v[202:203] op_sel:[1,0]
 v_pk_mul_f32 v[204:205], v[2:3], v[204:205] op_sel:[1,0]
 v_pk_mul_f32 v[206:207], v[2:3], v[206:207] op_sel:[1,0]
 v_cvt_pk_bf16_f32 v200, v200, v201
 v_cvt_pk_bf16_f32 v201, v202, v203
 v_cvt_pk_bf16_f32 v202, v204, v205
 v_cvt_pk_bf16_f32 v203, v206, v207
 ds_write_b128 v31, v[200:203] offset:52224
 s_cmp_lg_u32 s70, 0
 s_waitcnt lgkmcnt(0)
 s_barrier
 s_cbranch_scc1 L62_p1
 ds_read_b128 v[104:107], v28 offset:32768
 ds_read_b128 v[108:111], v28 offset:36864
 s_mov_b64 exec, s[66:67]
 ds_read_b128 v[240:243], v29 offset:34816
 ds_read_b128 v[244:247], v29 offset:35840
 s_mov_b64 exec, -1
 ds_read_b128 v[112:115], v28 offset:51200
 ds_read_b128 v[116:119], v28 offset:63488
 buffer_load_dword v31, v30, s[4:7], s35 offen sc1
 s_waitcnt lgkmcnt(1)
 v_mfma_f32_32x32x16_bf16 v[32:47], v[104:107], v[112:115], v[208:223]
 s_waitcnt lgkmcnt(0)
 v_mfma_f32_32x32x16_bf16 v[48:63], v[104:107], v[116:119], 0
 ds_read_b128 v[104:107], v28 offset:40960
 s_nop 8
 v_exp_f32 v32, v32
 v_exp_f32 v33, v33
 s_mov_b64 exec, s[66:67]
 ds_read_b128 v[248:251], v29 offset:38912
 ds_read_b128 v[252:255], v29 offset:39936
 s_mov_b64 exec, -1
 v_exp_f32 v34, v34
 v_cvt_pk_bf16_f32 v96, v32, v33
 v_exp_f32 v35, v35
 v_exp_f32 v36, v36
 v_cvt_pk_bf16_f32 v97, v34, v35
 v_exp_f32 v37, v37
 v_exp_f32 v38, v38
 v_cvt_pk_bf16_f32 v98, v36, v37
 v_exp_f32 v39, v39
 v_exp_f32 v40, v40
 v_cvt_pk_bf16_f32 v99, v38, v39
 v_exp_f32 v41, v41
 v_exp_f32 v42, v42
 v_mfma_f32_32x32x16_bf16 v[64:79], v[240:243], v[96:99], 0
 v_cvt_pk_bf16_f32 v100, v40, v41
 v_exp_f32 v43, v43
 v_exp_f32 v44, v44
 v_cvt_pk_bf16_f32 v101, v42, v43
 v_exp_f32 v45, v45
 v_exp_f32 v46, v46
 v_exp_f32 v47, v47
 v_cvt_pk_bf16_f32 v102, v44, v45
 v_cvt_pk_bf16_f32 v103, v46, v47
 v_exp_f32 v48, v48
 v_exp_f32 v49, v49
 v_mfma_f32_32x32x16_bf16 v[64:79], v[244:247], v[100:103], v[64:79]
 v_exp_f32 v50, v50
 v_cvt_pk_bf16_f32 v96, v48, v49
 v_exp_f32 v51, v51
 v_exp_f32 v52, v52
 v_cvt_pk_bf16_f32 v97, v50, v51
 v_mfma_f32_32x32x16_bf16 v[32:47], v[108:111], v[116:119], 0
 ds_read_b128 v[108:111], v28 offset:45056
 v_exp_f32 v53, v53
 v_exp_f32 v54, v54
 v_cvt_pk_bf16_f32 v98, v52, v53
 v_exp_f32 v55, v55
 v_exp_f32 v56, v56
 v_cvt_pk_bf16_f32 v99, v54, v55
 v_exp_f32 v57, v57
 v_exp_f32 v58, v58
 v_mfma_f32_32x32x16_bf16 v[80:95], v[240:243], v[96:99], 0
 v_cvt_pk_bf16_f32 v100, v56, v57
 v_exp_f32 v59, v59
 v_exp_f32 v60, v60
 v_cvt_pk_bf16_f32 v101, v58, v59
 v_exp_f32 v61, v61
 v_exp_f32 v62, v62
 v_exp_f32 v63, v63
 v_cvt_pk_bf16_f32 v102, v60, v61
 v_cvt_pk_bf16_f32 v103, v62, v63
 v_exp_f32 v32, v32
 v_exp_f32 v33, v33
 v_mfma_f32_32x32x16_bf16 v[80:95], v[244:247], v[100:103], v[80:95]
 s_mov_b64 exec, s[66:67]
 ds_read_b128 v[240:243], v29 offset:43008
 ds_read_b128 v[244:247], v29 offset:44032
 s_mov_b64 exec, -1
 v_exp_f32 v34, v34
 v_cvt_pk_bf16_f32 v96, v32, v33
 v_exp_f32 v35, v35
 s_add_u32 m0, s65, 16384
 s_cmp_eq_u32 s51, 0
 s_waitcnt vmcnt(0)
 s_cbranch_scc1 L78_g0
 v_cmp_ne_u32 vcc, s55, v31
 s_cbranch_vccnz L79_spin
L80_got:
L78_g0:
 buffer_load_dwordx4 v0, s[4:7], s36 offen sc1 nt lds
 buffer_load_dwordx4 v0, s[4:7], s36 offen offset:1024 sc1 nt lds
 buffer_load_dwordx4 v0, s[4:7], s36 offen offset:2048 sc1 nt lds
 buffer_load_dwordx4 v0, s[4:7], s36 offen offset:3072 sc1 nt lds
 v_exp_f32 v36, v36
 v_cvt_pk_bf16_f32 v97, v34, v35
 s_waitcnt lgkmcnt(5)
 v_mfma_f32_32x32x16_bf16 v[48:63], v[104:107], v[116:119], 0
 v_exp_f32 v37, v37
 v_exp_f32 v38, v38
 v_cvt_pk_bf16_f32 v98, v36, v37
 v_exp_f32 v39, v39
 v_exp_f32 v40, v40
 v_cvt_pk_bf16_f32 v99, v38, v39
 v_exp_f32 v41, v41
 v_exp_f32 v42, v42
 s_waitcnt lgkmcnt(3)
 v_mfma_f32_32x32x16_bf16 v[80:95], v[248:251], v[96:99], v[80:95]
 v_cvt_pk_bf16_f32 v100, v40, v41
 v_exp_f32 v43, v43
 v_exp_f32 v44, v44
 v_cvt_pk_bf16_f32 v101, v42, v43
 v_exp_f32 v45, v45
 v_exp_f32 v46, v46
 v_exp_f32 v47, v47
 v_cvt_pk_bf16_f32 v102, v44, v45
 v_cvt_pk_bf16_f32 v103, v46, v47
 v_exp_f32 v48, v48
 v_exp_f32 v49, v49
 v_mfma_f32_32x32x16_bf16 v[80:95], v[252:255], v[100:103], v[80:95]
 s_mov_b64 exec, s[66:67]
 ds_read_b128 v[248:251], v29 offset:47104
 ds_read_b128 v[252:255], v29 offset:48128
 s_mov_b64 exec, -1
 v_exp_f32 v50, v50
 v_cvt_pk_bf16_f32 v96, v48, v49
 v_exp_f32 v51, v51
 v_exp_f32 v52, v52
 v_cvt_pk_bf16_f32 v97, v50, v51
 s_waitcnt lgkmcnt(4)
 v_mfma_f32_32x32x16_bf16 v[32:47], v[108:111], v[116:119], v[208:223]
 v_exp_f32 v53, v53
 v_exp_f32 v54, v54
 v_cvt_pk_bf16_f32 v98, v52, v53
 v_exp_f32 v55, v55
 v_exp_f32 v56, v56
 v_cvt_pk_bf16_f32 v99, v54, v55
 v_exp_f32 v57, v57
 v_exp_f32 v58, v58
 s_waitcnt lgkmcnt(2)
 v_mfma_f32_32x32x16_bf16 v[80:95], v[240:243], v[96:99], v[80:95]
 v_cvt_pk_bf16_f32 v100, v56, v57
 v_exp_f32 v59, v59
 v_exp_f32 v60, v60
 v_cvt_pk_bf16_f32 v101, v58, v59
 v_exp_f32 v61, v61
 v_exp_f32 v62, v62
 v_exp_f32 v63, v63
 v_cvt_pk_bf16_f32 v102, v60, v61
 v_cvt_pk_bf16_f32 v103, v62, v63
 v_exp_f32 v32, v32
 v_exp_f32 v33, v33
 v_mfma_f32_32x32x16_bf16 v[80:95], v[244:247], v[100:103], v[80:95]
 v_exp_f32 v34, v34
 v_cvt_pk_bf16_f32 v96, v32, v33
 v_exp_f32 v35, v35
 v_exp_f32 v36, v36
 v_cvt_pk_bf16_f32 v97, v34, v35
 v_exp_f32 v37, v37
 v_exp_f32 v38, v38
 v_cvt_pk_bf16_f32 v98, v36, v37
 v_exp_f32 v39, v39
 v_exp_f32 v40, v40
 v_cvt_pk_bf16_f32 v99, v38, v39
 v_exp_f32 v41, v41
 v_exp_f32 v42, v42
 s_waitcnt lgkmcnt(0)
 v_mfma_f32_32x32x16_bf16 v[80:95], v[248:251], v[96:99], v[80:95]
 v_cvt_pk_bf16_f32 v100, v40, v41
 v_exp_f32 v43, v43
 v_exp_f32 v44, v44
 v_cvt_pk_bf16_f32 v101, v42, v43
 v_exp_f32 v45, v45
 v_exp_f32 v46, v46
 v_exp_f32 v47, v47
 v_cvt_pk_bf16_f32 v102, v44, v45
 v_cvt_pk_bf16_f32 v103, v46, v47
 s_nop 1
 v_mfma_f32_32x32x16_bf16 v[80:95], v[252:255], v[100:103], v[80:95]
 s_sub_u32 s28, s36, 16384
 s_cmp_ge_u32 s51, 2
 s_cselect_b32 s28, s28, 2146435072
 s_add_u32 m0, s65, 0
 s_nop 0
 buffer_load_dwordx4 v0, s[4:7], s28 offen sc1 nt lds
 buffer_load_dwordx4 v0, s[4:7], s28 offen offset:1024 sc1 nt lds
 buffer_load_dwordx4 v0, s[4:7], s28 offen offset:2048 sc1 nt lds
 buffer_load_dwordx4 v0, s[4:7], s28 offen offset:3072 sc1 nt lds
 s_getpc_b64 s[30:31]
L_pc30:
 s_add_u32 s30, s30, L63_aepi-L_pc30
 s_addc_u32 s31, s31, 0
 s_lshl2_add_u32 s3, s54, s50
 s_mul_i32 s3, s3, 256
 v_lshl_add_u32 v2, v0, 3, s3
 v_min_u32 v2, L_codeend-L63_aepi-4, v2
 s_mov_b64 exec, 3
 global_load_dword v191, v2, s[30:31]
 s_mov_b64 exec, -1
 s_cmp_eq_u32 s51, 0
 s_cbranch_scc1 L81_x
 s_waitcnt vmcnt(5)
 s_barrier
 ds_read_b128 v[104:107], v28 offset:28672
 s_mov_b64 exec, s[66:67]
 ds_read_b128 v[240:243], v29 offset:30720
 ds_read_b128 v[244:247], v29 offset:31744
 s_mov_b64 exec, -1
 s_waitcnt lgkmcnt(2)
 v_mfma_f32_32x32x16_bf16 v[32:47], v[104:107], v[112:115], 0
 v_mfma_f32_32x32x16_bf16 v[48:63], v[104:107], v[116:119], 0
 s_nop 10
 v_exp_f32 v32, v32
 v_exp_f32 v33, v33
 v_exp_f32 v34, v34
 v_cvt_pk_bf16_f32 v96, v32, v33
 v_exp_f32 v35, v35
 s_lshl_b32 s28, s50, 14
 s_add_u32 s28, s28, s41
 s_add_u32 s28, s28, 14336
 s_xor_b32 s29, s28, 1024
 buffer_load_dwordx4 v[144:147], v0, s[4:7], s28 offen sc1
 buffer_load_dwordx4 v[148:151], v0, s[4:7], s29 offen sc1
 v_exp_f32 v36, v36
 v_cvt_pk_bf16_f32 v97, v34, v35
 v_exp_f32 v37, v37
 v_exp_f32 v38, v38
 v_cvt_pk_bf16_f32 v98, v36, v37
 v_exp_f32 v39, v39
 v_exp_f32 v40, v40
 v_cvt_pk_bf16_f32 v99, v38, v39
 s_mul_i32 s37, s52, 204800
 s_mul_i32 s3, s50, 0xffffec00
 s_add_u32 s37, s37, s3
 s_add_u32 s37, s37, 19033088
 s_add_u32 m0, s65, 65536
 s_nop 0
 buffer_load_dwordx4 v0, s[4:7], s37 offen sc1 lds
 v_exp_f32 v41, v41
 v_exp_f32 v42, v42
 s_waitcnt lgkmcnt(0)
 v_mfma_f32_32x32x16_bf16 v[64:79], v[240:243], v[96:99], v[64:79]
 v_cvt_pk_bf16_f32 v100, v40, v41
 v_exp_f32 v43, v43
 v_exp_f32 v44, v44
 v_cvt_pk_bf16_f32 v101, v42, v43
 v_exp_f32 v45, v45
 ds_read_b128 v[108:111], v28 offset:24576
 s_mov_b64 exec, s[66:67]
 ds_read_b128 v[248:251], v29 offset:26624
 ds_read_b128 v[252:255], v29 offset:27648
 s_mov_b64 exec, -1
 buffer_load_dwordx4 v0, s[4:7], s37 offen offset:1024 sc1 lds
 v_exp_f32 v46, v46
 v_exp_f32 v47, v47
 v_cvt_pk_bf16_f32 v102, v44, v45
 v_cvt_pk_bf16_f32 v103, v46, v47
 v_exp_f32 v48, v48
 v_exp_f32 v49, v49
 v_mfma_f32_32x32x16_bf16 v[64:79], v[244:247], v[100:103], v[64:79]
 v_exp_f32 v50, v50
 v_cvt_pk_bf16_f32 v96, v48, v49
 v_exp_f32 v51, v51
 buffer_load_dwordx4 v0, s[4:7], s37 offen offset:2048 sc1 lds
 v_exp_f32 v52, v52
 v_cvt_pk_bf16_f32 v97, v50, v51
 s_waitcnt lgkmcnt(0)
 v_mfma_f32_32x32x16_bf16 v[32:47], v[108:111], v[112:115], 0
 v_exp_f32 v53, v53
 v_exp_f32 v54, v54
 v_cvt_pk_bf16_f32 v98, v52, v53
 v_exp_f32 v55, v55
 v_exp_f32 v56, v56
 v_cvt_pk_bf16_f32 v99, v54, v55
 buffer_load_dwordx4 v0, s[4:7], s37 offen offset:3072 sc1 lds
 s_sub_u32 s37, s37, 20480
 v_exp_f32 v57, v57
 v_exp_f32 v58, v58
 v_mfma_f32_32x32x16_bf16 v[80:95], v[240:243], v[96:99], v[80:95]
 v_cvt_pk_bf16_f32 v100, v56, v57
 v_exp_f32 v59, v59
 v_exp_f32 v60, v60
 v_cvt_pk_bf16_f32 v101, v58, v59
 v_exp_f32 v61, v61
 v_exp_f32 v62, v62
 v_exp_f32 v63, v63
 v_cvt_pk_bf16_f32 v102, v60, v61
 v_cvt_pk_bf16_f32 v103, v62, v63
 v_exp_f32 v32, v32
 v_exp_f32 v33, v33
 v_mfma_f32_32x32x16_bf16 v[80:95], v[244:247], v[100:103], v[80:95]
 v_exp_f32 v34, v34
 v_cvt_pk_bf16_f32 v96, v32, v33
 v_exp_f32 v35, v35
 s_add_u32 m0, s65, 81920
 s_nop 0
 buffer_load_dwordx4 v0, s[4:7], s37 offen sc1 lds
 v_exp_f32 v36, v36
 v_cvt_pk_bf16_f32 v97, v34, v35
 v_mfma_f32_32x32x16_bf16 v[48:63], v[108:111], v[116:119], 0
 v_exp_f32 v37, v37
 v_exp_f32 v38, v38
 v_cvt_pk_bf16_f32 v98, v36, v37
 v_exp_f32 v39, v39
 v_exp_f32 v40, v40
 v_cvt_pk_bf16_f32 v99, v38, v39
 buffer_load_dwordx4 v0, s[4:7], s37 offen offset:1024 sc1 lds
 v_exp_f32 v41, v41
 v_exp_f32 v42, v42
 v_mfma_f32_32x32x16_bf16 v[64:79], v[248:251], v[96:99], v[64:79]
 v_cvt_pk_bf16_f32 v100, v40, v41
 v_exp_f32 v43, v43
 v_exp_f32 v44, v44
 v_cvt_pk_bf16_f32 v101, v42, v43
 v_exp_f32 v45, v45
 ds_read_b128 v[104:107], v28 offset:20480
 s_mov_b64 exec, s[66:67]
 ds_read_b128 v[240:243], v29 offset:22528
 ds_read_b128 v[244:247], v29 offset:23552
 s_mov_b64 exec, -1
 v_exp_f32 v46, v46
 v_exp_f32 v47, v47
 v_cvt_pk_bf16_f32 v102, v44, v45
 v_cvt_pk_bf16_f32 v103, v46, v47
 v_exp_f32 v48, v48
 v_exp_f32 v49, v49
 v_mfma_f32_32x32x16_bf16 v[64:79], v[252:255], v[100:103], v[64:79]
 v_exp_f32 v50, v50
 v_cvt_pk_bf16_f32 v96, v48, v49
 v_exp_f32 v51, v51
 buffer_load_dwordx4 v0, s[4:7], s37 offen offset:2048 sc1 lds
 v_exp_f32 v52, v52
 v_cvt_pk_bf16_f32 v97, v50, v51
 s_waitcnt lgkmcnt(0)
 v_mfma_f32_32x32x16_bf16 v[32:47], v[104:107], v[112:115], 0
 v_exp_f32 v53, v53
 v_exp_f32 v54, v54
 v_cvt_pk_bf16_f32 v98, v52, v53
 v_exp_f32 v55, v55
 v_exp_f32 v56, v56
 v_cvt_pk_bf16_f32 v99, v54, v55
 buffer_load_dwordx4 v0, s[4:7], s37 offen offset:3072 sc1 lds
 s_sub_u32 s37, s37, 20480
 v_exp_f32 v57, v57
 v_exp_f32 v58, v58
 v_mfma_f32_32x32x16_bf16 v[80:95], v[248:251], v[96:99], v[80:95]
 v_cvt_pk_bf16_f32 v100, v56, v57
 v_exp_f32 v59, v59
 v_exp_f32 v60, v60
 v_cvt_pk_bf16_f32 v101, v58, v59
 v_exp_f32 v61, v61
 v_exp_f32 v62, v62
 v_exp_f32 v63, v63
 v_cvt_pk_bf16_f32 v102, v60, v61
 v_cvt_pk_bf16_f32 v103, v62, v63
 v_exp_f32 v32, v32
 v_exp_f32 v33, v33
 v_mfma_f32_32x32x16_bf16 v[80:95], v[252:255], v[100:103], v[80:95]
 v_exp_f32 v34, v34
 v_cvt_pk_bf16_f32 v96, v32, v33
 v_exp_f32 v35, v35
 s_add_u32 m0, s65, 98304
 s_nop 0
 buffer_load_dwordx4 v0, s[4:7], s37 offen sc1 lds
 v_exp_f32 v36, v36
 v_cvt_pk_bf16_f32 v97, v34, v35
 v_mfma_f32_32x32x16_bf16 v[48:63], v[104:107], v[116:119], 0
 v_exp_f32 v37, v37
 v_exp_f32 v38, v38
 v_cvt_pk_bf16_f32 v98, v36, v37
 v_exp_f32 v39, v39
 v_exp_f32 v40, v40
 v_cvt_pk_bf16_f32 v99, v38, v39
 buffer_load_dwordx4 v0, s[4:7], s37 offen offset:1024 sc1 lds
 v_exp_f32 v41, v41
 v_exp_f32 v42, v42
 v_mfma_f32_32x32x16_bf16 v[64:79], v[240:243], v[96:99], v[64:79]
 v_cvt_pk_bf16_f32 v100, v40, v41
 v_exp_f32 v43, v43
 v_exp_f32 v44, v44
 v_cvt_pk_bf16_f32 v101, v42, v43
 v_exp_f32 v45, v45
 ds_read_b128 v[108:111], v28 offset:16384
 s_mov_b64 exec, s[66:67]
 ds_read_b128 v[248:251], v29 offset:18432
 ds_read_b128 v[252:255], v29 offset:19456
 s_mov_b64 exec, -1
 v_exp_f32 v46, v46
 v_exp_f32 v47, v47
 v_cvt_pk_bf16_f32 v102, v44, v45
 v_cvt_pk_bf16_f32 v103, v46, v47
 v_exp_f32 v48, v48
 v_exp_f32 v49, v49
 v_mfma_f32_32x32x16_bf16 v[64:79], v[244:247], v[100:103], v[64:79]
 v_exp_f32 v50, v50
 v_cvt_pk_bf16_f32 v96, v48, v49
 v_exp_f32 v51, v51
 buffer_load_dwordx4 v0, s[4:7], s37 offen offset:2048 sc1 lds
 v_exp_f32 v52, v52
 v_cvt_pk_bf16_f32 v97, v50, v51
 s_waitcnt lgkmcnt(0)
 v_mfma_f32_32x32x16_bf16 v[32:47], v[108:111], v[112:115], 0
 v_exp_f32 v53, v53
 v_exp_f32 v54, v54
 v_cvt_pk_bf16_f32 v98, v52, v53
 v_exp_f32 v55, v55
 v_exp_f32 v56, v56
 v_cvt_pk_bf16_f32 v99, v54, v55
 buffer_load_dwordx4 v0, s[4:7], s37 offen offset:3072 sc1 lds
 s_sub_u32 s37, s37, 20480
 v_exp_f32 v57, v57
 v_exp_f32 v58, v58
 v_mfma_f32_32x32x16_bf16 v[80:95], v[240:243], v[96:99], v[80:95]
 v_cvt_pk_bf16_f32 v100, v56, v57
 v_exp_f32 v59, v59
 v_exp_f32 v60, v60
 v_cvt_pk_bf16_f32 v101, v58, v59
 v_exp_f32 v61, v61
 v_exp_f32 v62, v62
 v_exp_f32 v63, v63
 v_cvt_pk_bf16_f32 v102, v60, v61
 v_cvt_pk_bf16_f32 v103, v62, v63
 v_exp_f32 v32, v32
 v_exp_f32 v33, v33
 v_mfma_f32_32x32x16_bf16 v[80:95], v[244:247], v[100:103], v[80:95]
 v_exp_f32 v34, v34
 v_cvt_pk_bf16_f32 v96, v32, v33
 v_exp_f32 v35, v35
 s_add_u32 m0, s65, 114688
 s_nop 0
 buffer_load_dwordx4 v0, s[4:7], s37 offen sc1 lds
 v_exp_f32 v36, v36
 v_cvt_pk_bf16_f32 v97, v34, v35
 v_mfma_f32_32x32x16_bf16 v[48:63], v[108:111], v[116:119], 0
 v_exp_f32 v37, v37
 v_exp_f32 v38, v38
 v_cvt_pk_bf16_f32 v98, v36, v37
 v_exp_f32 v39, v39
 v_exp_f32 v40, v40
 v_cvt_pk_bf16_f32 v99, v38, v39
 buffer_load_dwordx4 v0, s[4:7], s37 offen offset:1024 sc1 lds
 v_exp_f32 v41, v41
 v_exp_f32 v42, v42
 v_mfma_f32_32x32x16_bf16 v[64:79], v[248:251], v[96:99], v[64:79]
 v_cvt_pk_bf16_f32 v100, v40, v41
 v_exp_f32 v43, v43
 v_exp_f32 v44, v44
 v_cvt_pk_bf16_f32 v101, v42, v43
 v_exp_f32 v45, v45
 s_waitcnt vmcnt(17)
 s_barrier
 ds_read_b128 v[104:107], v28 offset:12288
 s_mov_b64 exec, s[66:67]
 ds_read_b128 v[240:243], v29 offset:14336
 ds_read_b128 v[244:247], v29 offset:15360
 s_mov_b64 exec, -1
 v_exp_f32 v46, v46
 v_exp_f32 v47, v47
 v_cvt_pk_bf16_f32 v102, v44, v45
 v_cvt_pk_bf16_f32 v103, v46, v47
 v_exp_f32 v48, v48
 v_exp_f32 v49, v49
 v_mfma_f32_32x32x16_bf16 v[64:79], v[252:255], v[100:103], v[64:79]
 v_exp_f32 v50, v50
 v_cvt_pk_bf16_f32 v96, v48, v49
 v_exp_f32 v51, v51
 buffer_load_dwordx4 v0, s[4:7], s37 offen offset:2048 sc1 lds
 v_exp_f32 v52, v52
 v_cvt_pk_bf16_f32 v97, v50, v51
 s_waitcnt lgkmcnt(0)
 v_mfma_f32_32x32x16_bf16 v[32:47], v[104:107], v[112:115], 0
 v_exp_f32 v53, v53
 v_exp_f32 v54, v54
 v_cvt_pk_bf16_f32 v98, v52, v53
 v_exp_f32 v55, v55
 v_exp_f32 v56, v56
 v_cvt_pk_bf16_f32 v99, v54, v55
 buffer_load_dwordx4 v0, s[4:7], s37 offen offset:3072 sc1 lds
 s_sub_u32 s37, s37, 20480
 v_exp_f32 v57, v57
 v_exp_f32 v58, v58
 v_mfma_f32_32x32x16_bf16 v[80:95], v[248:251], v[96:99], v[80:95]
 v_cvt_pk_bf16_f32 v100, v56, v57
 v_exp_f32 v59, v59
 v_exp_f32 v60, v60
 v_cvt_pk_bf16_f32 v101, v58, v59
 v_exp_f32 v61, v61
 v_exp_f32 v62, v62
 v_exp_f32 v63, v63
 v_cvt_pk_bf16_f32 v102, v60, v61
 v_cvt_pk_bf16_f32 v103, v62, v63
 s_cmp_eq_u32 s51, 1
 s_cbranch_scc1 L91_x
 v_exp_f32 v32, v32
 v_exp_f32 v33, v33
 v_mfma_f32_32x32x16_bf16 v[80:95], v[252:255], v[100:103], v[80:95]
 v_exp_f32 v34, v34
 v_cvt_pk_bf16_f32 v96, v32, v33
 v_exp_f32 v35, v35
 s_add_u32 m0, s65, 131072
 s_nop 0
 buffer_load_dwordx4 v0, s[4:7], s37 offen sc1 lds
 v_exp_f32 v36, v36
 v_cvt_pk_bf16_f32 v97, v34, v35
 v_mfma_f32_32x32x16_bf16 v[48:63], v[104:107], v[116:119], v[224:239]
 v_exp_f32 v37, v37
 v_exp_f32 v38, v38
 v_cvt_pk_bf16_f32 v98, v36, v37
 v_exp_f32 v39, v39
 v_exp_f32 v40, v40
 v_cvt_pk_bf16_f32 v99, v38, v39
 buffer_load_dwordx4 v0, s[4:7], s37 offen offset:1024 sc1 lds
 v_exp_f32 v41, v41
 v_exp_f32 v42, v42
 v_mfma_f32_32x32x16_bf16 v[64:79], v[240:243], v[96:99], v[64:79]
 v_cvt_pk_bf16_f32 v100, v40, v41
 v_exp_f32 v43, v43
 v_exp_f32 v44, v44
 v_cvt_pk_bf16_f32 v101, v42, v43
 v_exp_f32 v45, v45
 ds_read_b128 v[108:111], v28 offset:8192
 s_mov_b64 exec, s[66:67]
 ds_read_b128 v[248:251], v29 offset:10240
 ds_read_b128 v[252:255], v29 offset:11264
 s_mov_b64 exec, -1
 ds_read_b128 v[104:107], v28 offset:4096
 v_exp_f32 v46, v46
 v_exp_f32 v47, v47
 v_cvt_pk_bf16_f32 v102, v44, v45
 v_cvt_pk_bf16_f32 v103, v46, v47
 v_exp_f32 v48, v48
 v_exp_f32 v49, v49
 v_mfma_f32_32x32x16_bf16 v[64:79], v[244:247], v[100:103], v[64:79]
 v_exp_f32 v50, v50
 v_cvt_pk_bf16_f32 v96, v48, v49
 v_exp_f32 v51, v51
 buffer_load_dwordx4 v0, s[4:7], s37 offen offset:2048 sc1 lds
 v_exp_f32 v52, v52
 v_cvt_pk_bf16_f32 v97, v50, v51
 s_waitcnt lgkmcnt(1)
 v_mfma_f32_32x32x16_bf16 v[32:47], v[108:111], v[112:115], 0
 ds_read_b128 v[108:111], v28 offset:0
 v_exp_f32 v53, v53
 v_exp_f32 v54, v54
 v_cvt_pk_bf16_f32 v98, v52, v53
 v_exp_f32 v55, v55
 v_exp_f32 v56, v56
 v_cvt_pk_bf16_f32 v99, v54, v55
 buffer_load_dwordx4 v0, s[4:7], s37 offen offset:3072 sc1 lds
 s_sub_u32 s37, s37, 20480
 v_exp_f32 v57, v57
 v_exp_f32 v58, v58
 v_mfma_f32_32x32x16_bf16 v[80:95], v[240:243], v[96:99], v[80:95]
 v_cvt_pk_bf16_f32 v100, v56, v57
 v_exp_f32 v59, v59
 v_exp_f32 v60, v60
 v_cvt_pk_bf16_f32 v101, v58, v59
 v_exp_f32 v61, v61
 v_exp_f32 v62, v62
 v_exp_f32 v63, v63
 v_cvt_pk_bf16_f32 v102, v60, v61
 v_cvt_pk_bf16_f32 v103, v62, v63
 v_exp_f32 v32, v32
 v_exp_f32 v33, v33
 v_mfma_f32_32x32x16_bf16 v[80:95], v[244:247], v[100:103], v[80:95]
 s_mov_b64 exec, s[66:67]
 ds_read_b128 v[240:243], v29 offset:6144
 ds_read_b128 v[244:247], v29 offset:7168
 s_mov_b64 exec, -1
 v_exp_f32 v34, v34
 v_cvt_pk_bf16_f32 v96, v32, v33
 v_exp_f32 v35, v35
 s_add_u32 m0, s65, 147456
 s_nop 0
 buffer_load_dwordx4 v0, s[4:7], s37 offen sc1 lds
 v_exp_f32 v36, v36
 v_cvt_pk_bf16_f32 v97, v34, v35
 s_waitcnt lgkmcnt(3)
 v_mfma_f32_32x32x16_bf16 v[48:63], v[104:107], v[112:115], 0
 v_exp_f32 v37, v37
 v_exp_f32 v38, v38
 v_cvt_pk_bf16_f32 v98, v36, v37
 v_exp_f32 v39, v39
 v_exp_f32 v40, v40
 v_cvt_pk_bf16_f32 v99, v38, v39
 buffer_load_dwordx4 v0, s[4:7], s37 offen offset:1024 sc1 lds
 v_exp_f32 v41, v41
 v_exp_f32 v42, v42
 v_mfma_f32_32x32x16_bf16 v[64:79], v[248:251], v[96:99], v[64:79]
 v_cvt_pk_bf16_f32 v100, v40, v41
 v_exp_f32 v43, v43
 v_exp_f32 v44, v44
 v_cvt_pk_bf16_f32 v101, v42, v43
 v_exp_f32 v45, v45
 v_exp_f32 v46, v46
 v_exp_f32 v47, v47
 v_cvt_pk_bf16_f32 v102, v44, v45
 v_cvt_pk_bf16_f32 v103, v46, v47
 v_exp_f32 v48, v48
 v_exp_f32 v49, v49
 v_mfma_f32_32x32x16_bf16 v[64:79], v[252:255], v[100:103], v[64:79]
 s_mov_b64 exec, s[66:67]
 ds_read_b128 v[248:251], v29 offset:2048
 ds_read_b128 v[252:255], v29 offset:3072
 s_mov_b64 exec, -1
 v_exp_f32 v50, v50
 v_cvt_pk_bf16_f32 v96, v48, v49
 v_exp_f32 v51, v51
 buffer_load_dwordx4 v0, s[4:7], s37 offen offset:2048 sc1 lds
 v_exp_f32 v52, v52
 v_cvt_pk_bf16_f32 v97, v50, v51
 s_waitcnt lgkmcnt(4)
 v_mfma_f32_32x32x16_bf16 v[32:47], v[108:111], v[112:115], v[224:239]
 v_exp_f32 v53, v53
 v_exp_f32 v54, v54
 v_cvt_pk_bf16_f32 v98, v52, v53
 v_exp_f32 v55, v55
 v_exp_f32 v56, v56
 v_cvt_pk_bf16_f32 v99, v54, v55
 buffer_load_dwordx4 v0, s[4:7], s37 offen offset:3072 sc1 lds
 s_sub_u32 s37, s37, 20480
 v_exp_f32 v57, v57
 v_exp_f32 v58, v58
 s_waitcnt lgkmcnt(2)
 v_mfma_f32_32x32x16_bf16 v[64:79], v[240:243], v[96:99], v[64:79]
 v_cvt_pk_bf16_f32 v100, v56, v57
 v_exp_f32 v59, v59
 v_exp_f32 v60, v60
 v_cvt_pk_bf16_f32 v101, v58, v59
 v_exp_f32 v61, v61
 v_exp_f32 v62, v62
 v_exp_f32 v63, v63
 v_cvt_pk_bf16_f32 v102, v60, v61
 v_cvt_pk_bf16_f32 v103, v62, v63
 v_exp_f32 v32, v32
 v_exp_f32 v33, v33
 v_mfma_f32_32x32x16_bf16 v[64:79], v[244:247], v[100:103], v[64:79]
 v_exp_f32 v34, v34
 v_cvt_pk_bf16_f32 v96, v32, v33
 v_exp_f32 v35, v35
 v_exp_f32 v36, v36
 v_cvt_pk_bf16_f32 v97, v34, v35
 v_exp_f32 v37, v37
 v_exp_f32 v38, v38
 v_cvt_pk_bf16_f32 v98, v36, v37
 v_exp_f32 v39, v39
 v_exp_f32 v40, v40
 v_cvt_pk_bf16_f32 v99, v38, v39
 v_exp_f32 v41, v41
 v_exp_f32 v42, v42
 s_waitcnt lgkmcnt(0)
 v_mfma_f32_32x32x16_bf16 v[64:79], v[248:251], v[96:99], v[64:79]
 v_cvt_pk_bf16_f32 v100, v40, v41
 v_exp_f32 v43, v43
 v_exp_f32 v44, v44
 v_cvt_pk_bf16_f32 v101, v42, v43
 v_exp_f32 v45, v45
 v_exp_f32 v46, v46
 v_exp_f32 v47, v47
 v_cvt_pk_bf16_f32 v102, v44, v45
 v_cvt_pk_bf16_f32 v103, v46, v47
 s_nop 1
 v_mfma_f32_32x32x16_bf16 v[64:79], v[252:255], v[100:103], v[64:79]
L63_aepi:
 v_subrev_u32 v3, 0x2b800000, v88
 v_cmp_lt_u32 vcc, 671088640, v3
 s_cbranch_vccnz L92_fb
L93_fbret:
 v_rcp_f32 v3, v88
 s_nop 0
 v_pk_mul_f32 v[80:81], v[2:3], v[80:81] op_sel:[1,0]
 v_pk_mul_f32 v[82:83], v[2:3], v[82:83] op_sel:[1,0]
 v_pk_mul_f32 v[84:85], v[2:3], v[84:85] op_sel:[1,0]
 v_pk_mul_f32 v[86:87], v[2:3], v[86:87] op_sel:[1,0]
 v_cvt_pk_bf16_f32 v80, v80, v81
 v_cvt_pk_bf16_f32 v81, v82, v83
 v_cvt_pk_bf16_f32 v82, v84, v85
 v_cvt_pk_bf16_f32 v83, v86, v87
 buffer_store_dwordx4 v[80:83], v0, s[4:7], s23 offen
 v_subrev_u32 v3, 0x2b800000, v72
 v_cmp_lt_u32 vcc, 671088640, v3
 s_cbranch_vccnz L94_fb
L95_fbret:
 v_rcp_f32 v3, v72
 s_nop 0
 v_pk_mul_f32 v[64:65], v[2:3], v[64:65] op_sel:[1,0]
 v_pk_mul_f32 v[66:67], v[2:3], v[66:67] op_sel:[1,0]
 v_pk_mul_f32 v[68:69], v[2:3], v[68:69] op_sel:[1,0]
 v_pk_mul_f32 v[70:71], v[2:3], v[70:71] op_sel:[1,0]
 v_cvt_pk_bf16_f32 v64, v64, v65
 v_cvt_pk_bf16_f32 v65, v66, v67
 v_cvt_pk_bf16_f32 v66, v68, v69
 v_cvt_pk_bf16_f32 v67, v70, v71
 buffer_store_dwordx4 v[64:67], v0, s[4:7], s22 offen
 v_mov_b32 v2, s55
 s_cmp_lg_u32 s68, 0
 s_mov_b64 exec, 1
 s_waitcnt vmcnt(0)
 s_cbranch_scc1 L96_rel
 buffer_store_dword v2, v0, s[4:7], s24 offen
 buffer_store_dword v2, v0, s[4:7], s25 offen
L97_relb:
 s_mov_b64 exec, -1
 buffer_load_dword v255, v166, s[4:7], s26 offen sc1
 s_xor_b32 s3, s65, 8192
 v_add_u32 v28, s3, v0
 s_xor_b32 s3, s65, 12288
 v_add_u32 v29, s3, v0
 s_xor_b32 s3, s65, 4096
 v_add_u32 v30, s3, v0
 v_add_u32 v31, s65, v0
L98_pt:
 s_waitcnt vmcnt(0)
 v_cmp_ne_u32 vcc, s55, v255
 s_cbranch_vccz L99_pd
 buffer_load_dword v255, v166, s[4:7], s26 offen sc1
 s_sub_u32 s57, s57, 1
 s_cbranch_scc0 L98_pt
 s_mov_b32 s57, 0
L99_pd:
 buffer_load_dwordx4 v[160:163], v0, s[4:7], s42 offen sc1
 buffer_load_dwordx4 v[164:167], v0, s[4:7], s42 offen offset:1024 sc1
 buffer_load_dwordx4 v[168:171], v0, s[4:7], s42 offen offset:2048 sc1
 buffer_load_dwordx4 v[172:175], v0, s[4:7], s42 offen offset:3072 sc1
 s_add_u32 s46, s42, 4096
 buffer_load_dwordx4 v[176:179], v0, s[4:7], s46 offen sc1
 buffer_load_dwordx4 v[180:183], v0, s[4:7], s46 offen offset:1024 sc1
 s_waitcnt vmcnt(5)
 v_mfma_f32_32x32x16_bf16 v[32:47], a[0:3], v[160:163], 0
 s_mul_i32 s29, s62, 36864
 s_add_u32 s29, s29, 1048576
 s_lshl_b32 s31, s64, 11
 s_add_u32 s31, s31, s29
 buffer_load_dwordx4 v[184:187], v0, s[4:7], s46 offen offset:2048 sc1
 v_mfma_f32_32x32x16_bf16 v[48:63], a[4:7], v[160:163], 0
 s_lshr_b32 s30, s64, 2
 s_lshl_b32 s30, s30, 10
 s_add_u32 s29, s29, s30
 s_and_b32 s30, s64, 3
 s_waitcnt vmcnt(5)
 v_mfma_f32_32x32x16_bf16 v[32:47], a[8:11], v[164:167], v[32:47]
 s_lshl2_add_u32 s29, s30, s29
 s_add_u32 s29, s29, 32768
 s_lshl_b32 s30, s62, 11
 s_lshl2_add_u32 s30, s64, s30
 buffer_load_dwordx4 v[188:191], v0, s[4:7], s46 offen offset:3072 sc1
 v_mfma_f32_32x32x16_bf16 v[48:63], a[12:15], v[164:167], v[48:63]
 s_add_u32 s30, s30, 3409024
 s_barrier
 s_waitcnt vmcnt(5)
 v_mfma_f32_32x32x16_bf16 v[32:47], a[16:19], v[168:171], v[32:47]
 buffer_load_dwordx4 v[192:195], v0, s[4:7], s43 offen sc1
 v_mfma_f32_32x32x16_bf16 v[48:63], a[20:23], v[168:171], v[48:63]
 s_waitcnt vmcnt(5)
 v_mfma_f32_32x32x16_bf16 v[32:47], a[24:27], v[172:175], v[32:47]
 buffer_load_dwordx4 v[196:199], v0, s[4:7], s43 offen offset:1024 sc1
 v_mfma_f32_32x32x16_bf16 v[48:63], a[28:31], v[172:175], v[48:63]
 s_waitcnt vmcnt(5)
 v_mfma_f32_32x32x16_bf16 v[32:47], a[32:35], v[176:179], v[32:47]
 buffer_load_dwordx4 v[200:203], v0, s[4:7], s43 offen offset:2048 sc1
 v_mfma_f32_32x32x16_bf16 v[48:63], a[36:39], v[176:179], v[48:63]
 s_waitcnt vmcnt(5)
 v_mfma_f32_32x32x16_bf16 v[32:47], a[40:43], v[180:183], v[32:47]
 buffer_load_dwordx4 v[204:207], v0, s[4:7], s43 offen offset:3072 sc1
 v_mfma_f32_32x32x16_bf16 v[48:63], a[44:47], v[180:183], v[48:63]
 s_waitcnt vmcnt(5)
 v_mfma_f32_32x32x16_bf16 v[32:47], a[48:51], v[184:187], v[32:47]
 s_add_u32 s46, s43, 4096
 buffer_load_dwordx4 v[208:211], v0, s[4:7], s46 offen sc1
 v_mfma_f32_32x32x16_bf16 v[48:63], a[52:55], v[184:187], v[48:63]
 s_waitcnt vmcnt(5)
 v_mfma_f32_32x32x16_bf16 v[32:47], v[144:147], v[188:191], v[32:47]
 buffer_load_dwordx4 v[212:215], v0, s[4:7], s46 offen offset:1024 sc1
 v_mfma_f32_32x32x16_bf16 v[48:63], v[148:151], v[188:191], v[48:63]
 s_waitcnt vmcnt(5)
 v_mfma_f32_32x32x16_bf16 v[64:79], a[4:7], v[192:195], 0
 buffer_load_dwordx4 v[216:219], v0, s[4:7], s46 offen offset:2048 sc1
 v_mfma_f32_32x32x16_bf16 v[12:27], a[0:3], v[192:195], v[12:27]
 s_waitcnt vmcnt(5)
 v_mfma_f32_32x32x16_bf16 v[64:79], a[12:15], v[196:199], v[64:79]
 buffer_load_dwordx4 v[220:223], v0, s[4:7], s46 offen offset:3072 sc1
 v_mfma_f32_32x32x16_bf16 v[12:27], a[8:11], v[196:199], v[12:27]
 s_nop 1
 ds_write_b128 v28, v[32:35] offset:0
 s_waitcnt vmcnt(5)
 v_mfma_f32_32x32x16_bf16 v[64:79], a[20:23], v[200:203], v[64:79]
 ds_write_b128 v28, v[36:39] offset:1024
 v_mfma_f32_32x32x16_bf16 v[12:27], a[16:19], v[200:203], v[12:27]
 ds_write_b128 v28, v[40:43] offset:2048
 s_waitcnt vmcnt(4)
 v_mfma_f32_32x32x16_bf16 v[64:79], a[28:31], v[204:207], v[64:79]
 ds_write_b128 v28, v[44:47] offset:3072
 v_mfma_f32_32x32x16_bf16 v[12:27], a[24:27], v[204:207], v[12:27]
 ds_write_b128 v29, v[48:51] offset:16384
 s_waitcnt vmcnt(3)
 v_mfma_f32_32x32x16_bf16 v[64:79], a[36:39], v[208:211], v[64:79]
 ds_write_b128 v29, v[52:55] offset:17408
 s_waitcnt vmcnt(2)
 v_mfma_f32_32x32x16_bf16 v[64:79], a[44:47], v[212:215], v[64:79]
 ds_write_b128 v29, v[56:59] offset:18432
 s_waitcnt vmcnt(1)
 v_mfma_f32_32x32x16_bf16 v[64:79], a[52:55], v[216:219], v[64:79]
 ds_write_b128 v29, v[60:63] offset:19456
 s_waitcnt vmcnt(0)
 v_mfma_f32_32x32x16_bf16 v[64:79], v[148:151], v[220:223], v[64:79]
 v_mfma_f32_32x32x16_bf16 v[12:27], a[32:35], v[208:211], v[12:27]
 v_mfma_f32_32x32x16_bf16 v[12:27], a[40:43], v[212:215], v[12:27]
 s_waitcnt lgkmcnt(0)
 s_barrier
 v_mfma_f32_32x32x16_bf16 v[12:27], a[48:51], v[216:219], v[12:27]
 s_nop 6
 ds_write_b128 v30, v[64:67] offset:32768
 v_mfma_f32_32x32x16_bf16 v[12:27], v[144:147], v[220:223], v[12:27]
 ds_write_b128 v30, v[68:71] offset:33792
 ds_write_b128 v30, v[72:75] offset:34816
 ds_write_b128 v30, v[76:79] offset:35840
 ds_read_b128 v[32:35], v31 offset:0
 ds_read_b128 v[36:39], v31 offset:1024
 ds_read_b128 v[40:43], v31 offset:2048
 ds_read_b128 v[44:47], v31 offset:3072
 ds_read_b128 v[48:51], v31 offset:16384
 ds_read_b128 v[52:55], v31 offset:17408
 ds_read_b128 v[56:59], v31 offset:18432
 ds_read_b128 v[60:63], v31 offset:19456
 s_waitcnt lgkmcnt(8)
 s_barrier
 ds_read_b128 v[64:67], v31 offset:32768
 ds_read_b128 v[68:71], v31 offset:33792
 ds_read_b128 v[72:75], v31 offset:34816
 ds_read_b128 v[76:79], v31 offset:35840
 s_waitcnt lgkmcnt(11)
 v_pk_add_f32 v[12:13], v[12:13], v[32:33]
 v_pk_add_f32 v[14:15], v[14:15], v[34:35]
 s_waitcnt lgkmcnt(10)
 v_pk_add_f32 v[16:17], v[16:17], v[36:37]
 v_pk_add_f32 v[18:19], v[18:19], v[38:39]
 s_waitcnt lgkmcnt(9)
 v_pk_add_f32 v[20:21], v[20:21], v[40:41]
 v_pk_add_f32 v[22:23], v[22:23], v[42:43]
 s_waitcnt lgkmcnt(8)
 v_pk_add_f32 v[24:25], v[24:25], v[44:45]
 v_pk_add_f32 v[26:27], v[26:27], v[46:47]
 s_waitcnt lgkmcnt(7)
 v_pk_add_f32 v[12:13], v[12:13], v[48:49]
 v_pk_add_f32 v[14:15], v[14:15], v[50:51]
 s_waitcnt lgkmcnt(6)
 v_pk_add_f32 v[16:17], v[16:17], v[52:53]
 v_pk_add_f32 v[18:19], v[18:19], v[54:55]
 s_waitcnt lgkmcnt(5)
 v_pk_add_f32 v[20:21], v[20:21], v[56:57]
 v_pk_add_f32 v[22:23], v[22:23], v[58:59]
 s_waitcnt lgkmcnt(4)
 v_pk_add_f32 v[24:25], v[24:25], v[60:61]
 v_pk_add_f32 v[26:27], v[26:27], v[62:63]
 s_waitcnt lgkmcnt(3)
 v_pk_add_f32 v[12:13], v[12:13], v[64:65]
 v_pk_add_f32 v[14:15], v[14:15], v[66:67]
 s_waitcnt lgkmcnt(2)
 v_pk_add_f32 v[16:17], v[16:17], v[68:69]
 v_pk_add_f32 v[18:19], v[18:19], v[70:71]
 s_waitcnt lgkmcnt(1)
 v_pk_add_f32 v[20:21], v[20:21], v[72:73]
 v_pk_add_f32 v[22:23], v[22:23], v[74:75]
 s_waitcnt lgkmcnt(0)
 v_pk_add_f32 v[24:25], v[24:25], v[76:77]
 v_pk_add_f32 v[26:27], v[26:27], v[78:79]
 v_cvt_pk_bf16_f32 v32, v12, v13
 v_cvt_pk_bf16_f32 v33, v14, v15
 v_cvt_pk_bf16_f32 v34, v16, v17
 v_cvt_pk_bf16_f32 v35, v18, v19
 buffer_store_dwordx4 v[32:35], v0, s[4:7], s31 offen
 v_cvt_pk_bf16_f32 v36, v20, v21
 v_cvt_pk_bf16_f32 v37, v22, v23
 v_cvt_pk_bf16_f32 v38, v24, v25
 v_cvt_pk_bf16_f32 v39, v26, v27
 buffer_store_dwordx4 v[36:39], v0, s[4:7], s31 offen offset:1024
 v_pk_add_f32 v[40:41], v[12:13], v[14:15]
 v_pk_mul_f32 v[42:43], v[12:13], v[12:13]
 v_pk_fma_f32 v[42:43], v[14:15], v[14:15], v[42:43]
 v_pk_add_f32 v[40:41], v[40:41], v[16:17]
 v_pk_fma_f32 v[42:43], v[16:17], v[16:17], v[42:43]
 v_pk_add_f32 v[40:41], v[40:41], v[18:19]
 v_pk_fma_f32 v[42:43], v[18:19], v[18:19], v[42:43]
 v_pk_add_f32 v[40:41], v[40:41], v[20:21]
 v_pk_fma_f32 v[42:43], v[20:21], v[20:21], v[42:43]
 v_pk_add_f32 v[40:41], v[40:41], v[22:23]
 v_pk_fma_f32 v[42:43], v[22:23], v[22:23], v[42:43]
 v_pk_add_f32 v[40:41], v[40:41], v[24:25]
 v_pk_fma_f32 v[42:43], v[24:25], v[24:25], v[42:43]
 v_pk_add_f32 v[40:41], v[40:41], v[26:27]
 v_pk_fma_f32 v[42:43], v[26:27], v[26:27], v[42:43]
 v_add_f32 v40, v40, v41
 v_add_f32 v42, v42, v43
 v_bfe_u32 v1, v0, 2, 6
 s_add_u32 s28, s61, 1152
 v_permlane32_swap_b32 v40, v42
 v_add_f32 v3, v40, v42
 v_mov_b32 v2, s55
 s_cmp_lg_u32 s68, 0
 s_mov_b64 exec, 1
 s_waitcnt vmcnt(0)
 s_cbranch_scc1 L100_rel
 buffer_store_dword v2, v0, s[4:7], s30 offen
L101_relb:
 s_mov_b64 exec, -1
 buffer_load_dword v255, v1, s[4:7], s28 offen sc1
 buffer_store_dword v3, v0, s[4:7], s29 offen
 v_bfe_u32 v28, v0, 4, 5
 v_lshlrev_b32 v28, 2, v28
 v_and_b32 v29, 0x200, v0
 v_add_u32 v28, v28, v29
 v_add_u32 v30, 65536, v0
 v_add_u32 v31, 131072, v0
 s_mul_i32 s33, s52, 5120
 s_add_u32 s33, s33, s60
 s_add_u32 s34, s33, 4096
 s_add_u32 s35, s52, 80
 s_lshl_b32 s35, s35, 10
 s_add_u32 s35, s35, s60
 s_lshl2_add_u32 s36, s52, s61
 s_add_u32 s36, s36, 1280
 s_add_u32 s38, s36, 64
 s_add_u32 s39, s36, 128
 s_add_u32 s32, s59, 28672
 ds_read_b128 a[240:243], v30 offset:0
 ds_read_b128 a[244:247], v30 offset:1024
 ds_read_b128 a[248:251], v30 offset:2048
 ds_read_b128 a[252:255], v30 offset:3072
 s_mul_i32 s3, s50, 20480
 s_add_u32 s3, s3, 4194304
 s_mul_i32 s44, s63, 90112
 s_add_u32 s42, s44, s3
 s_mul_i32 s44, s62, 90112
 s_add_u32 s43, s44, s3
 s_add_u32 s44, s44, 4276224
 s_and_b32 s26, s62, 0xfffffffe
 s_lshl_b32 s26, s26, 11
 v_and_b32 v4, 0x200, v0
 v_lshlrev_b32 v4, 2, v4
 s_lshl4_add_u32 s26, s50, s26
 s_add_u32 s26, s26, 3409152
 v_bfe_u32 v2, v0, 2, 4
 v_add_u32 v4, v4, v2
L102_pt:
 s_waitcnt vmcnt(0)
 v_cmp_ne_u32 vcc, s55, v255
 s_cbranch_vccz L103_pd
 buffer_load_dword v255, v1, s[4:7], s28 offen sc1
 s_sub_u32 s57, s57, 1
 s_cbranch_scc0 L102_pt
 s_mov_b32 s57, 0
L103_pd:
 buffer_load_dwordx4 v[32:35], v0, s[4:7], s32 offen offset:3072 sc1
 buffer_load_dwordx4 v[36:39], v0, s[4:7], s32 offen offset:2048 sc1
 buffer_load_dwordx4 v[40:43], v0, s[4:7], s32 offen offset:1024 sc1
 buffer_load_dwordx4 v[44:47], v0, s[4:7], s32 offen sc1
 s_add_u32 s32, s59, 24576
 buffer_load_dwordx4 v[48:51], v0, s[4:7], s32 offen offset:3072 sc1
 s_add_u32 s30, s30, 64
 v_mov_b32 v2, s55
 s_cmp_lg_u32 s68, 0
 s_mov_b64 exec, 1
 s_cbranch_scc1 L104_rel
 buffer_store_dword v2, v0, s[4:7], s30 offen
L105_relb:
 s_mov_b64 exec, -1
 s_waitcnt vmcnt(5) lgkmcnt(3)
 v_mfma_f32_32x32x16_bf16 v[160:175], a[240:243], v[32:35], 0
 buffer_load_dwordx4 v[52:55], v0, s[4:7], s32 offen offset:2048 sc1
 ds_read_b128 a[240:243], v30 offset:4096
 s_waitcnt lgkmcnt(3)
 v_mfma_f32_32x32x16_bf16 v[176:191], a[244:247], v[32:35], 0
 ds_read_b128 a[244:247], v30 offset:5120
 s_waitcnt lgkmcnt(3)
 v_mfma_f32_32x32x16_bf16 v[192:207], a[248:251], v[32:35], 0
 buffer_load_dwordx4 v[56:59], v0, s[4:7], s32 offen offset:1024 sc1
 ds_read_b128 a[248:251], v30 offset:6144
 s_waitcnt lgkmcnt(3)
 v_mfma_f32_32x32x16_bf16 v[208:223], a[252:255], v[32:35], 0
 ds_read_b128 a[252:255], v30 offset:7168
 s_waitcnt vmcnt(6) lgkmcnt(3)
 v_mfma_f32_32x32x16_bf16 v[160:175], a[240:243], v[36:39], v[160:175]
 buffer_load_dwordx4 v[60:63], v0, s[4:7], s32 offen sc1
 ds_read_b128 a[240:243], v30 offset:8192
 s_waitcnt lgkmcnt(3)
 v_mfma_f32_32x32x16_bf16 v[176:191], a[244:247], v[36:39], v[176:191]
 s_add_u32 s32, s59, 20480
 buffer_load_dwordx4 v[64:67], v0, s[4:7], s32 offen offset:3072 sc1
 ds_read_b128 a[244:247], v30 offset:9216
 s_waitcnt lgkmcnt(3)
 v_mfma_f32_32x32x16_bf16 v[192:207], a[248:251], v[36:39], v[192:207]
 ds_read_b128 a[248:251], v30 offset:10240
 s_waitcnt lgkmcnt(3)
 v_mfma_f32_32x32x16_bf16 v[208:223], a[252:255], v[36:39], v[208:223]
 buffer_load_dwordx4 v[68:71], v0, s[4:7], s32 offen offset:2048 sc1
 ds_read_b128 a[252:255], v30 offset:11264
 s_waitcnt vmcnt(8) lgkmcnt(3)
 v_mfma_f32_32x32x16_bf16 v[160:175], a[240:243], v[40:43], v[160:175]
 ds_read_b128 a[240:243], v30 offset:12288
 s_waitcnt lgkmcnt(3)
 v_mfma_f32_32x32x16_bf16 v[176:191], a[244:247], v[40:43], v[176:191]
 ds_read_b128 a[244:247], v30 offset:13312
 s_waitcnt lgkmcnt(3)
 v_mfma_f32_32x32x16_bf16 v[192:207], a[248:251], v[40:43], v[192:207]
 buffer_load_dwordx4 v[72:75], v0, s[4:7], s32 offen offset:1024 sc1
 ds_read_b128 a[248:251], v30 offset:14336
 s_waitcnt lgkmcnt(3)
 v_mfma_f32_32x32x16_bf16 v[208:223], a[252:255], v[40:43], v[208:223]
 ds_read_b128 a[252:255], v30 offset:15360
 s_waitcnt vmcnt(8) lgkmcnt(3)
 v_mfma_f32_32x32x16_bf16 v[160:175], a[240:243], v[44:47], v[160:175]
 buffer_load_dwordx4 v[76:79], v0, s[4:7], s32 offen sc1
 ds_read_b128 a[240:243], v30 offset:16384
 s_waitcnt lgkmcnt(3)
 v_mfma_f32_32x32x16_bf16 v[176:191], a[244:247], v[44:47], v[176:191]
 ds_read_b128 a[244:247], v30 offset:17408
 s_waitcnt lgkmcnt(3)
 v_mfma_f32_32x32x16_bf16 v[192:207], a[248:251], v[44:47], v[192:207]
 s_add_u32 s32, s59, 16384
 buffer_load_dwordx4 v[80:83], v0, s[4:7], s32 offen offset:3072 sc1
 ds_read_b128 a[248:251], v30 offset:18432
 s_waitcnt lgkmcnt(3)
 v_mfma_f32_32x32x16_bf16 v[208:223], a[252:255], v[44:47], v[208:223]
 buffer_load_dwordx4 v[84:87], v0, s[4:7], s32 offen offset:2048 sc1
 ds_read_b128 a[252:255], v30 offset:19456
 s_waitcnt vmcnt(10) lgkmcnt(3)
 v_mfma_f32_32x32x16_bf16 v[160:175], a[240:243], v[48:51], v[160:175]
 ds_read_b128 a[240:243], v30 offset:20480
 s_waitcnt lgkmcnt(3)
 v_mfma_f32_32x32x16_bf16 v[176:191], a[244:247], v[48:51], v[176:191]
 buffer_load_dwordx4 v[88:91], v0, s[4:7], s32 offen offset:1024 sc1
 ds_read_b128 a[244:247], v30 offset:21504
 s_waitcnt lgkmcnt(3)
 v_mfma_f32_32x32x16_bf16 v[192:207], a[248:251], v[48:51], v[192:207]
 ds_read_b128 a[248:251], v30 offset:22528
 s_waitcnt lgkmcnt(3)
 v_mfma_f32_32x32x16_bf16 v[208:223], a[252:255], v[48:51], v[208:223]
 ds_read_b128 a[252:255], v30 offset:23552
 s_waitcnt vmcnt(9) lgkmcnt(3)
 v_mfma_f32_32x32x16_bf16 v[160:175], a[240:243], v[52:55], v[160:175]
 buffer_load_dwordx4 v[92:95], v0, s[4:7], s32 offen sc1
 ds_read_b128 a[240:243], v30 offset:24576
 s_waitcnt lgkmcnt(3)
 v_mfma_f32_32x32x16_bf16 v[176:191], a[244:247], v[52:55], v[176:191]
 ds_read_b128 a[244:247], v30 offset:25600
 s_waitcnt lgkmcnt(3)
 v_mfma_f32_32x32x16_bf16 v[192:207], a[248:251], v[52:55], v[192:207]
 s_add_u32 s32, s59, 12288
 buffer_load_dwordx4 v[96:99], v0, s[4:7], s32 offen offset:3072 sc1
 ds_read_b128 a[248:251], v30 offset:26624
 s_waitcnt lgkmcnt(3)
 v_mfma_f32_32x32x16_bf16 v[208:223], a[252:255], v[52:55], v[208:223]
 ds_read_b128 a[252:255], v30 offset:27648
 s_waitcnt vmcnt(10) lgkmcnt(3)
 v_mfma_f32_32x32x16_bf16 v[160:175], a[240:243], v[56:59], v[160:175]
 buffer_load_dwordx4 v[100:103], v0, s[4:7], s32 offen offset:2048 sc1
 ds_read_b128 a[240:243], v30 offset:28672
 s_waitcnt lgkmcnt(3)
 v_mfma_f32_32x32x16_bf16 v[176:191], a[244:247], v[56:59], v[176:191]
 buffer_load_dwordx4 v[104:107], v0, s[4:7], s32 offen offset:1024 sc1
 ds_read_b128 a[244:247], v30 offset:29696
 s_waitcnt lgkmcnt(3)
 v_mfma_f32_32x32x16_bf16 v[192:207], a[248:251], v[56:59], v[192:207]
 ds_read_b128 a[248:251], v30 offset:30720
 s_waitcnt lgkmcnt(3)
 v_mfma_f32_32x32x16_bf16 v[208:223], a[252:255], v[56:59], v[208:223]
 buffer_load_dwordx4 v[108:111], v0, s[4:7], s32 offen sc1
 ds_read_b128 a[252:255], v30 offset:31744
 s_waitcnt vmcnt(12) lgkmcnt(3)
 v_mfma_f32_32x32x16_bf16 v[160:175], a[240:243], v[60:63], v[160:175]
 ds_read_b128 a[240:243], v30 offset:32768
 s_waitcnt lgkmcnt(3)
 v_mfma_f32_32x32x16_bf16 v[176:191], a[244:247], v[60:63], v[176:191]
 ds_read_b128 a[244:247], v30 offset:33792
 s_waitcnt lgkmcnt(3)
 v_mfma_f32_32x32x16_bf16 v[192:207], a[248:251], v[60:63], v[192:207]
 s_add_u32 s32, s59, 8192
 buffer_load_dwordx4 v[112:115], v0, s[4:7], s32 offen offset:3072 sc1
 ds_read_b128 a[248:251], v30 offset:34816
 s_waitcnt lgkmcnt(3)
 v_mfma_f32_32x32x16_bf16 v[208:223], a[252:255], v[60:63], v[208:223]
 ds_read_b128 a[252:255], v30 offset:35840
 s_waitcnt vmcnt(12) lgkmcnt(3)
 v_mfma_f32_32x32x16_bf16 v[160:175], a[240:243], v[64:67], v[160:175]
 buffer_load_dwordx4 v[116:119], v0, s[4:7], s32 offen offset:2048 sc1
 ds_read_b128 a[240:243], v30 offset:36864
 s_waitcnt lgkmcnt(3)
 v_mfma_f32_32x32x16_bf16 v[176:191], a[244:247], v[64:67], v[176:191]
 ds_read_b128 a[244:247], v30 offset:37888
 s_waitcnt lgkmcnt(3)
 v_mfma_f32_32x32x16_bf16 v[192:207], a[248:251], v[64:67], v[192:207]
 buffer_load_dwordx4 v[120:123], v0, s[4:7], s32 offen offset:1024 sc1
 buffer_load_dword v240, v1, s[4:7], s28 offen offset:64 sc1
 ds_read_b128 a[248:251], v30 offset:38912
 s_waitcnt lgkmcnt(3)
 v_mfma_f32_32x32x16_bf16 v[208:223], a[252:255], v[64:67], v[208:223]
 buffer_load_dwordx4 v[124:127], v0, s[4:7], s32 offen sc1
 ds_read_b128 a[252:255], v30 offset:39936
 s_waitcnt vmcnt(15) lgkmcnt(3)
 v_mfma_f32_32x32x16_bf16 v[160:175], a[240:243], v[68:71], v[160:175]
 ds_read_b128 a[240:243], v30 offset:40960
 s_waitcnt lgkmcnt(3)
 v_mfma_f32_32x32x16_bf16 v[176:191], a[244:247], v[68:71], v[176:191]
 s_add_u32 s32, s59, 4096
 buffer_load_dwordx4 v[128:131], v0, s[4:7], s32 offen offset:3072 sc1
 ds_read_b128 a[244:247], v30 offset:41984
 s_waitcnt lgkmcnt(3)
 v_mfma_f32_32x32x16_bf16 v[192:207], a[248:251], v[68:71], v[192:207]
 ds_read_b128 a[248:251], v30 offset:43008
 s_waitcnt lgkmcnt(3)
 v_mfma_f32_32x32x16_bf16 v[208:223], a[252:255], v[68:71], v[208:223]
 ds_read_b128 a[252:255], v30 offset:44032
 s_waitcnt vmcnt(15) lgkmcnt(3)
 v_mfma_f32_32x32x16_bf16 v[160:175], a[240:243], v[72:75], v[160:175]
 buffer_load_dwordx4 v[132:135], v0, s[4:7], s32 offen offset:2048 sc1
 ds_read_b128 a[240:243], v30 offset:45056
 s_waitcnt lgkmcnt(3)
 v_mfma_f32_32x32x16_bf16 v[176:191], a[244:247], v[72:75], v[176:191]
 ds_read_b128 a[244:247], v30 offset:46080
 s_waitcnt lgkmcnt(3)
 v_mfma_f32_32x32x16_bf16 v[192:207], a[248:251], v[72:75], v[192:207]
 buffer_load_dwordx4 v[136:139], v0, s[4:7], s32 offen offset:1024 sc1
 ds_read_b128 a[248:251], v30 offset:47104
 s_waitcnt lgkmcnt(3)
 v_mfma_f32_32x32x16_bf16 v[208:223], a[252:255], v[72:75], v[208:223]
 ds_read_b128 a[252:255], v30 offset:48128
 s_waitcnt vmcnt(16) lgkmcnt(3)
 v_mfma_f32_32x32x16_bf16 v[160:175], a[240:243], v[76:79], v[160:175]
 buffer_load_dwordx4 v[140:143], v0, s[4:7], s32 offen sc1
 ds_read_b128 a[240:243], v30 offset:49152
 s_waitcnt lgkmcnt(3)
 v_mfma_f32_32x32x16_bf16 v[176:191], a[244:247], v[76:79], v[176:191]
 s_add_u32 s32, s59, 0
 buffer_load_dwordx4 v[144:147], v0, s[4:7], s32 offen offset:3072 sc1
 ds_read_b128 a[244:247], v30 offset:50176
 s_waitcnt lgkmcnt(3)
 v_mfma_f32_32x32x16_bf16 v[192:207], a[248:251], v[76:79], v[192:207]
 ds_read_b128 a[248:251], v30 offset:51200
 s_waitcnt lgkmcnt(3)
 v_mfma_f32_32x32x16_bf16 v[208:223], a[252:255], v[76:79], v[208:223]
 buffer_load_dwordx4 v[148:151], v0, s[4:7], s32 offen offset:2048 sc1
 ds_read_b128 a[252:255], v30 offset:52224
 s_waitcnt vmcnt(18) lgkmcnt(3)
 v_mfma_f32_32x32x16_bf16 v[160:175], a[240:243], v[80:83], v[160:175]
 ds_read_b128 a[240:243], v30 offset:53248
 s_waitcnt lgkmcnt(3)
 v_mfma_f32_32x32x16_bf16 v[176:191], a[244:247], v[80:83], v[176:191]
 ds_read_b128 a[244:247], v30 offset:54272
 s_waitcnt lgkmcnt(3)
 v_mfma_f32_32x32x16_bf16 v[192:207], a[248:251], v[80:83], v[192:207]
 buffer_load_dwordx4 v[152:155], v0, s[4:7], s32 offen offset:1024 sc1
 ds_read_b128 a[248:251], v30 offset:55296
 s_waitcnt lgkmcnt(3)
 v_mfma_f32_32x32x16_bf16 v[208:223], a[252:255], v[80:83], v[208:223]
 ds_read_b128 a[252:255], v30 offset:56320
 s_waitcnt vmcnt(18) lgkmcnt(3)
 v_mfma_f32_32x32x16_bf16 v[160:175], a[240:243], v[84:87], v[160:175]
 buffer_load_dwordx4 v[156:159], v0, s[4:7], s32 offen sc1
 s_barrier
 ds_read_b128 a[240:243], v30 offset:57344
 s_waitcnt lgkmcnt(3)
 v_mfma_f32_32x32x16_bf16 v[176:191], a[244:247], v[84:87], v[176:191]
 ds_read_b128 a[244:247], v30 offset:58368
 s_waitcnt lgkmcnt(3)
 v_mfma_f32_32x32x16_bf16 v[192:207], a[248:251], v[84:87], v[192:207]
 s_waitcnt vmcnt(9)
 v_cmp_ne_u32 vcc, s55, v240
 s_cbranch_vccnz L106_spin
L107_got:
 s_add_u32 s32, s59, 32768
 buffer_load_dwordx4 v[240:243], v0, s[4:7], s32 offen sc1
 ds_read_b128 a[248:251], v30 offset:59392
 s_waitcnt lgkmcnt(3)
 v_mfma_f32_32x32x16_bf16 v[208:223], a[252:255], v[84:87], v[208:223]
 buffer_load_dwordx4 v[244:247], v0, s[4:7], s32 offen offset:1024 sc1
 ds_read_b128 a[252:255], v30 offset:60416
 s_waitcnt lgkmcnt(3)
 v_mfma_f32_32x32x16_bf16 v[160:175], a[240:243], v[88:91], v[160:175]
 ds_read_b128 a[240:243], v30 offset:61440
 s_waitcnt lgkmcnt(3)
 v_mfma_f32_32x32x16_bf16 v[176:191], a[244:247], v[88:91], v[176:191]
 buffer_load_dwordx4 v[248:251], v0, s[4:7], s32 offen offset:2048 sc1
 ds_read_b128 a[244:247], v30 offset:62464
 s_waitcnt lgkmcnt(3)
 v_mfma_f32_32x32x16_bf16 v[192:207], a[248:251], v[88:91], v[192:207]
 ds_read_b128 a[248:251], v30 offset:63488
 s_waitcnt lgkmcnt(3)
 v_mfma_f32_32x32x16_bf16 v[208:223], a[252:255], v[88:91], v[208:223]
 ds_read_b128 a[252:255], v30 offset:64512
 s_waitcnt lgkmcnt(3)
 v_mfma_f32_32x32x16_bf16 v[160:175], a[240:243], v[92:95], v[160:175]
 buffer_load_dwordx4 v[252:255], v0, s[4:7], s32 offen offset:3072 sc1
 ds_read_b128 a[240:243], v31 offset:0
 s_waitcnt lgkmcnt(3)
 v_mfma_f32_32x32x16_bf16 v[176:191], a[244:247], v[92:95], v[176:191]
 ds_read_b128 a[244:247], v31 offset:1024
 s_waitcnt lgkmcnt(3)
 v_mfma_f32_32x32x16_bf16 v[192:207], a[248:251], v[92:95], v[192:207]
 s_add_u32 m0, s65, 49152
 s_nop 0
 buffer_load_dwordx4 v0, s[4:7], s37 offen sc1 lds
 ds_read_b128 a[248:251], v31 offset:2048
 s_waitcnt lgkmcnt(3)
 v_mfma_f32_32x32x16_bf16 v[208:223], a[252:255], v[92:95], v[208:223]
 ds_read_b128 a[252:255], v31 offset:3072
 s_waitcnt lgkmcnt(3)
 v_mfma_f32_32x32x16_bf16 v[160:175], a[240:243], v[96:99], v[160:175]
 buffer_load_dwordx4 v0, s[4:7], s37 offen offset:1024 sc1 lds
 ds_read_b128 a[240:243], v31 offset:4096
 s_waitcnt lgkmcnt(3)
 v_mfma_f32_32x32x16_bf16 v[176:191], a[244:247], v[96:99], v[176:191]
 buffer_load_dwordx4 v0, s[4:7], s37 offen offset:2048 sc1 lds
 ds_read_b128 a[244:247], v31 offset:5120
 s_waitcnt lgkmcnt(3)
 v_mfma_f32_32x32x16_bf16 v[192:207], a[248:251], v[96:99], v[192:207]
 ds_read_b128 a[248:251], v31 offset:6144
 s_waitcnt lgkmcnt(3)
 v_mfma_f32_32x32x16_bf16 v[208:223], a[252:255], v[96:99], v[208:223]
 buffer_load_dwordx4 v0, s[4:7], s37 offen offset:3072 sc1 lds
 s_sub_u32 s37, s37, 20480
 ds_read_b128 a[252:255], v31 offset:7168
 s_waitcnt lgkmcnt(3)
 v_mfma_f32_32x32x16_bf16 v[160:175], a[240:243], v[100:103], v[160:175]
 ds_read_b128 a[240:243], v31 offset:8192
 s_waitcnt lgkmcnt(3)
 v_mfma_f32_32x32x16_bf16 v[176:191], a[244:247], v[100:103], v[176:191]
 ds_read_b128 a[244:247], v31 offset:9216
 s_waitcnt lgkmcnt(3)
 v_mfma_f32_32x32x16_bf16 v[192:207], a[248:251], v[100:103], v[192:207]
 s_add_u32 m0, s65, 0
 s_nop 0
 buffer_load_dwordx4 v0, s[4:7], s37 offen sc1 lds
 ds_read_b128 a[248:251], v31 offset:10240
 s_waitcnt lgkmcnt(3)
 v_mfma_f32_32x32x16_bf16 v[208:223], a[252:255], v[100:103], v[208:223]
 ds_read_b128 a[252:255], v31 offset:11264
 s_waitcnt lgkmcnt(3)
 v_mfma_f32_32x32x16_bf16 v[160:175], a[240:243], v[104:107], v[160:175]
 buffer_load_dwordx4 v0, s[4:7], s37 offen offset:1024 sc1 lds
 ds_read_b128 a[240:243], v31 offset:12288
 s_waitcnt lgkmcnt(3)
 v_mfma_f32_32x32x16_bf16 v[176:191], a[244:247], v[104:107], v[176:191]
 ds_read_b128 a[244:247], v31 offset:13312
 s_waitcnt lgkmcnt(3)
 v_mfma_f32_32x32x16_bf16 v[192:207], a[248:251], v[104:107], v[192:207]
 buffer_load_dwordx4 v0, s[4:7], s37 offen offset:2048 sc1 lds
 ds_read_b128 a[248:251], v31 offset:14336
 s_waitcnt lgkmcnt(3)
 v_mfma_f32_32x32x16_bf16 v[208:223], a[252:255], v[104:107], v[208:223]
 buffer_load_dwordx4 v0, s[4:7], s37 offen offset:3072 sc1 lds
 s_sub_u32 s37, s37, 20480
 ds_read_b128 a[252:255], v31 offset:15360
 s_waitcnt lgkmcnt(3)
 v_mfma_f32_32x32x16_bf16 v[160:175], a[240:243], v[108:111], v[160:175]
 ds_read_b128 a[240:243], v31 offset:16384
 s_waitcnt lgkmcnt(3)
 v_mfma_f32_32x32x16_bf16 v[176:191], a[244:247], v[108:111], v[176:191]
 s_mul_i32 s37, s52, 204800
 s_mul_i32 s3, s50, 1024
 s_add_u32 s37, s37, s3
 s_add_u32 s37, s37, 19038208
 s_lshl_b32 s40, s50, 10
 s_add_u32 m0, s40, 98304
 s_nop 0
 buffer_load_dwordx4 v0, s[4:7], s37 offen sc1 lds
 ds_read_b128 a[244:247], v31 offset:17408
 s_waitcnt lgkmcnt(3)
 v_mfma_f32_32x32x16_bf16 v[192:207], a[248:251], v[108:111], v[192:207]
 ds_read_b128 a[248:251], v31 offset:18432
 s_waitcnt lgkmcnt(3)
 v_mfma_f32_32x32x16_bf16 v[208:223], a[252:255], v[108:111], v[208:223]
 ds_read_b128 a[252:255], v31 offset:19456
 s_waitcnt lgkmcnt(3)
 v_mfma_f32_32x32x16_bf16 v[160:175], a[240:243], v[112:115], v[160:175]
 s_mul_i32 s37, s52, 204800
 s_mul_i32 s3, s50, 33792
 s_add_u32 s37, s37, s3
 s_add_u32 s37, s37, 19042304
 s_cmp_lt_u32 s50, 2
 s_cselect_b32 s37, s37, 2146435072
 s_add_u32 m0, s40, 102400
 s_nop 0
 buffer_load_dwordx4 v0, s[4:7], s37 offen sc1 lds
 ds_read_b128 a[240:243], v31 offset:20480
 s_waitcnt lgkmcnt(3)
 v_mfma_f32_32x32x16_bf16 v[176:191], a[244:247], v[112:115], v[176:191]
 ds_read_b128 a[244:247], v31 offset:21504
 s_waitcnt lgkmcnt(3)
 v_mfma_f32_32x32x16_bf16 v[192:207], a[248:251], v[112:115], v[192:207]
 s_mul_i32 s37, s52, 204800
 s_mul_i32 s3, s50, 20480
 s_add_u32 s37, s37, s3
 s_add_u32 s37, s37, 18878464
 s_add_u32 m0, s65, 16384
 s_nop 0
 buffer_load_dwordx4 v0, s[4:7], s37 offen sc1 lds
 ds_read_b128 a[248:251], v31 offset:22528
 s_waitcnt lgkmcnt(3)
 v_mfma_f32_32x32x16_bf16 v[208:223], a[252:255], v[112:115], v[208:223]
 ds_read_b128 a[252:255], v31 offset:23552
 s_waitcnt lgkmcnt(3)
 v_mfma_f32_32x32x16_bf16 v[160:175], a[240:243], v[116:119], v[160:175]
 s_add_u32 s40, s37, 4096
 buffer_load_dwordx4 v0, s[4:7], s40 offen offset:1024 sc1 lds
 ds_read_b128 a[240:243], v31 offset:24576
 s_waitcnt lgkmcnt(3)
 v_mfma_f32_32x32x16_bf16 v[176:191], a[244:247], v[116:119], v[176:191]
 s_add_u32 s40, s37, 8192
 buffer_load_dwordx4 v0, s[4:7], s40 offen offset:2048 sc1 lds
 ds_read_b128 a[244:247], v31 offset:25600
 s_waitcnt lgkmcnt(3)
 v_mfma_f32_32x32x16_bf16 v[192:207], a[248:251], v[116:119], v[192:207]
 ds_read_b128 a[248:251], v31 offset:26624
 s_waitcnt lgkmcnt(3)
 v_mfma_f32_32x32x16_bf16 v[208:223], a[252:255], v[116:119], v[208:223]
 s_add_u32 s40, s37, 12288
 buffer_load_dwordx4 v0, s[4:7], s40 offen offset:3072 sc1 lds
 s_add_u32 s37, s37, 81920
 ds_read_b128 a[252:255], v31 offset:27648
 s_waitcnt lgkmcnt(3)
 v_mfma_f32_32x32x16_bf16 v[160:175], a[240:243], v[120:123], v[160:175]
 ds_read_b128 a[240:243], v31 offset:28672
 s_waitcnt lgkmcnt(3)
 v_mfma_f32_32x32x16_bf16 v[176:191], a[244:247], v[120:123], v[176:191]
 ds_read_b128 a[244:247], v31 offset:29696
 s_waitcnt lgkmcnt(3)
 v_mfma_f32_32x32x16_bf16 v[192:207], a[248:251], v[120:123], v[192:207]
 s_add_u32 m0, s65, 32768
 s_nop 0
 buffer_load_dwordx4 v0, s[4:7], s37 offen sc1 lds
 ds_read_b128 a[248:251], v31 offset:30720
 s_waitcnt lgkmcnt(3)
 v_mfma_f32_32x32x16_bf16 v[208:223], a[252:255], v[120:123], v[208:223]
 ds_read_b128 a[252:255], v31 offset:31744
 s_waitcnt vmcnt(27) lgkmcnt(3)
 v_mfma_f32_32x32x16_bf16 v[160:175], a[240:243], v[124:127], v[160:175]
 s_add_u32 s40, s37, 4096
 buffer_load_dwordx4 v0, s[4:7], s40 offen offset:1024 sc1 lds
 s_waitcnt vmcnt(12)
 s_barrier
 ds_read_b128 a[240:243], v0 offset:49152
 s_waitcnt lgkmcnt(3)
 v_mfma_f32_32x32x16_bf16 v[176:191], a[244:247], v[124:127], v[176:191]
 ds_read_b128 a[244:247], v0 offset:50176
 s_waitcnt lgkmcnt(3)
 v_mfma_f32_32x32x16_bf16 v[192:207], a[248:251], v[124:127], v[192:207]
 s_add_u32 s40, s37, 8192
 buffer_load_dwordx4 v0, s[4:7], s40 offen offset:2048 sc1 lds
 ds_read_b128 a[248:251], v0 offset:51200
 s_waitcnt lgkmcnt(3)
 v_mfma_f32_32x32x16_bf16 v[208:223], a[252:255], v[124:127], v[208:223]
 s_add_u32 s40, s37, 12288
 buffer_load_dwordx4 v0, s[4:7], s40 offen offset:3072 sc1 lds
 s_add_u32 s37, s37, 81920
 ds_read_b128 a[252:255], v0 offset:52224
 s_waitcnt lgkmcnt(3)
 v_mfma_f32_32x32x16_bf16 v[160:175], a[240:243], v[128:131], v[160:175]
 ds_read_b128 a[240:243], v0 offset:53248
 s_waitcnt lgkmcnt(3)
 v_mfma_f32_32x32x16_bf16 v[176:191], a[244:247], v[128:131], v[176:191]
 s_mul_i32 s37, s52, 204800
 s_mul_i32 s3, s50, 4096
 s_add_u32 s37, s37, s3
 s_add_u32 s37, s37, 19043328
 s_cmp_lt_u32 s52, 6
 s_cselect_b32 s37, s37, 2146435072
 s_add_u32 m0, s65, 65536
 s_nop 0
 buffer_load_dwordx4 v0, s[4:7], s37 offen sc1 lds
 ds_read_b128 a[244:247], v0 offset:54272
 s_waitcnt lgkmcnt(3)
 v_mfma_f32_32x32x16_bf16 v[192:207], a[248:251], v[128:131], v[192:207]
 ds_read_b128 a[248:251], v0 offset:55296
 s_waitcnt lgkmcnt(3)
 v_mfma_f32_32x32x16_bf16 v[208:223], a[252:255], v[128:131], v[208:223]
 ds_read_b128 a[252:255], v0 offset:56320
 s_waitcnt lgkmcnt(3)
 v_mfma_f32_32x32x16_bf16 v[160:175], a[240:243], v[132:135], v[160:175]
 buffer_load_dwordx4 v0, s[4:7], s37 offen offset:1024 sc1 lds
 ds_read_b128 a[240:243], v0 offset:57344
 s_waitcnt lgkmcnt(3)
 v_mfma_f32_32x32x16_bf16 v[176:191], a[244:247], v[132:135], v[176:191]
 ds_read_b128 a[244:247], v0 offset:58368
 s_waitcnt lgkmcnt(3)
 v_mfma_f32_32x32x16_bf16 v[192:207], a[248:251], v[132:135], v[192:207]
 buffer_load_dwordx4 v0, s[4:7], s37 offen offset:2048 sc1 lds
 ds_read_b128 a[248:251], v0 offset:59392
 s_waitcnt lgkmcnt(3)
 v_mfma_f32_32x32x16_bf16 v[208:223], a[252:255], v[132:135], v[208:223]
 ds_read_b128 a[252:255], v0 offset:60416
 s_waitcnt lgkmcnt(3)
 v_mfma_f32_32x32x16_bf16 v[160:175], a[240:243], v[136:139], v[160:175]
 buffer_load_dwordx4 v0, s[4:7], s37 offen offset:3072 sc1 lds
 s_add_u32 s37, s37, 16384
 ds_read_b128 a[240:243], v0 offset:61440
 s_waitcnt lgkmcnt(3)
 v_mfma_f32_32x32x16_bf16 v[176:191], a[244:247], v[136:139], v[176:191]
 s_add_u32 m0, s65, 81920
 s_nop 0
 buffer_load_dwordx4 v0, s[4:7], s37 offen sc1 lds
 ds_read_b128 a[244:247], v0 offset:62464
 s_waitcnt lgkmcnt(3)
 v_mfma_f32_32x32x16_bf16 v[192:207], a[248:251], v[136:139], v[192:207]
 ds_read_b128 a[248:251], v0 offset:63488
 s_waitcnt lgkmcnt(3)
 v_mfma_f32_32x32x16_bf16 v[208:223], a[252:255], v[136:139], v[208:223]
 buffer_load_dwordx4 v0, s[4:7], s37 offen offset:1024 sc1 lds
 ds_read_b128 a[252:255], v0 offset:64512
 s_waitcnt lgkmcnt(3)
 v_mfma_f32_32x32x16_bf16 v[160:175], a[240:243], v[140:143], v[160:175]
 s_waitcnt vmcnt(16)
 s_barrier
 ds_read_b128 a[240:243], v0 offset:0
 s_waitcnt lgkmcnt(3)
 v_mfma_f32_32x32x16_bf16 v[176:191], a[244:247], v[140:143], v[176:191]
 ds_read_b128 a[244:247], v0 offset:1024
 s_waitcnt lgkmcnt(3)
 v_mfma_f32_32x32x16_bf16 v[192:207], a[248:251], v[140:143], v[192:207]
 buffer_load_dwordx4 v0, s[4:7], s37 offen offset:2048 sc1 lds
 ds_read_b128 a[248:251], v0 offset:2048
 s_waitcnt lgkmcnt(3)
 v_mfma_f32_32x32x16_bf16 v[208:223], a[252:255], v[140:143], v[208:223]
 ds_read_b128 a[252:255], v0 offset:3072
 s_waitcnt lgkmcnt(3)
 v_mfma_f32_32x32x16_bf16 v[160:175], a[240:243], v[144:147], v[160:175]
 buffer_load_dwordx4 v0, s[4:7], s37 offen offset:3072 sc1 lds
 s_add_u32 s37, s37, 16384
 ds_read_b128 a[240:243], v0 offset:4096
 v_add_f32 v240, v240, v248
 v_add_f32 v241, v241, v249
 s_waitcnt lgkmcnt(3)
 v_mfma_f32_32x32x16_bf16 v[176:191], a[244:247], v[144:147], v[176:191]
 ds_read_b128 a[244:247], v0 offset:5120
 v_add_f32 v242, v242, v250
 v_add_f32 v243, v243, v251
 s_waitcnt lgkmcnt(3)
 v_mfma_f32_32x32x16_bf16 v[192:207], a[248:251], v[144:147], v[192:207]
 ds_read_b128 a[248:251], v0 offset:6144
 v_add_f32 v244, v244, v252
 v_add_f32 v245, v245, v253
 s_waitcnt lgkmcnt(3)
 v_mfma_f32_32x32x16_bf16 v[208:223], a[252:255], v[144:147], v[208:223]
 ds_read_b128 a[252:255], v0 offset:7168
 v_add_f32 v246, v246, v254
 v_add_f32 v247, v247, v255
 s_waitcnt lgkmcnt(3)
 v_mfma_f32_32x32x16_bf16 v[160:175], a[240:243], v[148:151], v[160:175]
 ds_read_b128 a[240:243], v0 offset:8192
 v_add_f32 v240, v240, v244
 v_add_f32 v241, v241, v245
 s_waitcnt lgkmcnt(3)
 v_mfma_f32_32x32x16_bf16 v[176:191], a[244:247], v[148:151], v[176:191]
 ds_read_b128 a[244:247], v0 offset:9216
 v_add_f32 v242, v242, v246
 v_add_f32 v243, v243, v247
 s_waitcnt lgkmcnt(3)
 v_mfma_f32_32x32x16_bf16 v[192:207], a[248:251], v[148:151], v[192:207]
 ds_read_b128 a[248:251], v0 offset:10240
 v_add_f32 v240, v240, v242
 v_add_f32 v241, v241, v243
 s_waitcnt lgkmcnt(3)
 v_mfma_f32_32x32x16_bf16 v[208:223], a[252:255], v[148:151], v[208:223]
 ds_read_b128 a[252:255], v0 offset:11264
 v_add_f32 v240, v240, v241
 v_mov_b32 v241, v240
 s_waitcnt lgkmcnt(3)
 v_mfma_f32_32x32x16_bf16 v[160:175], a[240:243], v[152:155], v[160:175]
 ds_read_b128 a[240:243], v0 offset:12288
 v_permlane32_swap_b32 v240, v241
 v_mul_f32 v240, 0xbb000000, v240
 s_waitcnt lgkmcnt(3)
 v_mfma_f32_32x32x16_bf16 v[176:191], a[244:247], v[152:155], v[176:191]
 ds_read_b128 a[244:247], v0 offset:13312
 v_mul_f32 v241, 0x3b000000, v241
 v_fma_f32 v241, -v240, v240, v241
 s_waitcnt lgkmcnt(3)
 v_mfma_f32_32x32x16_bf16 v[192:207], a[248:251], v[152:155], v[192:207]
 ds_read_b128 a[248:251], v0 offset:14336
 v_max_f32 v241, 0, v241
 v_add_f32 v241, 0x3727c5ac, v241
 s_waitcnt lgkmcnt(3)
 v_mfma_f32_32x32x16_bf16 v[208:223], a[252:255], v[152:155], v[208:223]
 ds_read_b128 a[252:255], v0 offset:15360
 v_rsq_f32 v3, v241
 v_cvt_pk_bf16_f32 v8, v240, v240
 s_waitcnt lgkmcnt(3)
 v_mfma_f32_32x32x16_bf16 v[160:175], a[240:243], v[156:159], v[160:175]
 s_waitcnt vmcnt(12)
 s_barrier
 v_add_u32 v29, 98304, v28
 ds_read2_b32 a[240:241], v29 offset0:0 offset1:32
 ds_read2_b32 a[242:243], v29 offset0:64 offset1:96
 v_mov_b32 v9, v8
 v_mov_b32 v10, v8
 s_waitcnt lgkmcnt(4)
 v_mfma_f32_32x32x16_bf16 v[176:191], a[244:247], v[156:159], v[176:191]
 v_add_u32 v29, 99328, v28
 ds_read2_b32 a[244:245], v29 offset0:0 offset1:32
 ds_read2_b32 a[246:247], v29 offset0:64 offset1:96
 v_mov_b32 v11, v8
 v_mul_f32 v3, v3, v3
 s_waitcnt lgkmcnt(5)
 v_mfma_f32_32x32x16_bf16 v[192:207], a[248:251], v[156:159], v[192:207]
 v_add_u32 v29, 100352, v28
 ds_read2_b32 a[248:249], v29 offset0:0 offset1:32
 ds_read2_b32 a[250:251], v29 offset0:64 offset1:96
 s_waitcnt lgkmcnt(6)
 v_mfma_f32_32x32x16_bf16 v[208:223], a[252:255], v[156:159], v[208:223]
 v_add_u32 v29, 101376, v28
 ds_read2_b32 a[252:253], v29 offset0:0 offset1:32
 ds_read2_b32 a[254:255], v29 offset0:64 offset1:96
 s_waitcnt lgkmcnt(6)
 v_mfma_f32_32x32x16_bf16 v[160:175], a[240:243], v[8:11], v[160:175]
 ds_read_b128 a[240:243], v0 offset:16384
 s_waitcnt lgkmcnt(5)
 v_mfma_f32_32x32x16_bf16 v[176:191], a[244:247], v[8:11], v[176:191]
 ds_read_b128 a[244:247], v0 offset:17408
 s_waitcnt lgkmcnt(4)
 v_mfma_f32_32x32x16_bf16 v[192:207], a[248:251], v[8:11], v[192:207]
 ds_read_b128 a[248:251], v0 offset:18432
 s_waitcnt lgkmcnt(3)
 v_mfma_f32_32x32x16_bf16 v[208:223], a[252:255], v[8:11], v[208:223]
 ds_read_b128 a[252:255], v0 offset:19456
 s_waitcnt lgkmcnt(3)
 v_mfma_f32_32x32x16_bf16 v[224:239], a[240:243], v[156:159], 0
 ds_read_b128 a[240:243], v0 offset:20480
 s_waitcnt lgkmcnt(3)
 v_mfma_f32_32x32x16_bf16 v[224:239], a[244:247], v[152:155], v[224:239]
 ds_read_b128 a[244:247], v0 offset:21504
 v_mul_f32 v160, v3, v160
 v_mul_f32 v161, v3, v161
 v_mul_f32 v162, v3, v162
 v_mul_f32 v163, v3, v163
 v_mul_f32 v164, v3, v164
 s_waitcnt lgkmcnt(3)
 v_mfma_f32_32x32x16_bf16 v[224:239], a[248:251], v[148:151], v[224:239]
 ds_read_b128 a[248:251], v0 offset:22528
 v_mul_f32 v165, v3, v165
 v_mul_f32 v166, v3, v166
 v_mul_f32 v167, v3, v167
 v_mul_f32 v160, v160, v168
 s_waitcnt lgkmcnt(3)
 v_mfma_f32_32x32x16_bf16 v[224:239], a[252:255], v[144:147], v[224:239]
 ds_read_b128 a[252:255], v0 offset:23552
 v_mul_f32 v161, v161, v169
 v_mul_f32 v162, v162, v170
 v_mul_f32 v163, v163, v171
 v_mul_f32 v164, v164, v172
 v_mul_f32 v165, v165, v173
 s_waitcnt lgkmcnt(3)
 v_mfma_f32_32x32x16_bf16 v[224:239], a[240:243], v[140:143], v[224:239]
 ds_read_b128 a[240:243], v0 offset:24576
 v_mul_f32 v166, v166, v174
 v_mul_f32 v167, v167, v175
 v_cvt_pk_bf16_f32 v160, v160, v161
 v_cvt_pk_bf16_f32 v161, v162, v163
 s_waitcnt lgkmcnt(3)
 v_mfma_f32_32x32x16_bf16 v[224:239], a[244:247], v[136:139], v[224:239]
 ds_read_b128 a[244:247], v0 offset:25600
 v_cvt_pk_bf16_f32 v162, v164, v165
 v_cvt_pk_bf16_f32 v163, v166, v167
 buffer_store_dwordx4 v[160:163], v0, s[4:7], s33 offen
 v_mul_f32 v176, v3, v176
 v_mul_f32 v177, v3, v177
 s_waitcnt lgkmcnt(3)
 v_mfma_f32_32x32x16_bf16 v[224:239], a[248:251], v[132:135], v[224:239]
 ds_read_b128 a[248:251], v0 offset:26624
 v_mul_f32 v178, v3, v178
 v_mul_f32 v179, v3, v179
 v_mul_f32 v180, v3, v180
 v_mul_f32 v181, v3, v181
 s_waitcnt lgkmcnt(3)
 v_mfma_f32_32x32x16_bf16 v[224:239], a[252:255], v[128:131], v[224:239]
 ds_read_b128 a[252:255], v0 offset:27648
 v_mul_f32 v182, v3, v182
 v_mul_f32 v183, v3, v183
 v_mul_f32 v176, v176, v184
 v_mul_f32 v177, v177, v185
 v_mul_f32 v178, v178, v186
 s_waitcnt lgkmcnt(3)
 v_mfma_f32_32x32x16_bf16 v[224:239], a[240:243], v[124:127], v[224:239]
 ds_read_b128 a[240:243], v0 offset:28672
 v_mul_f32 v179, v179, v187
 v_mul_f32 v180, v180, v188
 v_mul_f32 v181, v181, v189
 v_mul_f32 v182, v182, v190
 s_waitcnt lgkmcnt(3)
 v_mfma_f32_32x32x16_bf16 v[224:239], a[244:247], v[120:123], v[224:239]
 ds_read_b128 a[244:247], v0 offset:29696
 v_mul_f32 v183, v183, v191
 v_cvt_pk_bf16_f32 v176, v176, v177
 v_cvt_pk_bf16_f32 v177, v178, v179
 v_cvt_pk_bf16_f32 v178, v180, v181
 v_cvt_pk_bf16_f32 v179, v182, v183
 s_waitcnt lgkmcnt(3)
 v_mfma_f32_32x32x16_bf16 v[224:239], a[248:251], v[116:119], v[224:239]
 ds_read_b128 a[248:251], v0 offset:30720
 buffer_store_dwordx4 v[176:179], v0, s[4:7], s33 offen offset:1024
 v_mul_f32 v192, v3, v192
 v_mul_f32 v193, v3, v193
 v_mul_f32 v194, v3, v194
 s_waitcnt lgkmcnt(3)
 v_mfma_f32_32x32x16_bf16 v[224:239], a[252:255], v[112:115], v[224:239]
 ds_read_b128 a[252:255], v0 offset:31744
 v_mul_f32 v195, v3, v195
 v_mul_f32 v196, v3, v196
 v_mul_f32 v197, v3, v197
 v_mul_f32 v198, v3, v198
 v_mul_f32 v199, v3, v199
 s_waitcnt lgkmcnt(3)
 v_mfma_f32_32x32x16_bf16 v[224:239], a[240:243], v[108:111], v[224:239]
 s_waitcnt vmcnt(6)
 s_barrier
 ds_read_b128 a[240:243], v0 offset:32768
 v_mul_f32 v192, v192, v200
 v_mul_f32 v193, v193, v201
 v_mul_f32 v194, v194, v202
 v_mul_f32 v195, v195, v203
 s_waitcnt lgkmcnt(3)
 v_mfma_f32_32x32x16_bf16 v[224:239], a[244:247], v[104:107], v[224:239]
 ds_read_b128 a[244:247], v0 offset:33792
 v_mul_f32 v196, v196, v204
 v_mul_f32 v197, v197, v205
 v_mul_f32 v198, v198, v206
 v_mul_f32 v199, v199, v207
 v_cvt_pk_bf16_f32 v192, v192, v193
 s_waitcnt lgkmcnt(3)
 v_mfma_f32_32x32x16_bf16 v[224:239], a[248:251], v[100:103], v[224:239]
 ds_read_b128 a[248:251], v0 offset:34816
 v_cvt_pk_bf16_f32 v193, v194, v195
 v_cvt_pk_bf16_f32 v194, v196, v197
 v_cvt_pk_bf16_f32 v195, v198, v199
 buffer_store_dwordx4 v[192:195], v0, s[4:7], s33 offen offset:2048
 s_waitcnt lgkmcnt(3)
 v_mfma_f32_32x32x16_bf16 v[224:239], a[252:255], v[96:99], v[224:239]
 ds_read_b128 a[252:255], v0 offset:35840
 v_mul_f32 v208, v3, v208
 v_mul_f32 v209, v3, v209
 v_mul_f32 v210, v3, v210
 v_mul_f32 v211, v3, v211
 v_mul_f32 v212, v3, v212
 s_waitcnt lgkmcnt(3)
 v_mfma_f32_32x32x16_bf16 v[224:239], a[240:243], v[92:95], v[224:239]
 ds_read_b128 a[240:243], v0 offset:36864
 v_mul_f32 v213, v3, v213
 v_mul_f32 v214, v3, v214
 v_mul_f32 v215, v3, v215
 v_mul_f32 v208, v208, v216
 s_waitcnt lgkmcnt(3)
 v_mfma_f32_32x32x16_bf16 v[224:239], a[244:247], v[88:91], v[224:239]
 ds_read_b128 a[244:247], v0 offset:37888
 v_mul_f32 v209, v209, v217
 v_mul_f32 v210, v210, v218
 v_mul_f32 v211, v211, v219
 v_mul_f32 v212, v212, v220
 v_mul_f32 v213, v213, v221
 s_waitcnt lgkmcnt(3)
 v_mfma_f32_32x32x16_bf16 v[224:239], a[248:251], v[84:87], v[224:239]
 ds_read_b128 a[248:251], v0 offset:38912
 v_mul_f32 v214, v214, v222
 v_mul_f32 v215, v215, v223
 v_cvt_pk_bf16_f32 v208, v208, v209
 v_cvt_pk_bf16_f32 v209, v210, v211
 s_waitcnt lgkmcnt(3)
 v_mfma_f32_32x32x16_bf16 v[224:239], a[252:255], v[80:83], v[224:239]
 ds_read_b128 a[252:255], v0 offset:39936
 v_cvt_pk_bf16_f32 v210, v212, v213
 v_cvt_pk_bf16_f32 v211, v214, v215
 buffer_store_dwordx4 v[208:211], v0, s[4:7], s33 offen offset:3072
 s_waitcnt lgkmcnt(3)
 v_mfma_f32_32x32x16_bf16 v[224:239], a[240:243], v[76:79], v[224:239]
 ds_read_b128 a[240:243], v0 offset:40960
 s_waitcnt lgkmcnt(3)
 v_mfma_f32_32x32x16_bf16 v[224:239], a[244:247], v[72:75], v[224:239]
 ds_read_b128 a[244:247], v0 offset:41984
 s_waitcnt lgkmcnt(3)
 v_mfma_f32_32x32x16_bf16 v[224:239], a[248:251], v[68:71], v[224:239]
 ds_read_b128 a[248:251], v0 offset:43008
 s_waitcnt lgkmcnt(3)
 v_mfma_f32_32x32x16_bf16 v[224:239], a[252:255], v[64:67], v[224:239]
 ds_read_b128 a[252:255], v0 offset:44032
 s_waitcnt lgkmcnt(3)
 v_mfma_f32_32x32x16_bf16 v[224:239], a[240:243], v[60:63], v[224:239]
 ds_read_b128 a[240:243], v0 offset:45056
 s_waitcnt lgkmcnt(3)
 v_mfma_f32_32x32x16_bf16 v[224:239], a[244:247], v[56:59], v[224:239]
 ds_read_b128 a[244:247], v0 offset:46080
 s_waitcnt lgkmcnt(3)
 v_mfma_f32_32x32x16_bf16 v[224:239], a[248:251], v[52:55], v[224:239]
 ds_read_b128 a[248:251], v0 offset:47104
 s_waitcnt lgkmcnt(3)
 v_mfma_f32_32x32x16_bf16 v[224:239], a[252:255], v[48:51], v[224:239]
 ds_read_b128 a[252:255], v0 offset:48128
 s_waitcnt lgkmcnt(3)
 v_mfma_f32_32x32x16_bf16 v[224:239], a[240:243], v[44:47], v[224:239]
 v_add_u32 v29, 102400, v28
 ds_read2_b32 a[240:241], v29 offset0:0 offset1:32
 ds_read2_b32 a[242:243], v29 offset0:64 offset1:96
 s_waitcnt lgkmcnt(4)
 v_mfma_f32_32x32x16_bf16 v[224:239], a[244:247], v[40:43], v[224:239]
 ds_read_b128 a[244:247], v30 offset:0
 s_waitcnt lgkmcnt(4)
 v_mfma_f32_32x32x16_bf16 v[224:239], a[248:251], v[36:39], v[224:239]
 ds_read_b128 a[248:251], v30 offset:1024
 v_mov_b32 v2, s55
 s_cmp_lg_u32 s68, 0
 s_mov_b64 exec, 1
 s_waitcnt vmcnt(0)
 s_cbranch_scc1 L108_rel
 buffer_store_dword v2, v0, s[4:7], s36 offen
L109_relb:
 s_mov_b64 exec, -1
 s_waitcnt lgkmcnt(4)
 v_mfma_f32_32x32x16_bf16 v[224:239], a[252:255], v[32:35], v[224:239]
 ds_read_b128 a[252:255], v30 offset:2048
 s_waitcnt lgkmcnt(3)
 v_mfma_f32_32x32x16_bf16 v[224:239], a[240:243], v[8:11], v[224:239]
 ds_read_b128 a[240:243], v30 offset:3072
 s_cmp_ge_u32 s52, 6
 s_cbranch_scc1 L110_five
 s_waitcnt lgkmcnt(3)
 v_mfma_f32_32x32x16_bf16 v[240:255], a[244:247], v[156:159], 0
 ds_read_b128 a[244:247], v30 offset:4096
 s_waitcnt lgkmcnt(3)
 v_mfma_f32_32x32x16_bf16 v[240:255], a[248:251], v[152:155], v[240:255]
 ds_read_b128 a[248:251], v30 offset:5120
 s_nop 2
 v_mul_f32 v224, v3, v224
 v_mul_f32 v225, v3, v225
 v_mul_f32 v226, v3, v226
 v_mul_f32 v227, v3, v227
 s_waitcnt lgkmcnt(3)
 v_mfma_f32_32x32x16_bf16 v[240:255], a[252:255], v[148:151], v[240:255]
 ds_read_b128 a[252:255], v30 offset:6144
 v_mul_f32 v228, v3, v228
 v_mul_f32 v229, v3, v229
 v_mul_f32 v230, v3, v230
 v_mul_f32 v231, v3, v231
 s_waitcnt lgkmcnt(3)
 v_mfma_f32_32x32x16_bf16 v[240:255], a[240:243], v[144:147], v[240:255]
 ds_read_b128 a[240:243], v30 offset:7168
 buffer_load_dword v160, v4, s[4:7], s26 offen sc1
 v_mul_f32 v224, v224, v232
 v_mul_f32 v225, v225, v233
 v_mul_f32 v226, v226, v234
 v_mul_f32 v227, v227, v235
 s_waitcnt lgkmcnt(3)
 v_mfma_f32_32x32x16_bf16 v[240:255], a[244:247], v[140:143], v[240:255]
 ds_read_b128 a[244:247], v30 offset:8192
 v_mul_f32 v228, v228, v236
 v_mul_f32 v229, v229, v237
 v_mul_f32 v230, v230, v238
 v_mul_f32 v231, v231, v239
 s_waitcnt lgkmcnt(3)
 v_mfma_f32_32x32x16_bf16 v[240:255], a[248:251], v[136:139], v[240:255]
 ds_read_b128 a[248:251], v30 offset:9216
 v_cvt_pk_bf16_f32 v224, v224, v225
 v_cvt_pk_bf16_f32 v225, v226, v227
 v_cvt_pk_bf16_f32 v226, v228, v229
 v_cvt_pk_bf16_f32 v227, v230, v231
 s_waitcnt lgkmcnt(3)
 v_mfma_f32_32x32x16_bf16 v[240:255], a[252:255], v[132:135], v[240:255]
 ds_read_b128 a[252:255], v30 offset:10240
 buffer_store_dwordx4 v[224:227], v0, s[4:7], s34 offen
 s_waitcnt lgkmcnt(3)
 v_mfma_f32_32x32x16_bf16 v[240:255], a[240:243], v[128:131], v[240:255]
 ds_read_b128 a[240:243], v30 offset:11264
 s_waitcnt lgkmcnt(3)
 v_mfma_f32_32x32x16_bf16 v[240:255], a[244:247], v[124:127], v[240:255]
 ds_read_b128 a[244:247], v30 offset:12288
 s_waitcnt lgkmcnt(3)
 v_mfma_f32_32x32x16_bf16 v[240:255], a[248:251], v[120:123], v[240:255]
 ds_read_b128 a[248:251], v30 offset:13312
 s_waitcnt lgkmcnt(3)
 v_mfma_f32_32x32x16_bf16 v[240:255], a[252:255], v[116:119], v[240:255]
 ds_read_b128 a[252:255], v30 offset:14336
 s_waitcnt vmcnt(1)
 v_cmp_ne_u32 vcc, s55, v160
 s_cbranch_vccnz L116_spin
L117_got:
 buffer_load_dwordx4 v[160:163], v0, s[4:7], s42 offen sc1
 s_waitcnt lgkmcnt(3)
 v_mfma_f32_32x32x16_bf16 v[240:255], a[240:243], v[112:115], v[240:255]
 ds_read_b128 a[240:243], v30 offset:15360
 s_waitcnt lgkmcnt(3)
 v_mfma_f32_32x32x16_bf16 v[240:255], a[244:247], v[108:111], v[240:255]
 s_barrier
 ds_read_b128 a[244:247], v30 offset:16384
 buffer_load_dwordx4 v[164:167], v0, s[4:7], s42 offen offset:1024 sc1
 s_waitcnt lgkmcnt(3)
 v_mfma_f32_32x32x16_bf16 v[240:255], a[248:251], v[104:107], v[240:255]
 ds_read_b128 a[248:251], v30 offset:17408
 s_waitcnt lgkmcnt(3)
 v_mfma_f32_32x32x16_bf16 v[240:255], a[252:255], v[100:103], v[240:255]
 ds_read_b128 a[252:255], v30 offset:18432
 buffer_load_dwordx4 v[168:171], v0, s[4:7], s42 offen offset:2048 sc1
 s_waitcnt lgkmcnt(3)
 v_mfma_f32_32x32x16_bf16 v[240:255], a[240:243], v[96:99], v[240:255]
 ds_read_b128 a[240:243], v30 offset:19456
 s_waitcnt lgkmcnt(3)
 v_mfma_f32_32x32x16_bf16 v[240:255], a[244:247], v[92:95], v[240:255]
 ds_read_b128 a[244:247], v30 offset:20480
 v_mov_b32 v2, s55
 s_cmp_lg_u32 s68, 0
 s_mov_b64 exec, 1
 s_waitcnt vmcnt(3)
 s_cbranch_scc1 L118_rel
 buffer_store_dword v2, v0, s[4:7], s38 offen
L119_relb:
 s_mov_b64 exec, -1
 buffer_load_dwordx4 v[172:175], v0, s[4:7], s42 offen offset:3072 sc1
 s_waitcnt lgkmcnt(3)
 v_mfma_f32_32x32x16_bf16 v[240:255], a[248:251], v[88:91], v[240:255]
 ds_read_b128 a[248:251], v30 offset:21504
 s_waitcnt lgkmcnt(3)
 v_mfma_f32_32x32x16_bf16 v[240:255], a[252:255], v[84:87], v[240:255]
 ds_read_b128 a[252:255], v30 offset:22528
 s_add_u32 s46, s42, 4096
 buffer_load_dwordx4 v[176:179], v0, s[4:7], s46 offen offset:1024 sc1
 s_waitcnt lgkmcnt(3)
 v_mfma_f32_32x32x16_bf16 v[240:255], a[240:243], v[80:83], v[240:255]
 ds_read_b128 a[240:243], v30 offset:23552
 s_waitcnt lgkmcnt(3)
 v_mfma_f32_32x32x16_bf16 v[240:255], a[244:247], v[76:79], v[240:255]
 ds_read_b128 a[244:247], v30 offset:24576
 buffer_load_dwordx4 v[180:183], v0, s[4:7], s46 offen offset:2048 sc1
 s_waitcnt lgkmcnt(3)
 v_mfma_f32_32x32x16_bf16 v[240:255], a[248:251], v[72:75], v[240:255]
 ds_read_b128 a[248:251], v30 offset:25600
 s_waitcnt lgkmcnt(3)
 v_mfma_f32_32x32x16_bf16 v[240:255], a[252:255], v[68:71], v[240:255]
 ds_read_b128 a[252:255], v30 offset:26624
 buffer_load_dwordx4 v[184:187], v0, s[4:7], s46 offen offset:3072 sc1
 s_waitcnt lgkmcnt(3)
 v_mfma_f32_32x32x16_bf16 v[240:255], a[240:243], v[64:67], v[240:255]
 ds_read_b128 a[240:243], v30 offset:27648
 s_waitcnt lgkmcnt(3)
 v_mfma_f32_32x32x16_bf16 v[240:255], a[244:247], v[60:63], v[240:255]
 ds_read_b128 a[244:247], v30 offset:28672
 s_add_u32 s46, s42, 8192
 buffer_load_dwordx4 v[188:191], v0, s[4:7], s46 offen sc1
 s_waitcnt lgkmcnt(3)
 v_mfma_f32_32x32x16_bf16 v[240:255], a[248:251], v[56:59], v[240:255]
 ds_read_b128 a[248:251], v30 offset:29696
 s_waitcnt lgkmcnt(3)
 v_mfma_f32_32x32x16_bf16 v[240:255], a[252:255], v[52:55], v[240:255]
 ds_read_b128 a[252:255], v30 offset:30720
 buffer_load_dwordx4 v[192:195], v0, s[4:7], s46 offen offset:2048 sc1
 s_waitcnt lgkmcnt(3)
 v_mfma_f32_32x32x16_bf16 v[240:255], a[240:243], v[48:51], v[240:255]
 ds_read_b128 a[240:243], v30 offset:31744
 s_waitcnt lgkmcnt(3)
 v_mfma_f32_32x32x16_bf16 v[240:255], a[244:247], v[44:47], v[240:255]
 v_add_u32 v29, 103424, v28
 ds_read2_b32 a[244:245], v29 offset0:0 offset1:32
 ds_read2_b32 a[246:247], v29 offset0:64 offset1:96
 buffer_load_dwordx4 v[196:199], v0, s[4:7], s46 offen offset:3072 sc1
 s_waitcnt lgkmcnt(4)
 v_mfma_f32_32x32x16_bf16 v[240:255], a[248:251], v[40:43], v[240:255]
 s_waitcnt lgkmcnt(3)
 v_mfma_f32_32x32x16_bf16 v[240:255], a[252:255], v[36:39], v[240:255]
 s_add_u32 s46, s42, 12288
 buffer_load_dwordx4 v[200:203], v0, s[4:7], s46 offen sc1
 s_waitcnt lgkmcnt(2)
 v_mfma_f32_32x32x16_bf16 v[240:255], a[240:243], v[32:35], v[240:255]
 s_waitcnt lgkmcnt(0)
 v_mfma_f32_32x32x16_bf16 v[240:255], a[244:247], v[8:11], v[240:255]
 buffer_load_dwordx4 v[204:207], v0, s[4:7], s46 offen offset:1024 sc1
 s_nop 10
 v_pk_mul_f32 v[240:241], v[2:3], v[240:241] op_sel:[1,0]
 v_pk_mul_f32 v[242:243], v[2:3], v[242:243] op_sel:[1,0]
 v_pk_mul_f32 v[244:245], v[2:3], v[244:245] op_sel:[1,0]
 v_pk_mul_f32 v[246:247], v[2:3], v[246:247] op_sel:[1,0]
 v_pk_mul_f32 v[240:241], v[240:241], v[248:249]
 v_pk_mul_f32 v[242:243], v[242:243], v[250:251]
 v_pk_mul_f32 v[244:245], v[244:245], v[252:253]
 v_pk_mul_f32 v[246:247], v[246:247], v[254:255]
 v_cvt_pk_bf16_f32 v240, v240, v241
 v_cvt_pk_bf16_f32 v241, v242, v243
 v_cvt_pk_bf16_f32 v242, v244, v245
 v_cvt_pk_bf16_f32 v243, v246, v247
 buffer_store_dwordx4 v[240:243], v0, s[4:7], s35 offen
L111_gujoin:
 s_waitcnt vmcnt(13)
 v_mfma_f32_32x32x16_bf16 v[32:47], a[56:59], v[160:163], 0
 s_xor_b32 s3, s65, 8192
 v_add_u32 v28, s3, v0
 s_xor_b32 s3, s65, 12288
 v_add_u32 v29, s3, v0
 buffer_load_dwordx4 v[208:211], v0, s[4:7], s46 offen offset:3072 sc1
 buffer_load_dword v3, v4, s[4:7], s26 offen offset:64 sc1
 v_mfma_f32_32x32x16_bf16 v[48:63], a[60:63], v[160:163], 0
 s_xor_b32 s3, s65, 4096
 v_add_u32 v30, s3, v0
 v_add_u32 v31, s65, v0
 v_bfe_u32 v9, v0, 4, 5
 s_waitcnt vmcnt(14)
 v_mfma_f32_32x32x16_bf16 v[32:47], a[64:67], v[164:167], v[32:47]
 v_lshrrev_b32 v10, 9, v0
 v_lshlrev_b32 v10, 4, v10
 v_lshl_add_u32 v9, v9, 10, v10
 s_lshl_b32 s31, s62, 15
 s_add_u32 s46, s42, 16384
 buffer_load_dwordx4 v[212:215], v0, s[4:7], s46 offen sc1
 v_mfma_f32_32x32x16_bf16 v[48:63], a[68:71], v[164:167], v[48:63]
 s_lshl_b32 s29, s64, 6
 s_add_u32 s31, s31, s29
 s_mov_b32 s45, 2146435072
 v_bfe_u32 v8, v0, 2, 5
 s_waitcnt vmcnt(14)
 v_mfma_f32_32x32x16_bf16 v[32:47], a[72:75], v[168:171], v[32:47]
 v_min_u32 v8, 20, v8
 s_lshl_b32 s32, s62, 11
 s_add_u32 s32, s32, 3409280
 buffer_load_dwordx4 v[216:219], v0, s[4:7], s46 offen offset:1024 sc1
 v_mfma_f32_32x32x16_bf16 v[48:63], a[76:79], v[168:171], v[48:63]
 s_waitcnt vmcnt(13)
 v_mfma_f32_32x32x16_bf16 v[32:47], a[80:83], v[172:175], v[32:47]
 buffer_load_dwordx4 v[220:223], v0, s[4:7], s46 offen offset:2048 sc1
 v_mfma_f32_32x32x16_bf16 v[48:63], a[84:87], v[172:175], v[48:63]
 s_waitcnt vmcnt(13)
 v_mfma_f32_32x32x16_bf16 v[32:47], a[96:99], v[176:179], v[32:47]
 buffer_load_dwordx4 v[80:83], v0, s[4:7], s43 offen sc1
 v_mfma_f32_32x32x16_bf16 v[48:63], a[100:103], v[176:179], v[48:63]
 s_waitcnt vmcnt(13)
 v_mfma_f32_32x32x16_bf16 v[32:47], a[104:107], v[180:183], v[32:47]
 buffer_load_dwordx4 v[84:87], v0, s[4:7], s43 offen offset:1024 sc1
 v_mfma_f32_32x32x16_bf16 v[48:63], a[108:111], v[180:183], v[48:63]
 s_waitcnt vmcnt(13)
 v_mfma_f32_32x32x16_bf16 v[32:47], a[112:115], v[184:187], v[32:47]
 buffer_load_dwordx4 v[88:91], v0, s[4:7], s43 offen offset:2048 sc1
 v_mfma_f32_32x32x16_bf16 v[48:63], a[116:119], v[184:187], v[48:63]
 s_waitcnt vmcnt(13)
 v_mfma_f32_32x32x16_bf16 v[32:47], a[120:123], v[188:191], v[32:47]
 buffer_load_dwordx4 v[92:95], v0, s[4:7], s43 offen offset:3072 sc1
 v_mfma_f32_32x32x16_bf16 v[48:63], a[124:127], v[188:191], v[48:63]
 v_mov_b32 v2, s55
 s_cmp_lg_u32 s68, 0
 s_mov_b64 exec, 1
 s_waitcnt vmcnt(9)
 s_cbranch_scc1 L120_rel
 buffer_store_dword v2, v0, s[4:7], s39 offen
L121_relb:
 s_mov_b64 exec, -1
 v_mfma_f32_32x32x16_bf16 v[32:47], a[136:139], v[192:195], v[32:47]
 s_waitcnt vmcnt(8)
 v_cmp_ne_u32 vcc, s55, v3
 s_cbranch_vccnz L122_spin
L123_got:
 s_add_u32 s46, s42, 4096
 buffer_load_dwordx4 v[96:99], v0, s[4:7], s46 offen sc1
 v_mfma_f32_32x32x16_bf16 v[48:63], a[140:143], v[192:195], v[48:63]
 v_mfma_f32_32x32x16_bf16 v[32:47], a[144:147], v[196:199], v[32:47]
 s_add_u32 s46, s42, 8192
 buffer_load_dwordx4 v[100:103], v0, s[4:7], s46 offen offset:1024 sc1
 v_mfma_f32_32x32x16_bf16 v[48:63], a[148:151], v[196:199], v[48:63]
 v_mfma_f32_32x32x16_bf16 v[32:47], a[152:155], v[200:203], v[32:47]
 s_add_u32 s46, s42, 12288
 buffer_load_dwordx4 v[104:107], v0, s[4:7], s46 offen offset:2048 sc1
 v_mfma_f32_32x32x16_bf16 v[48:63], a[156:159], v[200:203], v[48:63]
 v_mfma_f32_32x32x16_bf16 v[32:47], a[160:163], v[204:207], v[32:47]
 s_add_u32 s46, s42, 16384
 buffer_load_dwordx4 v[108:111], v0, s[4:7], s46 offen offset:3072 sc1
 v_mfma_f32_32x32x16_bf16 v[48:63], a[164:167], v[204:207], v[48:63]
 v_mfma_f32_32x32x16_bf16 v[32:47], a[176:179], v[208:211], v[32:47]
 s_add_u32 s46, s43, 4096
 buffer_load_dwordx4 v[112:115], v0, s[4:7], s46 offen offset:1024 sc1
 v_mfma_f32_32x32x16_bf16 v[48:63], a[180:183], v[208:211], v[48:63]
 s_barrier
 s_waitcnt vmcnt(12)
 v_mfma_f32_32x32x16_bf16 v[32:47], a[184:187], v[212:215], v[32:47]
 buffer_load_dwordx4 v[116:119], v0, s[4:7], s46 offen offset:2048 sc1
 v_mfma_f32_32x32x16_bf16 v[48:63], a[188:191], v[212:215], v[48:63]
 s_waitcnt vmcnt(12)
 v_mfma_f32_32x32x16_bf16 v[32:47], a[192:195], v[216:219], v[32:47]
 buffer_load_dwordx4 v[120:123], v0, s[4:7], s46 offen offset:3072 sc1
 v_mfma_f32_32x32x16_bf16 v[48:63], a[196:199], v[216:219], v[48:63]
 s_waitcnt vmcnt(12)
 v_mfma_f32_32x32x16_bf16 v[32:47], a[200:203], v[220:223], v[32:47]
 s_add_u32 s46, s43, 8192
 buffer_load_dwordx4 v[124:127], v0, s[4:7], s46 offen sc1
 v_mfma_f32_32x32x16_bf16 v[48:63], a[204:207], v[220:223], v[48:63]
 s_waitcnt vmcnt(12)
 v_mfma_f32_32x32x16_bf16 v[64:79], a[60:63], v[80:83], 0
 buffer_load_dwordx4 v[128:131], v0, s[4:7], s46 offen offset:2048 sc1
 v_mfma_f32_32x32x16_bf16 v[12:27], a[56:59], v[80:83], v[12:27]
 s_waitcnt vmcnt(12)
 v_mfma_f32_32x32x16_bf16 v[64:79], a[68:71], v[84:87], v[64:79]
 buffer_load_dwordx4 v[132:135], v0, s[4:7], s46 offen offset:3072 sc1
 v_mfma_f32_32x32x16_bf16 v[12:27], a[64:67], v[84:87], v[12:27]
 s_waitcnt vmcnt(12)
 v_mfma_f32_32x32x16_bf16 v[64:79], a[76:79], v[88:91], v[64:79]
 s_add_u32 s46, s43, 12288
 buffer_load_dwordx4 v[136:139], v0, s[4:7], s46 offen sc1
 buffer_load_dword v3, v8, s[4:7], s32 offen sc1
 v_mfma_f32_32x32x16_bf16 v[12:27], a[72:75], v[88:91], v[12:27]
 s_waitcnt vmcnt(13)
 v_mfma_f32_32x32x16_bf16 v[64:79], a[84:87], v[92:95], v[64:79]
 buffer_load_dwordx4 v[140:143], v0, s[4:7], s46 offen offset:1024 sc1
 v_mfma_f32_32x32x16_bf16 v[12:27], a[80:83], v[92:95], v[12:27]
 s_waitcnt vmcnt(12)
 v_mfma_f32_32x32x16_bf16 v[32:47], a[88:91], v[96:99], v[32:47]
 buffer_load_dwordx4 v[144:147], v0, s[4:7], s46 offen offset:3072 sc1
 v_mfma_f32_32x32x16_bf16 v[48:63], a[92:95], v[96:99], v[48:63]
 s_waitcnt vmcnt(12)
 v_mfma_f32_32x32x16_bf16 v[32:47], a[128:131], v[100:103], v[32:47]
 s_add_u32 s46, s43, 16384
 buffer_load_dwordx4 v[148:151], v0, s[4:7], s46 offen sc1
 v_mfma_f32_32x32x16_bf16 v[48:63], a[132:135], v[100:103], v[48:63]
 s_waitcnt vmcnt(12)
 v_mfma_f32_32x32x16_bf16 v[32:47], a[168:171], v[104:107], v[32:47]
 buffer_load_dwordx4 v[152:155], v0, s[4:7], s46 offen offset:1024 sc1
 v_mfma_f32_32x32x16_bf16 v[48:63], a[172:175], v[104:107], v[48:63]
 s_waitcnt vmcnt(12)
 v_mfma_f32_32x32x16_bf16 v[32:47], a[208:211], v[108:111], v[32:47]
 buffer_load_dwordx4 v[156:159], v0, s[4:7], s46 offen offset:2048 sc1
 v_mfma_f32_32x32x16_bf16 v[48:63], a[212:215], v[108:111], v[48:63]
 s_waitcnt vmcnt(12)
 v_mfma_f32_32x32x16_bf16 v[64:79], a[100:103], v[112:115], v[64:79]
 s_add_u32 s46, s43, 4096
 buffer_load_dwordx4 v[224:227], v0, s[4:7], s46 offen sc1
 v_mfma_f32_32x32x16_bf16 v[12:27], a[96:99], v[112:115], v[12:27]
 s_waitcnt vmcnt(12)
 v_mfma_f32_32x32x16_bf16 v[64:79], a[108:111], v[116:119], v[64:79]
 s_add_u32 s46, s43, 8192
 buffer_load_dwordx4 v[228:231], v0, s[4:7], s46 offen offset:1024 sc1
 v_mfma_f32_32x32x16_bf16 v[12:27], a[104:107], v[116:119], v[12:27]
 ds_write_b128 v28, v[32:35] offset:0
 s_waitcnt vmcnt(12)
 v_mfma_f32_32x32x16_bf16 v[64:79], a[116:119], v[120:123], v[64:79]
 s_add_u32 s46, s43, 12288
 buffer_load_dwordx4 v[232:235], v0, s[4:7], s46 offen offset:2048 sc1
 v_mfma_f32_32x32x16_bf16 v[12:27], a[112:115], v[120:123], v[12:27]
 ds_write_b128 v28, v[36:39] offset:1024
 s_waitcnt vmcnt(12)
 v_mfma_f32_32x32x16_bf16 v[64:79], a[124:127], v[124:127], v[64:79]
 s_add_u32 s46, s43, 16384
 buffer_load_dwordx4 v[236:239], v0, s[4:7], s46 offen offset:3072 sc1
 v_mfma_f32_32x32x16_bf16 v[12:27], a[120:123], v[124:127], v[12:27]
 ds_write_b128 v28, v[40:43] offset:2048
 s_waitcnt vmcnt(12)
 v_mfma_f32_32x32x16_bf16 v[64:79], a[140:143], v[128:131], v[64:79]
 s_waitcnt vmcnt(9)
 v_cmp_ne_u32 vcc, s55, v3
 s_cbranch_vccnz L124_spin
L125_got:
 buffer_load_dwordx4 v[240:243], v0, s[4:7], s44 offen sc1
 v_mfma_f32_32x32x16_bf16 v[12:27], a[136:139], v[128:131], v[12:27]
 ds_write_b128 v28, v[44:47] offset:3072
 v_mfma_f32_32x32x16_bf16 v[64:79], a[148:151], v[132:135], v[64:79]
 buffer_load_dwordx4 v[244:247], v0, s[4:7], s44 offen offset:1024 sc1
 v_mfma_f32_32x32x16_bf16 v[12:27], a[144:147], v[132:135], v[12:27]
 ds_write_b128 v29, v[48:51] offset:16384
 v_mfma_f32_32x32x16_bf16 v[64:79], a[156:159], v[136:139], v[64:79]
 buffer_load_dwordx4 v[248:251], v0, s[4:7], s44 offen offset:2048 sc1
 v_mfma_f32_32x32x16_bf16 v[12:27], a[152:155], v[136:139], v[12:27]
 ds_write_b128 v29, v[52:55] offset:17408
 s_waitcnt vmcnt(11)
 v_mfma_f32_32x32x16_bf16 v[64:79], a[164:167], v[140:143], v[64:79]
 buffer_load_dwordx4 v[252:255], v0, s[4:7], s44 offen offset:3072 sc1
 v_mfma_f32_32x32x16_bf16 v[12:27], a[160:163], v[140:143], v[12:27]
 ds_write_b128 v29, v[56:59] offset:18432
 s_waitcnt vmcnt(11)
 v_mfma_f32_32x32x16_bf16 v[64:79], a[180:183], v[144:147], v[64:79]
 s_add_u32 s46, s44, 4096
 buffer_load_dwordx4 v[160:163], v0, s[4:7], s46 offen sc1
 v_mfma_f32_32x32x16_bf16 v[12:27], a[176:179], v[144:147], v[12:27]
 ds_write_b128 v29, v[60:63] offset:19456
 s_waitcnt vmcnt(11)
 v_mfma_f32_32x32x16_bf16 v[64:79], a[188:191], v[148:151], v[64:79]
 buffer_load_dwordx4 v[164:167], v0, s[4:7], s46 offen offset:1024 sc1
 v_mfma_f32_32x32x16_bf16 v[12:27], a[184:187], v[148:151], v[12:27]
 s_waitcnt lgkmcnt(0)
 s_barrier
 s_waitcnt vmcnt(11)
 v_mfma_f32_32x32x16_bf16 v[64:79], a[196:199], v[152:155], v[64:79]
 ds_read_b128 v[32:35], v31 offset:0
 ds_read_b128 v[48:51], v31 offset:16384
 v_mfma_f32_32x32x16_bf16 v[12:27], a[192:195], v[152:155], v[12:27]
 ds_read_b128 v[36:39], v31 offset:1024
 ds_read_b128 v[52:55], v31 offset:17408
 s_waitcnt vmcnt(10)
 v_mfma_f32_32x32x16_bf16 v[64:79], a[204:207], v[156:159], v[64:79]
 ds_read_b128 v[40:43], v31 offset:2048
 ds_read_b128 v[56:59], v31 offset:18432
 s_waitcnt vmcnt(9)
 v_mfma_f32_32x32x16_bf16 v[64:79], a[92:95], v[224:227], v[64:79]
 ds_read_b128 v[44:47], v31 offset:3072
 ds_read_b128 v[60:63], v31 offset:19456
 s_waitcnt vmcnt(8)
 v_mfma_f32_32x32x16_bf16 v[64:79], a[132:135], v[228:231], v[64:79]
 s_waitcnt vmcnt(7)
 v_mfma_f32_32x32x16_bf16 v[64:79], a[172:175], v[232:235], v[64:79]
 s_waitcnt vmcnt(6)
 v_mfma_f32_32x32x16_bf16 v[64:79], a[212:215], v[236:239], v[64:79]
 v_mfma_f32_32x32x16_bf16 v[12:27], a[200:203], v[156:159], v[12:27]
 s_waitcnt lgkmcnt(6)
 v_add_f32 v32, v32, v48
 v_add_f32 v33, v33, v49
 v_add_f32 v34, v34, v50
 v_add_f32 v35, v35, v51
 s_waitcnt lgkmcnt(4)
 v_add_f32 v36, v36, v52
 v_add_f32 v37, v37, v53
 v_add_f32 v38, v38, v54
 v_add_f32 v39, v39, v55
 v_mfma_f32_32x32x16_bf16 v[12:27], a[88:91], v[224:227], v[12:27]
 s_waitcnt lgkmcnt(2)
 v_add_f32 v40, v40, v56
 v_add_f32 v41, v41, v57
 v_add_f32 v42, v42, v58
 v_add_f32 v43, v43, v59
 s_waitcnt lgkmcnt(0)
 v_add_f32 v44, v44, v60
 v_add_f32 v45, v45, v61
 v_add_f32 v46, v46, v62
 v_add_f32 v47, v47, v63
 v_mfma_f32_32x32x16_bf16 v[12:27], a[128:131], v[228:231], v[12:27]
 ds_write_b128 v30, v[64:67] offset:32768
 v_mfma_f32_32x32x16_bf16 v[12:27], a[168:171], v[232:235], v[12:27]
 ds_write_b128 v30, v[68:71] offset:33792
 v_mfma_f32_32x32x16_bf16 v[12:27], a[208:211], v[236:239], v[12:27]
 ds_write_b128 v30, v[72:75] offset:34816
 s_waitcnt vmcnt(5)
 v_mfma_f32_32x32x16_bf16 v[12:27], a[216:219], v[240:243], v[12:27]
 ds_write_b128 v30, v[76:79] offset:35840
 s_waitcnt vmcnt(4)
 v_mfma_f32_32x32x16_bf16 v[12:27], a[220:223], v[244:247], v[12:27]
 s_waitcnt vmcnt(3)
 v_mfma_f32_32x32x16_bf16 v[12:27], a[224:227], v[248:251], v[12:27]
 s_waitcnt vmcnt(2)
 v_mfma_f32_32x32x16_bf16 v[12:27], a[228:231], v[252:255], v[12:27]
 s_waitcnt lgkmcnt(0)
 s_barrier
 ds_read_b128 v[64:67], v31 offset:32768
 ds_read_b128 v[68:71], v31 offset:33792
 ds_read_b128 v[72:75], v31 offset:34816
 ds_read_b128 v[76:79], v31 offset:35840
 s_waitcnt vmcnt(1)
 v_mfma_f32_32x32x16_bf16 v[12:27], a[232:235], v[160:163], v[12:27]
 s_waitcnt vmcnt(0)
 v_mfma_f32_32x32x16_bf16 v[12:27], a[236:239], v[164:167], v[12:27]
 s_waitcnt lgkmcnt(3)
 v_pk_add_f32 v[32:33], v[32:33], v[64:65]
 v_pk_add_f32 v[34:35], v[34:35], v[66:67]
 s_waitcnt lgkmcnt(2)
 v_pk_add_f32 v[36:37], v[36:37], v[68:69]
 v_pk_add_f32 v[38:39], v[38:39], v[70:71]
 s_waitcnt lgkmcnt(1)
 v_pk_add_f32 v[40:41], v[40:41], v[72:73]
 v_pk_add_f32 v[42:43], v[42:43], v[74:75]
 s_waitcnt lgkmcnt(0)
 v_pk_add_f32 v[44:45], v[44:45], v[76:77]
 v_pk_add_f32 v[46:47], v[46:47], v[78:79]
 v_pk_add_f32 v[12:13], v[12:13], v[32:33]
 v_pk_add_f32 v[14:15], v[14:15], v[34:35]
 v_pk_add_f32 v[16:17], v[16:17], v[36:37]
 v_pk_add_f32 v[18:19], v[18:19], v[38:39]
 v_pk_add_f32 v[20:21], v[20:21], v[40:41]
 v_pk_add_f32 v[22:23], v[22:23], v[42:43]
 v_pk_add_f32 v[24:25], v[24:25], v[44:45]
 v_pk_add_f32 v[26:27], v[26:27], v[46:47]
 v_cvt_pk_bf16_f32 v32, v12, v13
 v_cvt_pk_bf16_f32 v33, v14, v15
 v_cvt_pk_bf16_f32 v34, v16, v17
 v_cvt_pk_bf16_f32 v35, v18, v19
 v_cvt_pk_bf16_f32 v36, v20, v21
 v_cvt_pk_bf16_f32 v37, v22, v23
 v_cvt_pk_bf16_f32 v38, v24, v25
 v_cvt_pk_bf16_f32 v39, v26, v27
 v_permlane32_swap_b32 v32, v34
 v_permlane32_swap_b32 v33, v35
 buffer_store_dwordx4 v[32:35], v9, s[16:19], s31 offen offset:0
 v_permlane32_swap_b32 v36, v38
 v_permlane32_swap_b32 v37, v39
 buffer_store_dwordx4 v[36:39], v9, s[16:19], s31 offen offset:32
 s_endpgm
L_exit:
 s_endpgm
L1_spin:
 buffer_load_dwordx4 v[24:27], v14, s[4:7], s36 offen offset:0 sc1
 s_sub_u32 s57, s57, 1
 s_cbranch_scc1 L1_spin_x
 s_waitcnt vmcnt(0)
 v_xor_b32 v1, s55, v25
 v_xor_b32 v27, s55, v27
 v_or_b32 v1, v1, v27
 v_cmp_ne_u32 vcc, 0, v1
 s_cbranch_vccnz L1_spin
 s_branch L2_got
L1_spin_x:
 s_mov_b32 s57, 0
 s_waitcnt vmcnt(0)
 s_branch L2_got
L3_spin:
 buffer_load_dword v13, v12, s[4:7], 0 offen offset:0 sc1
 s_sub_u32 s57, s57, 1
 s_cbranch_scc1 L3_spin_x
 s_waitcnt vmcnt(0)
 v_and_b32 v1, 0xfffffff0, v13
 v_cmp_ne_u32 vcc, s55, v1
 s_cbranch_vccnz L3_spin
 s_branch L4_got
L3_spin_x:
 s_mov_b32 s57, 0
 s_waitcnt vmcnt(0)
 s_branch L4_got
L8_spin:
 buffer_load_dword v25, v30, s[4:7], s35 offen offset:0 sc1
 s_sub_u32 s57, s57, 1
 s_cbranch_scc1 L8_spin_x
 s_waitcnt vmcnt(0)
 v_cmp_ne_u32 vcc, s55, v25
 s_cbranch_vccnz L8_spin
 s_branch L9_got
L8_spin_x:
 s_mov_b32 s57, 0
 s_waitcnt vmcnt(0)
 s_branch L9_got
L10_x:
 s_waitcnt lgkmcnt(0)
 v_mfma_f32_32x32x16_bf16 v[80:95], v[244:247], v[100:103], v[80:95]
 s_waitcnt vmcnt(0)
 buffer_load_dwordx4 a[64:67], v0, s[4:7], s48 offen offset:2048 sc1
 buffer_load_dwordx4 a[68:71], v0, s[4:7], s49 offen offset:2048 sc1
 s_add_u32 s48, s48, 4096
 s_add_u32 s49, s49, 4096
 buffer_load_dwordx4 a[72:75], v0, s[4:7], s48 offen sc1
 buffer_load_dwordx4 a[76:79], v0, s[4:7], s49 offen sc1
 s_lshl_b32 s28, s50, 14
 s_add_u32 s28, s28, s41
 s_add_u32 s28, s28, 14336
 s_xor_b32 s29, s28, 1024
 buffer_load_dwordx4 v[144:147], v0, s[4:7], s28 offen sc1
 buffer_load_dwordx4 v[148:151], v0, s[4:7], s29 offen sc1
 buffer_load_dwordx4 a[80:83], v0, s[4:7], s48 offen offset:2048 sc1
 buffer_load_dwordx4 a[84:87], v0, s[4:7], s49 offen offset:2048 sc1
 s_add_u32 s48, s48, 4096
 s_add_u32 s49, s49, 4096
 buffer_load_dwordx4 a[88:91], v0, s[4:7], s48 offen sc1
 buffer_load_dwordx4 a[92:95], v0, s[4:7], s49 offen sc1
 s_and_b32 s28, s50, 1
 s_lshl1_add_u32 s28, s52, s28
 s_lshl2_add_u32 s3, s51, s70
 s_mul_i32 s3, s3, 88
 s_add_u32 s3, s3, s28
 s_lshl_b32 s3, s3, 10
 s_add_u32 s29, s3, 4194304
 s_lshl2_add_u32 s3, s51, s71
 s_mul_i32 s3, s3, 88
 s_add_u32 s3, s3, s28
 s_lshl_b32 s3, s3, 10
 s_add_u32 s30, s3, 4193280
 s_mul_i32 s31, s62, 36864
 s_lshl_b32 s3, s64, 11
 s_add_u32 s31, s31, s3
 s_add_u32 s31, s31, 1046528
 v_mov_b32 v1, s29
 v_mov_b32 v2, s30
 v_cmp_gt_u32 vcc, 128, v0
 s_nop 1
 v_cndmask_b32 v1, v2, v1, vcc
 v_mov_b32 v2, s31
 v_cmp_gt_u32 vcc, 256, v0
 s_nop 1
 v_cndmask_b32 v1, v2, v1, vcc
 v_lshl_add_u32 v1, v0, 3, v1
 s_mov_b32 exec_hi, 0
 buffer_load_dword a239, v1, s[4:7], 0 offen
 s_mov_b32 exec_hi, -1
 buffer_load_dwordx4 a[96:99], v0, s[4:7], s48 offen offset:2048 sc1
 buffer_load_dwordx4 a[100:103], v0, s[4:7], s49 offen offset:2048 sc1
 s_add_u32 s48, s48, 4096
 s_add_u32 s49, s49, 4096
 buffer_load_dwordx4 a[104:107], v0, s[4:7], s48 offen sc1
 buffer_load_dwordx4 a[108:111], v0, s[4:7], s49 offen sc1
 buffer_load_dwordx4 a[112:115], v0, s[4:7], s48 offen offset:2048 sc1
 buffer_load_dwordx4 a[116:119], v0, s[4:7], s49 offen offset:2048 sc1
 s_add_u32 s48, s48, 4096
 s_add_u32 s49, s49, 4096
 buffer_load_dwordx4 a[120:123], v0, s[4:7], s48 offen sc1
 buffer_load_dwordx4 a[124:127], v0, s[4:7], s49 offen sc1
 buffer_load_dwordx4 a[128:131], v0, s[4:7], s48 offen offset:2048 sc1
 buffer_load_dwordx4 a[132:135], v0, s[4:7], s49 offen offset:2048 sc1
 s_add_u32 s48, s48, 4096
 s_add_u32 s49, s49, 4096
 buffer_load_dwordx4 a[136:139], v0, s[4:7], s48 offen sc1
 buffer_load_dwordx4 a[140:143], v0, s[4:7], s49 offen sc1
 s_mul_i32 s28, s52, 5
 s_lshr_b32 s28, s28, 2
 s_lshl_b32 s28, s28, 10
 s_min_u32 s29, s52, 5
 s_add_u32 s29, s29, 80
 s_lshr_b32 s29, s29, 2
 s_lshl_b32 s29, s29, 10
 v_and_b32 v9, 0xf0, v0
 v_lshl_add_u32 v9, v9, 3, s28
 v_cmp_gt_u32 vcc, 256, v0
 v_and_b32 v10, 0x70, v0
 v_lshl_add_u32 v10, v10, 3, s29
 v_cndmask_b32 v9, v10, v9, vcc
 s_mov_b32 s36, 131072
 buffer_load_dword v10, v9, s[4:7], s36 offen sc1
 buffer_load_dwordx4 a[144:147], v0, s[4:7], s48 offen offset:2048 sc1
 buffer_load_dwordx4 a[148:151], v0, s[4:7], s49 offen offset:2048 sc1
 s_add_u32 s48, s48, 4096
 s_add_u32 s49, s49, 4096
 buffer_load_dwordx4 a[152:155], v0, s[4:7], s48 offen sc1
 buffer_load_dwordx4 a[156:159], v0, s[4:7], s49 offen sc1
 s_nop 11
 s_branch L6_aepi
L11_x:
 s_waitcnt lgkmcnt(0)
 v_mfma_f32_32x32x16_bf16 v[80:95], v[244:247], v[100:103], v[80:95]
 buffer_load_dwordx4 a[128:131], v0, s[4:7], s48 offen offset:2048 sc1
 buffer_load_dwordx4 a[132:135], v0, s[4:7], s49 offen offset:2048 sc1
 s_add_u32 s48, s48, 4096
 s_add_u32 s49, s49, 4096
 buffer_load_dwordx4 a[136:139], v0, s[4:7], s48 offen sc1
 buffer_load_dwordx4 a[140:143], v0, s[4:7], s49 offen sc1
 s_mul_i32 s28, s52, 5
 s_lshr_b32 s28, s28, 2
 s_lshl_b32 s28, s28, 10
 s_min_u32 s29, s52, 5
 s_add_u32 s29, s29, 80
 s_lshr_b32 s29, s29, 2
 s_lshl_b32 s29, s29, 10
 v_and_b32 v9, 0xf0, v0
 v_lshl_add_u32 v9, v9, 3, s28
 v_cmp_gt_u32 vcc, 256, v0
 v_and_b32 v10, 0x70, v0
 v_lshl_add_u32 v10, v10, 3, s29
 v_cndmask_b32 v9, v10, v9, vcc
 s_mov_b32 s36, 131072
 buffer_load_dword v10, v9, s[4:7], s36 offen sc1
 buffer_load_dwordx4 a[144:147], v0, s[4:7], s48 offen offset:2048 sc1
 buffer_load_dwordx4 a[148:151], v0, s[4:7], s49 offen offset:2048 sc1
 s_add_u32 s48, s48, 4096
 s_add_u32 s49, s49, 4096
 buffer_load_dwordx4 a[152:155], v0, s[4:7], s48 offen sc1
 buffer_load_dwordx4 a[156:159], v0, s[4:7], s49 offen sc1
 s_nop 11
 s_branch L6_aepi
L5_p1:
 ds_read_b128 v[104:107], v28 offset:32768
 s_mov_b64 exec, s[66:67]
 ds_read_b128 v[240:243], v29 offset:34816
 ds_read_b128 v[244:247], v29 offset:35840
 s_mov_b64 exec, -1
 ds_read_b128 v[112:115], v28 offset:55296
 ds_read_b128 v[116:119], v28 offset:59392
 s_waitcnt lgkmcnt(1)
 v_mfma_f32_32x32x16_bf16 v[32:47], v[104:107], v[112:115], 0
 s_waitcnt lgkmcnt(0)
 v_mfma_f32_32x32x16_bf16 v[48:63], v[104:107], v[116:119], 0
 s_nop 9
 v_exp_f32 v32, v32
 v_exp_f32 v33, v33
 v_exp_f32 v34, v34
 v_cvt_pk_bf16_f32 v96, v32, v33
 v_exp_f32 v35, v35
 s_add_u32 m0, s65, 16384
 s_cmp_eq_u32 s51, 0
 s_waitcnt vmcnt(6)
 s_cbranch_scc1 L7_g0
 v_cmp_ne_u32 vcc, s55, v25
 s_cbranch_vccnz L8_spin
L9_got:
L7_g0:
 buffer_load_dwordx4 v0, s[4:7], s36 offen sc1 nt lds
 buffer_load_dwordx4 v0, s[4:7], s36 offen offset:1024 sc1 nt lds
 buffer_load_dwordx4 v0, s[4:7], s36 offen offset:2048 sc1 nt lds
 buffer_load_dwordx4 v0, s[4:7], s36 offen offset:3072 sc1 nt lds
 v_exp_f32 v36, v36
 v_cvt_pk_bf16_f32 v97, v34, v35
 v_exp_f32 v37, v37
 v_exp_f32 v38, v38
 v_cvt_pk_bf16_f32 v98, v36, v37
 v_exp_f32 v39, v39
 v_exp_f32 v40, v40
 v_cvt_pk_bf16_f32 v99, v38, v39
 s_sub_u32 s28, s36, 16384
 s_cmp_ge_u32 s51, 2
 s_cselect_b32 s28, s28, 2146435072
 s_add_u32 m0, s65, 0
 s_nop 0
 buffer_load_dwordx4 v0, s[4:7], s28 offen sc1 nt lds
 buffer_load_dwordx4 v0, s[4:7], s28 offen offset:1024 sc1 nt lds
 buffer_load_dwordx4 v0, s[4:7], s28 offen offset:2048 sc1 nt lds
 buffer_load_dwordx4 v0, s[4:7], s28 offen offset:3072 sc1 nt lds
 v_exp_f32 v41, v41
 v_exp_f32 v42, v42
 v_mfma_f32_32x32x16_bf16 v[64:79], v[240:243], v[96:99], 0
 v_cvt_pk_bf16_f32 v100, v40, v41
 v_exp_f32 v43, v43
 v_exp_f32 v44, v44
 v_cvt_pk_bf16_f32 v101, v42, v43
 v_exp_f32 v45, v45
 ds_read_b128 v[108:111], v28 offset:36864
 s_mov_b64 exec, s[66:67]
 ds_read_b128 v[248:251], v29 offset:38912
 ds_read_b128 v[252:255], v29 offset:39936
 s_mov_b64 exec, -1
 v_bfe_u32 v1, v0, 4, 5
 v_lshrrev_b32 v2, 9, v0
 v_lshlrev_b32 v2, 4, v2
 v_lshl_add_u32 v1, v1, 10, v2
 s_lshl_b32 s28, s62, 15
 s_lshl_b32 s29, s64, 6
 s_add_u32 s28, s28, s29
 buffer_load_dwordx4 v[20:23], v1, s[8:11], s28 offen offset:0
 buffer_load_dwordx4 v[24:27], v1, s[8:11], s28 offen offset:32
 v_exp_f32 v46, v46
 v_exp_f32 v47, v47
 v_cvt_pk_bf16_f32 v102, v44, v45
 v_cvt_pk_bf16_f32 v103, v46, v47
 v_exp_f32 v48, v48
 v_exp_f32 v49, v49
 v_mfma_f32_32x32x16_bf16 v[64:79], v[244:247], v[100:103], v[64:79]
 v_exp_f32 v50, v50
 v_cvt_pk_bf16_f32 v96, v48, v49
 v_exp_f32 v51, v51
 v_exp_f32 v52, v52
 v_cvt_pk_bf16_f32 v97, v50, v51
 s_waitcnt lgkmcnt(0)
 v_mfma_f32_32x32x16_bf16 v[32:47], v[108:111], v[112:115], v[208:223]
 v_exp_f32 v53, v53
 v_exp_f32 v54, v54
 v_cvt_pk_bf16_f32 v98, v52, v53
 v_exp_f32 v55, v55
 v_exp_f32 v56, v56
 v_cvt_pk_bf16_f32 v99, v54, v55
 v_exp_f32 v57, v57
 v_exp_f32 v58, v58
 v_mfma_f32_32x32x16_bf16 v[80:95], v[240:243], v[96:99], 0
 v_cvt_pk_bf16_f32 v100, v56, v57
 v_exp_f32 v59, v59
 v_exp_f32 v60, v60
 v_cvt_pk_bf16_f32 v101, v58, v59
 v_exp_f32 v61, v61
 v_exp_f32 v62, v62
 v_exp_f32 v63, v63
 v_cvt_pk_bf16_f32 v102, v60, v61
 v_cvt_pk_bf16_f32 v103, v62, v63
 v_exp_f32 v32, v32
 v_exp_f32 v33, v33
 v_mfma_f32_32x32x16_bf16 v[80:95], v[244:247], v[100:103], v[80:95]
 v_exp_f32 v34, v34
 v_cvt_pk_bf16_f32 v96, v32, v33
 v_exp_f32 v35, v35
 v_exp_f32 v36, v36
 v_cvt_pk_bf16_f32 v97, v34, v35
 v_mfma_f32_32x32x16_bf16 v[48:63], v[108:111], v[116:119], 0
 v_exp_f32 v37, v37
 v_exp_f32 v38, v38
 v_cvt_pk_bf16_f32 v98, v36, v37
 v_exp_f32 v39, v39
 v_exp_f32 v40, v40
 v_cvt_pk_bf16_f32 v99, v38, v39
 v_exp_f32 v41, v41
 v_exp_f32 v42, v42
 v_mfma_f32_32x32x16_bf16 v[64:79], v[248:251], v[96:99], v[64:79]
 v_cvt_pk_bf16_f32 v100, v40, v41
 v_exp_f32 v43, v43
 v_exp_f32 v44, v44
 v_cvt_pk_bf16_f32 v101, v42, v43
 v_exp_f32 v45, v45
 ds_read_b128 v[104:107], v28 offset:40960
 s_mov_b64 exec, s[66:67]
 ds_read_b128 v[240:243], v29 offset:43008
 ds_read_b128 v[244:247], v29 offset:44032
 s_mov_b64 exec, -1
 v_exp_f32 v46, v46
 v_exp_f32 v47, v47
 v_cvt_pk_bf16_f32 v102, v44, v45
 v_cvt_pk_bf16_f32 v103, v46, v47
 v_exp_f32 v48, v48
 v_exp_f32 v49, v49
 v_mfma_f32_32x32x16_bf16 v[64:79], v[252:255], v[100:103], v[64:79]
 v_exp_f32 v50, v50
 v_cvt_pk_bf16_f32 v96, v48, v49
 v_exp_f32 v51, v51
 v_exp_f32 v52, v52
 v_cvt_pk_bf16_f32 v97, v50, v51
 s_waitcnt lgkmcnt(0)
 v_mfma_f32_32x32x16_bf16 v[32:47], v[104:107], v[116:119], v[208:223]
 v_exp_f32 v53, v53
 v_exp_f32 v54, v54
 v_cvt_pk_bf16_f32 v98, v52, v53
 v_exp_f32 v55, v55
 v_exp_f32 v56, v56
 v_cvt_pk_bf16_f32 v99, v54, v55
 v_exp_f32 v57, v57
 v_exp_f32 v58, v58
 v_mfma_f32_32x32x16_bf16 v[80:95], v[248:251], v[96:99], v[80:95]
 v_cvt_pk_bf16_f32 v100, v56, v57
 v_exp_f32 v59, v59
 v_exp_f32 v60, v60
 v_cvt_pk_bf16_f32 v101, v58, v59
 v_exp_f32 v61, v61
 v_exp_f32 v62, v62
 v_exp_f32 v63, v63
 v_cvt_pk_bf16_f32 v102, v60, v61
 v_cvt_pk_bf16_f32 v103, v62, v63
 v_exp_f32 v32, v32
 v_exp_f32 v33, v33
 v_mfma_f32_32x32x16_bf16 v[80:95], v[252:255], v[100:103], v[80:95]
 v_exp_f32 v34, v34
 v_cvt_pk_bf16_f32 v96, v32, v33
 v_exp_f32 v35, v35
 v_exp_f32 v36, v36
 v_cvt_pk_bf16_f32 v97, v34, v35
 v_exp_f32 v37, v37
 v_exp_f32 v38, v38
 v_cvt_pk_bf16_f32 v98, v36, v37
 v_exp_f32 v39, v39
 v_exp_f32 v40, v40
 v_cvt_pk_bf16_f32 v99, v38, v39
 s_and_b32 s28, s50, 1
 s_lshl1_add_u32 s28, s52, s28
 s_lshl2_add_u32 s20, s51, s70
 s_mul_i32 s22, s20, 88
 s_add_u32 s22, s22, s28
 s_lshl_b32 s22, s22, 10
 s_add_u32 s22, s22, 4194304
 s_lshl_b32 s24, s20, 11
 s_lshl2_add_u32 s24, s28, s24
 s_add_u32 s24, s24, 3407872
 s_lshl2_add_u32 s21, s51, s71
 s_mul_i32 s23, s21, 88
 s_add_u32 s23, s23, s28
 s_lshl_b32 s23, s23, 10
 s_add_u32 s23, s23, 4194304
 s_lshl_b32 s25, s21, 11
 s_lshl2_add_u32 s25, s28, s25
 s_add_u32 s25, s25, 3407872
 s_and_b32 s26, s62, 0xfffffffe
 s_lshl_b32 s26, s26, 11
 v_and_b32 v8, 0x200, v0
 v_lshlrev_b32 v8, 2, v8
 s_lshl_b32 s3, s50, 5
 s_add_u32 s26, s26, s3
 s_add_u32 s26, s26, 3407872
 v_bfe_u32 v2, v0, 2, 5
 v_add_u32 v8, v8, v2
 s_mul_i32 s3, s50, 8192
 s_add_u32 s3, s3, 4194304
 s_mul_i32 s44, s63, 90112
 s_add_u32 s42, s44, s3
 s_mul_i32 s44, s62, 90112
 s_add_u32 s43, s44, s3
 s_waitcnt vmcnt(6)
 s_barrier
 s_lshl3_add_u32 s28, s72, s53
 s_lshl_b32 s28, s28, 7
 s_add_u32 s28, s28, 131072
 s_cmp_eq_u32 s50, 0
 s_cselect_b32 s28, s28, 2146435072
 v_lshrrev_b32 v1, 2, v0
 v_mov_b32 v2, s55
 s_mov_b32 exec_hi, 0
 buffer_store_dword v2, v1, s[4:7], s28 offen sc1
 s_mov_b32 exec_hi, -1
 ds_read_b128 v[108:111], v28 offset:28672
 s_mov_b64 exec, s[66:67]
 ds_read_b128 v[248:251], v29 offset:30720
 ds_read_b128 v[252:255], v29 offset:31744
 s_mov_b64 exec, -1
 v_exp_f32 v41, v41
 v_exp_f32 v42, v42
 v_mfma_f32_32x32x16_bf16 v[80:95], v[240:243], v[96:99], v[80:95]
 v_cvt_pk_bf16_f32 v100, v40, v41
 v_exp_f32 v43, v43
 v_exp_f32 v44, v44
 v_cvt_pk_bf16_f32 v101, v42, v43
 v_exp_f32 v45, v45
 s_waitcnt lgkmcnt(2)
 v_mfma_f32_32x32x16_bf16 v[48:63], v[108:111], v[112:115], 0
 v_exp_f32 v46, v46
 v_exp_f32 v47, v47
 v_cvt_pk_bf16_f32 v102, v44, v45
 v_cvt_pk_bf16_f32 v103, v46, v47
 s_cmp_eq_u32 s51, 0
 s_cbranch_scc1 L10_x
 s_nop 5
 v_exp_f32 v48, v48
 v_exp_f32 v49, v49
 v_mfma_f32_32x32x16_bf16 v[80:95], v[244:247], v[100:103], v[80:95]
 v_exp_f32 v50, v50
 v_cvt_pk_bf16_f32 v96, v48, v49
 v_exp_f32 v51, v51
 buffer_load_dwordx4 a[64:67], v0, s[4:7], s48 offen offset:2048 sc1
 v_exp_f32 v52, v52
 v_cvt_pk_bf16_f32 v97, v50, v51
 v_mfma_f32_32x32x16_bf16 v[32:47], v[108:111], v[116:119], 0
 v_exp_f32 v53, v53
 v_exp_f32 v54, v54
 v_cvt_pk_bf16_f32 v98, v52, v53
 v_exp_f32 v55, v55
 v_exp_f32 v56, v56
 v_cvt_pk_bf16_f32 v99, v54, v55
 buffer_load_dwordx4 a[68:71], v0, s[4:7], s49 offen offset:2048 sc1
 s_add_u32 s48, s48, 4096
 s_add_u32 s49, s49, 4096
 v_exp_f32 v57, v57
 v_exp_f32 v58, v58
 s_waitcnt lgkmcnt(0)
 v_mfma_f32_32x32x16_bf16 v[64:79], v[248:251], v[96:99], v[64:79]
 v_cvt_pk_bf16_f32 v100, v56, v57
 v_exp_f32 v59, v59
 v_exp_f32 v60, v60
 v_cvt_pk_bf16_f32 v101, v58, v59
 v_exp_f32 v61, v61
 ds_read_b128 v[104:107], v28 offset:24576
 s_mov_b64 exec, s[66:67]
 ds_read_b128 v[240:243], v29 offset:26624
 ds_read_b128 v[244:247], v29 offset:27648
 s_mov_b64 exec, -1
 v_exp_f32 v62, v62
 v_exp_f32 v63, v63
 v_cvt_pk_bf16_f32 v102, v60, v61
 v_cvt_pk_bf16_f32 v103, v62, v63
 v_exp_f32 v32, v32
 v_exp_f32 v33, v33
 v_mfma_f32_32x32x16_bf16 v[64:79], v[252:255], v[100:103], v[64:79]
 v_exp_f32 v34, v34
 v_cvt_pk_bf16_f32 v96, v32, v33
 v_exp_f32 v35, v35
 buffer_load_dwordx4 a[72:75], v0, s[4:7], s48 offen sc1
 v_exp_f32 v36, v36
 v_cvt_pk_bf16_f32 v97, v34, v35
 s_waitcnt lgkmcnt(0)
 v_mfma_f32_32x32x16_bf16 v[48:63], v[104:107], v[112:115], 0
 v_exp_f32 v37, v37
 v_exp_f32 v38, v38
 v_cvt_pk_bf16_f32 v98, v36, v37
 v_exp_f32 v39, v39
 v_exp_f32 v40, v40
 v_cvt_pk_bf16_f32 v99, v38, v39
 buffer_load_dwordx4 a[76:79], v0, s[4:7], s49 offen sc1
 v_exp_f32 v41, v41
 v_exp_f32 v42, v42
 v_mfma_f32_32x32x16_bf16 v[80:95], v[248:251], v[96:99], v[80:95]
 v_cvt_pk_bf16_f32 v100, v40, v41
 v_exp_f32 v43, v43
 v_exp_f32 v44, v44
 v_cvt_pk_bf16_f32 v101, v42, v43
 v_exp_f32 v45, v45
 s_lshl_b32 s28, s50, 14
 s_add_u32 s28, s28, s41
 s_add_u32 s28, s28, 14336
 s_xor_b32 s29, s28, 1024
 buffer_load_dwordx4 v[144:147], v0, s[4:7], s28 offen sc1
 buffer_load_dwordx4 v[148:151], v0, s[4:7], s29 offen sc1
 v_exp_f32 v46, v46
 v_exp_f32 v47, v47
 v_cvt_pk_bf16_f32 v102, v44, v45
 v_cvt_pk_bf16_f32 v103, v46, v47
 v_exp_f32 v48, v48
 v_exp_f32 v49, v49
 v_mfma_f32_32x32x16_bf16 v[80:95], v[252:255], v[100:103], v[80:95]
 v_exp_f32 v50, v50
 v_cvt_pk_bf16_f32 v96, v48, v49
 v_exp_f32 v51, v51
 buffer_load_dwordx4 a[80:83], v0, s[4:7], s48 offen offset:2048 sc1
 v_exp_f32 v52, v52
 v_cvt_pk_bf16_f32 v97, v50, v51
 v_mfma_f32_32x32x16_bf16 v[32:47], v[104:107], v[116:119], 0
 v_exp_f32 v53, v53
 v_exp_f32 v54, v54
 v_cvt_pk_bf16_f32 v98, v52, v53
 v_exp_f32 v55, v55
 v_exp_f32 v56, v56
 v_cvt_pk_bf16_f32 v99, v54, v55
 buffer_load_dwordx4 a[84:87], v0, s[4:7], s49 offen offset:2048 sc1
 s_add_u32 s48, s48, 4096
 s_add_u32 s49, s49, 4096
 v_exp_f32 v57, v57
 v_exp_f32 v58, v58
 v_mfma_f32_32x32x16_bf16 v[64:79], v[240:243], v[96:99], v[64:79]
 v_cvt_pk_bf16_f32 v100, v56, v57
 v_exp_f32 v59, v59
 v_exp_f32 v60, v60
 v_cvt_pk_bf16_f32 v101, v58, v59
 v_exp_f32 v61, v61
 ds_read_b128 v[108:111], v28 offset:20480
 s_mov_b64 exec, s[66:67]
 ds_read_b128 v[248:251], v29 offset:22528
 ds_read_b128 v[252:255], v29 offset:23552
 s_mov_b64 exec, -1
 v_exp_f32 v62, v62
 v_exp_f32 v63, v63
 v_cvt_pk_bf16_f32 v102, v60, v61
 v_cvt_pk_bf16_f32 v103, v62, v63
 v_exp_f32 v32, v32
 v_exp_f32 v33, v33
 v_mfma_f32_32x32x16_bf16 v[64:79], v[244:247], v[100:103], v[64:79]
 v_exp_f32 v34, v34
 v_cvt_pk_bf16_f32 v96, v32, v33
 v_exp_f32 v35, v35
 buffer_load_dwordx4 a[88:91], v0, s[4:7], s48 offen sc1
 v_exp_f32 v36, v36
 v_cvt_pk_bf16_f32 v97, v34, v35
 s_waitcnt lgkmcnt(0)
 v_mfma_f32_32x32x16_bf16 v[48:63], v[108:111], v[112:115], 0
 v_exp_f32 v37, v37
 v_exp_f32 v38, v38
 v_cvt_pk_bf16_f32 v98, v36, v37
 v_exp_f32 v39, v39
 v_exp_f32 v40, v40
 v_cvt_pk_bf16_f32 v99, v38, v39
 buffer_load_dwordx4 a[92:95], v0, s[4:7], s49 offen sc1
 v_exp_f32 v41, v41
 v_exp_f32 v42, v42
 v_mfma_f32_32x32x16_bf16 v[80:95], v[240:243], v[96:99], v[80:95]
 v_cvt_pk_bf16_f32 v100, v40, v41
 v_exp_f32 v43, v43
 v_exp_f32 v44, v44
 v_cvt_pk_bf16_f32 v101, v42, v43
 v_exp_f32 v45, v45
 v_exp_f32 v46, v46
 v_exp_f32 v47, v47
 v_cvt_pk_bf16_f32 v102, v44, v45
 v_cvt_pk_bf16_f32 v103, v46, v47
 v_exp_f32 v48, v48
 v_exp_f32 v49, v49
 v_mfma_f32_32x32x16_bf16 v[80:95], v[244:247], v[100:103], v[80:95]
 v_exp_f32 v50, v50
 v_cvt_pk_bf16_f32 v96, v48, v49
 v_exp_f32 v51, v51
 s_and_b32 s28, s50, 1
 s_lshl1_add_u32 s28, s52, s28
 s_lshl2_add_u32 s3, s51, s70
 s_mul_i32 s3, s3, 88
 s_add_u32 s3, s3, s28
 s_lshl_b32 s3, s3, 10
 s_add_u32 s29, s3, 4194304
 s_lshl2_add_u32 s3, s51, s71
 s_mul_i32 s3, s3, 88
 s_add_u32 s3, s3, s28
 s_lshl_b32 s3, s3, 10
 s_add_u32 s30, s3, 4193280
 s_mul_i32 s31, s62, 36864
 s_lshl_b32 s3, s64, 11
 s_add_u32 s31, s31, s3
 s_add_u32 s31, s31, 1046528
 v_mov_b32 v1, s29
 v_mov_b32 v2, s30
 v_cmp_gt_u32 vcc, 128, v0
 s_nop 1
 v_cndmask_b32 v1, v2, v1, vcc
 v_mov_b32 v2, s31
 v_cmp_gt_u32 vcc, 256, v0
 s_nop 1
 v_cndmask_b32 v1, v2, v1, vcc
 v_lshl_add_u32 v1, v0, 3, v1
 s_mov_b32 exec_hi, 0
 buffer_load_dword a239, v1, s[4:7], 0 offen
 s_mov_b32 exec_hi, -1
 v_exp_f32 v52, v52
 v_cvt_pk_bf16_f32 v97, v50, v51
 v_mfma_f32_32x32x16_bf16 v[32:47], v[108:111], v[116:119], 0
 v_exp_f32 v53, v53
 v_exp_f32 v54, v54
 v_cvt_pk_bf16_f32 v98, v52, v53
 v_exp_f32 v55, v55
 v_exp_f32 v56, v56
 v_cvt_pk_bf16_f32 v99, v54, v55
 buffer_load_dwordx4 a[96:99], v0, s[4:7], s48 offen offset:2048 sc1
 v_exp_f32 v57, v57
 v_exp_f32 v58, v58
 v_mfma_f32_32x32x16_bf16 v[64:79], v[248:251], v[96:99], v[64:79]
 v_cvt_pk_bf16_f32 v100, v56, v57
 v_exp_f32 v59, v59
 v_exp_f32 v60, v60
 v_cvt_pk_bf16_f32 v101, v58, v59
 v_exp_f32 v61, v61
 ds_read_b128 v[104:107], v28 offset:16384
 s_mov_b64 exec, s[66:67]
 ds_read_b128 v[240:243], v29 offset:18432
 ds_read_b128 v[244:247], v29 offset:19456
 s_mov_b64 exec, -1
 buffer_load_dwordx4 a[100:103], v0, s[4:7], s49 offen offset:2048 sc1
 s_add_u32 s48, s48, 4096
 s_add_u32 s49, s49, 4096
 v_exp_f32 v62, v62
 v_exp_f32 v63, v63
 v_cvt_pk_bf16_f32 v102, v60, v61
 v_cvt_pk_bf16_f32 v103, v62, v63
 v_exp_f32 v32, v32
 v_exp_f32 v33, v33
 v_mfma_f32_32x32x16_bf16 v[64:79], v[252:255], v[100:103], v[64:79]
 v_exp_f32 v34, v34
 v_cvt_pk_bf16_f32 v96, v32, v33
 v_exp_f32 v35, v35
 buffer_load_dwordx4 a[104:107], v0, s[4:7], s48 offen sc1
 v_exp_f32 v36, v36
 v_cvt_pk_bf16_f32 v97, v34, v35
 s_waitcnt lgkmcnt(0)
 v_mfma_f32_32x32x16_bf16 v[48:63], v[104:107], v[112:115], 0
 v_exp_f32 v37, v37
 v_exp_f32 v38, v38
 v_cvt_pk_bf16_f32 v98, v36, v37
 v_exp_f32 v39, v39
 v_exp_f32 v40, v40
 v_cvt_pk_bf16_f32 v99, v38, v39
 buffer_load_dwordx4 a[108:111], v0, s[4:7], s49 offen sc1
 v_exp_f32 v41, v41
 v_exp_f32 v42, v42
 v_mfma_f32_32x32x16_bf16 v[80:95], v[248:251], v[96:99], v[80:95]
 v_cvt_pk_bf16_f32 v100, v40, v41
 v_exp_f32 v43, v43
 v_exp_f32 v44, v44
 v_cvt_pk_bf16_f32 v101, v42, v43
 v_exp_f32 v45, v45
 v_exp_f32 v46, v46
 v_exp_f32 v47, v47
 v_cvt_pk_bf16_f32 v102, v44, v45
 v_cvt_pk_bf16_f32 v103, v46, v47
 v_exp_f32 v48, v48
 v_exp_f32 v49, v49
 v_mfma_f32_32x32x16_bf16 v[80:95], v[252:255], v[100:103], v[80:95]
 v_exp_f32 v50, v50
 v_cvt_pk_bf16_f32 v96, v48, v49
 v_exp_f32 v51, v51
 buffer_load_dwordx4 a[112:115], v0, s[4:7], s48 offen offset:2048 sc1
 v_exp_f32 v52, v52
 v_cvt_pk_bf16_f32 v97, v50, v51
 v_mfma_f32_32x32x16_bf16 v[32:47], v[104:107], v[116:119], 0
 v_exp_f32 v53, v53
 v_exp_f32 v54, v54
 v_cvt_pk_bf16_f32 v98, v52, v53
 v_exp_f32 v55, v55
 v_exp_f32 v56, v56
 v_cvt_pk_bf16_f32 v99, v54, v55
 buffer_load_dwordx4 a[116:119], v0, s[4:7], s49 offen offset:2048 sc1
 s_add_u32 s48, s48, 4096
 s_add_u32 s49, s49, 4096
 v_exp_f32 v57, v57
 v_exp_f32 v58, v58
 v_mfma_f32_32x32x16_bf16 v[64:79], v[240:243], v[96:99], v[64:79]
 v_cvt_pk_bf16_f32 v100, v56, v57
 v_exp_f32 v59, v59
 v_exp_f32 v60, v60
 v_cvt_pk_bf16_f32 v101, v58, v59
 v_exp_f32 v61, v61
 s_waitcnt vmcnt(20)
 s_barrier
 ds_read_b128 v[108:111], v28 offset:12288
 s_mov_b64 exec, s[66:67]
 ds_read_b128 v[248:251], v29 offset:14336
 ds_read_b128 v[252:255], v29 offset:15360
 s_mov_b64 exec, -1
 v_exp_f32 v62, v62
 v_exp_f32 v63, v63
 v_cvt_pk_bf16_f32 v102, v60, v61
 v_cvt_pk_bf16_f32 v103, v62, v63
 v_exp_f32 v32, v32
 v_exp_f32 v33, v33
 v_mfma_f32_32x32x16_bf16 v[64:79], v[244:247], v[100:103], v[64:79]
 v_exp_f32 v34, v34
 v_cvt_pk_bf16_f32 v96, v32, v33
 v_exp_f32 v35, v35
 buffer_load_dwordx4 a[120:123], v0, s[4:7], s48 offen sc1
 v_exp_f32 v36, v36
 v_cvt_pk_bf16_f32 v97, v34, v35
 s_waitcnt lgkmcnt(0)
 v_mfma_f32_32x32x16_bf16 v[48:63], v[108:111], v[112:115], 0
 v_exp_f32 v37, v37
 v_exp_f32 v38, v38
 v_cvt_pk_bf16_f32 v98, v36, v37
 v_exp_f32 v39, v39
 v_exp_f32 v40, v40
 v_cvt_pk_bf16_f32 v99, v38, v39
 buffer_load_dwordx4 a[124:127], v0, s[4:7], s49 offen sc1
 v_exp_f32 v41, v41
 v_exp_f32 v42, v42
 v_mfma_f32_32x32x16_bf16 v[80:95], v[240:243], v[96:99], v[80:95]
 v_cvt_pk_bf16_f32 v100, v40, v41
 v_exp_f32 v43, v43
 v_exp_f32 v44, v44
 v_cvt_pk_bf16_f32 v101, v42, v43
 v_exp_f32 v45, v45
 v_exp_f32 v46, v46
 v_exp_f32 v47, v47
 v_cvt_pk_bf16_f32 v102, v44, v45
 v_cvt_pk_bf16_f32 v103, v46, v47
 s_cmp_eq_u32 s51, 1
 s_cbranch_scc1 L11_x
 v_exp_f32 v48, v48
 v_exp_f32 v49, v49
 v_mfma_f32_32x32x16_bf16 v[80:95], v[244:247], v[100:103], v[80:95]
 v_exp_f32 v50, v50
 v_cvt_pk_bf16_f32 v96, v48, v49
 v_exp_f32 v51, v51
 buffer_load_dwordx4 a[128:131], v0, s[4:7], s48 offen offset:2048 sc1
 v_exp_f32 v52, v52
 v_cvt_pk_bf16_f32 v97, v50, v51
 v_mfma_f32_32x32x16_bf16 v[32:47], v[108:111], v[116:119], 0
 v_exp_f32 v53, v53
 v_exp_f32 v54, v54
 v_cvt_pk_bf16_f32 v98, v52, v53
 v_exp_f32 v55, v55
 v_exp_f32 v56, v56
 v_cvt_pk_bf16_f32 v99, v54, v55
 buffer_load_dwordx4 a[132:135], v0, s[4:7], s49 offen offset:2048 sc1
 s_add_u32 s48, s48, 4096
 s_add_u32 s49, s49, 4096
 v_exp_f32 v57, v57
 v_exp_f32 v58, v58
 v_mfma_f32_32x32x16_bf16 v[64:79], v[248:251], v[96:99], v[64:79]
 v_cvt_pk_bf16_f32 v100, v56, v57
 v_exp_f32 v59, v59
 v_exp_f32 v60, v60
 v_cvt_pk_bf16_f32 v101, v58, v59
 v_exp_f32 v61, v61
 ds_read_b128 v[104:107], v28 offset:8192
 s_mov_b64 exec, s[66:67]
 ds_read_b128 v[240:243], v29 offset:10240
 ds_read_b128 v[244:247], v29 offset:11264
 s_mov_b64 exec, -1
 v_exp_f32 v62, v62
 v_exp_f32 v63, v63
 v_cvt_pk_bf16_f32 v102, v60, v61
 v_cvt_pk_bf16_f32 v103, v62, v63
 v_exp_f32 v32, v32
 v_exp_f32 v33, v33
 v_mfma_f32_32x32x16_bf16 v[64:79], v[252:255], v[100:103], v[64:79]
 v_exp_f32 v34, v34
 v_cvt_pk_bf16_f32 v96, v32, v33
 v_exp_f32 v35, v35
 buffer_load_dwordx4 a[136:139], v0, s[4:7], s48 offen sc1
 v_exp_f32 v36, v36
 v_cvt_pk_bf16_f32 v97, v34, v35
 s_waitcnt lgkmcnt(0)
 v_mfma_f32_32x32x16_bf16 v[48:63], v[104:107], v[112:115], 0
 v_exp_f32 v37, v37
 v_exp_f32 v38, v38
 v_cvt_pk_bf16_f32 v98, v36, v37
 v_exp_f32 v39, v39
 v_exp_f32 v40, v40
 v_cvt_pk_bf16_f32 v99, v38, v39
 buffer_load_dwordx4 a[140:143], v0, s[4:7], s49 offen sc1
 v_exp_f32 v41, v41
 v_exp_f32 v42, v42
 v_mfma_f32_32x32x16_bf16 v[80:95], v[248:251], v[96:99], v[80:95]
 v_cvt_pk_bf16_f32 v100, v40, v41
 v_exp_f32 v43, v43
 v_exp_f32 v44, v44
 v_cvt_pk_bf16_f32 v101, v42, v43
 v_exp_f32 v45, v45
 v_exp_f32 v46, v46
 v_exp_f32 v47, v47
 v_cvt_pk_bf16_f32 v102, v44, v45
 v_cvt_pk_bf16_f32 v103, v46, v47
 v_exp_f32 v48, v48
 v_exp_f32 v49, v49
 v_mfma_f32_32x32x16_bf16 v[80:95], v[252:255], v[100:103], v[80:95]
 v_exp_f32 v50, v50
 v_cvt_pk_bf16_f32 v96, v48, v49
 v_exp_f32 v51, v51
 s_mul_i32 s28, s52, 5
 s_lshr_b32 s28, s28, 2
 s_lshl_b32 s28, s28, 10
 s_min_u32 s29, s52, 5
 s_add_u32 s29, s29, 80
 s_lshr_b32 s29, s29, 2
 s_lshl_b32 s29, s29, 10
 v_and_b32 v9, 0xf0, v0
 v_lshl_add_u32 v9, v9, 3, s28
 v_cmp_gt_u32 vcc, 256, v0
 v_and_b32 v10, 0x70, v0
 v_lshl_add_u32 v10, v10, 3, s29
 v_cndmask_b32 v9, v10, v9, vcc
 s_mov_b32 s36, 131072
 buffer_load_dword v10, v9, s[4:7], s36 offen sc1
 v_exp_f32 v52, v52
 v_cvt_pk_bf16_f32 v97, v50, v51
 v_mfma_f32_32x32x16_bf16 v[32:47], v[104:107], v[116:119], v[224:239]
 v_exp_f32 v53, v53
 v_exp_f32 v54, v54
 v_cvt_pk_bf16_f32 v98, v52, v53
 v_exp_f32 v55, v55
 v_exp_f32 v56, v56
 v_cvt_pk_bf16_f32 v99, v54, v55
 buffer_load_dwordx4 a[144:147], v0, s[4:7], s48 offen offset:2048 sc1
 v_exp_f32 v57, v57
 v_exp_f32 v58, v58
 v_mfma_f32_32x32x16_bf16 v[64:79], v[240:243], v[96:99], v[64:79]
 v_cvt_pk_bf16_f32 v100, v56, v57
 v_exp_f32 v59, v59
 v_exp_f32 v60, v60
 v_cvt_pk_bf16_f32 v101, v58, v59
 v_exp_f32 v61, v61
 ds_read_b128 v[108:111], v28 offset:4096
 s_mov_b64 exec, s[66:67]
 ds_read_b128 v[248:251], v29 offset:6144
 ds_read_b128 v[252:255], v29 offset:7168
 s_mov_b64 exec, -1
 buffer_load_dwordx4 a[148:151], v0, s[4:7], s49 offen offset:2048 sc1
 s_add_u32 s48, s48, 4096
 s_add_u32 s49, s49, 4096
 v_exp_f32 v62, v62
 v_exp_f32 v63, v63
 v_cvt_pk_bf16_f32 v102, v60, v61
 v_cvt_pk_bf16_f32 v103, v62, v63
 v_exp_f32 v32, v32
 v_exp_f32 v33, v33
 v_mfma_f32_32x32x16_bf16 v[64:79], v[244:247], v[100:103], v[64:79]
 v_exp_f32 v34, v34
 v_cvt_pk_bf16_f32 v96, v32, v33
 v_exp_f32 v35, v35
 buffer_load_dwordx4 a[152:155], v0, s[4:7], s48 offen sc1
 v_exp_f32 v36, v36
 v_cvt_pk_bf16_f32 v97, v34, v35
 s_waitcnt lgkmcnt(0)
 v_mfma_f32_32x32x16_bf16 v[48:63], v[108:111], v[112:115], v[224:239]
 v_exp_f32 v37, v37
 v_exp_f32 v38, v38
 v_cvt_pk_bf16_f32 v98, v36, v37
 v_exp_f32 v39, v39
 v_exp_f32 v40, v40
 v_cvt_pk_bf16_f32 v99, v38, v39
 buffer_load_dwordx4 a[156:159], v0, s[4:7], s49 offen sc1
 v_exp_f32 v41, v41
 v_exp_f32 v42, v42
 v_mfma_f32_32x32x16_bf16 v[80:95], v[240:243], v[96:99], v[80:95]
 v_cvt_pk_bf16_f32 v100, v40, v41
 v_exp_f32 v43, v43
 v_exp_f32 v44, v44
 v_cvt_pk_bf16_f32 v101, v42, v43
 v_exp_f32 v45, v45
 v_exp_f32 v46, v46
 v_exp_f32 v47, v47
 v_cvt_pk_bf16_f32 v102, v44, v45
 v_cvt_pk_bf16_f32 v103, v46, v47
 v_exp_f32 v48, v48
 v_exp_f32 v49, v49
 v_mfma_f32_32x32x16_bf16 v[80:95], v[244:247], v[100:103], v[80:95]
 v_exp_f32 v50, v50
 v_cvt_pk_bf16_f32 v96, v48, v49
 v_exp_f32 v51, v51
 v_exp_f32 v52, v52
 v_cvt_pk_bf16_f32 v97, v50, v51
 v_exp_f32 v53, v53
 v_exp_f32 v54, v54
 v_cvt_pk_bf16_f32 v98, v52, v53
 v_exp_f32 v55, v55
 v_exp_f32 v56, v56
 v_cvt_pk_bf16_f32 v99, v54, v55
 v_exp_f32 v57, v57
 v_exp_f32 v58, v58
 v_mfma_f32_32x32x16_bf16 v[64:79], v[248:251], v[96:99], v[64:79]
 v_cvt_pk_bf16_f32 v100, v56, v57
 v_exp_f32 v59, v59
 v_exp_f32 v60, v60
 v_cvt_pk_bf16_f32 v101, v58, v59
 v_exp_f32 v61, v61
 v_exp_f32 v62, v62
 v_exp_f32 v63, v63
 v_cvt_pk_bf16_f32 v102, v60, v61
 v_cvt_pk_bf16_f32 v103, v62, v63
 s_nop 1
 v_mfma_f32_32x32x16_bf16 v[64:79], v[252:255], v[100:103], v[64:79]
 s_branch L6_aepi
L13_spin:
 buffer_load_dword v25, v30, s[4:7], s35 offen offset:0 sc1
 s_sub_u32 s57, s57, 1
 s_cbranch_scc1 L13_spin_x
 s_waitcnt vmcnt(0)
 v_cmp_ne_u32 vcc, s55, v25
 s_cbranch_vccnz L13_spin
 s_branch L14_got
L13_spin_x:
 s_mov_b32 s57, 0
 s_waitcnt vmcnt(0)
 s_branch L14_got
L15_x:
 s_waitcnt lgkmcnt(0)
 v_mfma_f32_32x32x16_bf16 v[80:95], v[252:255], v[100:103], v[80:95]
 s_waitcnt vmcnt(0)
 buffer_load_dwordx4 a[64:67], v0, s[4:7], s48 offen offset:2048 sc1
 buffer_load_dwordx4 a[68:71], v0, s[4:7], s49 offen offset:2048 sc1
 s_add_u32 s48, s48, 4096
 s_add_u32 s49, s49, 4096
 buffer_load_dwordx4 a[72:75], v0, s[4:7], s48 offen sc1
 buffer_load_dwordx4 a[76:79], v0, s[4:7], s49 offen sc1
 s_lshl_b32 s28, s50, 14
 s_add_u32 s28, s28, s41
 s_add_u32 s28, s28, 14336
 s_xor_b32 s29, s28, 1024
 buffer_load_dwordx4 v[144:147], v0, s[4:7], s28 offen sc1
 buffer_load_dwordx4 v[148:151], v0, s[4:7], s29 offen sc1
 buffer_load_dwordx4 a[80:83], v0, s[4:7], s48 offen offset:2048 sc1
 buffer_load_dwordx4 a[84:87], v0, s[4:7], s49 offen offset:2048 sc1
 s_add_u32 s48, s48, 4096
 s_add_u32 s49, s49, 4096
 buffer_load_dwordx4 a[88:91], v0, s[4:7], s48 offen sc1
 buffer_load_dwordx4 a[92:95], v0, s[4:7], s49 offen sc1
 s_and_b32 s28, s50, 1
 s_lshl1_add_u32 s28, s52, s28
 s_lshl2_add_u32 s3, s51, s70
 s_mul_i32 s3, s3, 88
 s_add_u32 s3, s3, s28
 s_lshl_b32 s3, s3, 10
 s_add_u32 s29, s3, 4194304
 s_lshl2_add_u32 s3, s51, s71
 s_mul_i32 s3, s3, 88
 s_add_u32 s3, s3, s28
 s_lshl_b32 s3, s3, 10
 s_add_u32 s30, s3, 4193280
 s_mul_i32 s31, s62, 36864
 s_lshl_b32 s3, s64, 11
 s_add_u32 s31, s31, s3
 s_add_u32 s31, s31, 1046528
 v_mov_b32 v1, s29
 v_mov_b32 v2, s30
 v_cmp_gt_u32 vcc, 128, v0
 s_nop 1
 v_cndmask_b32 v1, v2, v1, vcc
 v_mov_b32 v2, s31
 v_cmp_gt_u32 vcc, 256, v0
 s_nop 1
 v_cndmask_b32 v1, v2, v1, vcc
 v_lshl_add_u32 v1, v0, 3, v1
 s_mov_b32 exec_hi, 0
 buffer_load_dword a239, v1, s[4:7], 0 offen
 s_mov_b32 exec_hi, -1
 buffer_load_dwordx4 a[96:99], v0, s[4:7], s48 offen offset:2048 sc1
 buffer_load_dwordx4 a[100:103], v0, s[4:7], s49 offen offset:2048 sc1
 s_add_u32 s48, s48, 4096
 s_add_u32 s49, s49, 4096
 buffer_load_dwordx4 a[104:107], v0, s[4:7], s48 offen sc1
 buffer_load_dwordx4 a[108:111], v0, s[4:7], s49 offen sc1
 buffer_load_dwordx4 a[112:115], v0, s[4:7], s48 offen offset:2048 sc1
 buffer_load_dwordx4 a[116:119], v0, s[4:7], s49 offen offset:2048 sc1
 s_add_u32 s48, s48, 4096
 s_add_u32 s49, s49, 4096
 buffer_load_dwordx4 a[120:123], v0, s[4:7], s48 offen sc1
 buffer_load_dwordx4 a[124:127], v0, s[4:7], s49 offen sc1
 buffer_load_dwordx4 a[128:131], v0, s[4:7], s48 offen offset:2048 sc1
 buffer_load_dwordx4 a[132:135], v0, s[4:7], s49 offen offset:2048 sc1
 s_add_u32 s48, s48, 4096
 s_add_u32 s49, s49, 4096
 buffer_load_dwordx4 a[136:139], v0, s[4:7], s48 offen sc1
 buffer_load_dwordx4 a[140:143], v0, s[4:7], s49 offen sc1
 s_mul_i32 s28, s52, 5
 s_lshr_b32 s28, s28, 2
 s_lshl_b32 s28, s28, 10
 s_min_u32 s29, s52, 5
 s_add_u32 s29, s29, 80
 s_lshr_b32 s29, s29, 2
 s_lshl_b32 s29, s29, 10
 v_and_b32 v9, 0xf0, v0
 v_lshl_add_u32 v9, v9, 3, s28
 v_cmp_gt_u32 vcc, 256, v0
 v_and_b32 v10, 0x70, v0
 v_lshl_add_u32 v10, v10, 3, s29
 v_cndmask_b32 v9, v10, v9, vcc
 s_mov_b32 s36, 131072
 buffer_load_dword v10, v9, s[4:7], s36 offen sc1
 buffer_load_dwordx4 a[144:147], v0, s[4:7], s48 offen offset:2048 sc1
 buffer_load_dwordx4 a[148:151], v0, s[4:7], s49 offen offset:2048 sc1
 s_add_u32 s48, s48, 4096
 s_add_u32 s49, s49, 4096
 buffer_load_dwordx4 a[152:155], v0, s[4:7], s48 offen sc1
 buffer_load_dwordx4 a[156:159], v0, s[4:7], s49 offen sc1
 s_nop 11
 s_branch L6_aepi
L16_x:
 s_waitcnt lgkmcnt(0)
 v_mfma_f32_32x32x16_bf16 v[80:95], v[252:255], v[100:103], v[80:95]
 buffer_load_dwordx4 a[128:131], v0, s[4:7], s48 offen offset:2048 sc1
 buffer_load_dwordx4 a[132:135], v0, s[4:7], s49 offen offset:2048 sc1
 s_add_u32 s48, s48, 4096
 s_add_u32 s49, s49, 4096
 buffer_load_dwordx4 a[136:139], v0, s[4:7], s48 offen sc1
 buffer_load_dwordx4 a[140:143], v0, s[4:7], s49 offen sc1
 s_mul_i32 s28, s52, 5
 s_lshr_b32 s28, s28, 2
 s_lshl_b32 s28, s28, 10
 s_min_u32 s29, s52, 5
 s_add_u32 s29, s29, 80
 s_lshr_b32 s29, s29, 2
 s_lshl_b32 s29, s29, 10
 v_and_b32 v9, 0xf0, v0
 v_lshl_add_u32 v9, v9, 3, s28
 v_cmp_gt_u32 vcc, 256, v0
 v_and_b32 v10, 0x70, v0
 v_lshl_add_u32 v10, v10, 3, s29
 v_cndmask_b32 v9, v10, v9, vcc
 s_mov_b32 s36, 131072
 buffer_load_dword v10, v9, s[4:7], s36 offen sc1
 buffer_load_dwordx4 a[144:147], v0, s[4:7], s48 offen offset:2048 sc1
 buffer_load_dwordx4 a[148:151], v0, s[4:7], s49 offen offset:2048 sc1
 s_add_u32 s48, s48, 4096
 s_add_u32 s49, s49, 4096
 buffer_load_dwordx4 a[152:155], v0, s[4:7], s48 offen sc1
 buffer_load_dwordx4 a[156:159], v0, s[4:7], s49 offen sc1
 s_nop 11
 s_branch L6_aepi
L17_fb:
 s_waitcnt lgkmcnt(0)
 s_nop 15
 s_min_u32 s33, s21, 8
 s_add_u32 s34, s71, 8
 s_lshl_b32 s34, s34, 12
 v_add_u32 v30, s34, v28
 v_add_u32 v31, s34, v29
 s_mov_b32 s32, 0
 v_mov_b32 v2, 0xff7fffff
L17_fb_p1:
 ds_read_b128 v[104:107], v30 offset:0
 s_waitcnt lgkmcnt(0)
 s_cmp_eq_u32 s32, 0
 s_cbranch_scc1 L17_fb_xa
 s_cmp_eq_u32 s32, 8
 s_cbranch_scc1 L17_fb_xb
 v_mfma_f32_32x32x16_bf16 v[32:47], v[104:107], v[116:119], 0
 s_branch L17_fb_xc
L17_fb_xa:
 v_mfma_f32_32x32x16_bf16 v[32:47], v[104:107], v[116:119], v[208:223]
 s_branch L17_fb_xc
L17_fb_xb:
 v_mfma_f32_32x32x16_bf16 v[32:47], v[104:107], v[116:119], v[224:239]
L17_fb_xc:
 s_nop 15
 v_max3_f32 v2, v2, v32, v33
 v_max3_f32 v2, v2, v34, v35
 v_max3_f32 v2, v2, v36, v37
 v_max3_f32 v2, v2, v38, v39
 v_max3_f32 v2, v2, v40, v41
 v_max3_f32 v2, v2, v42, v43
 v_max3_f32 v2, v2, v44, v45
 v_max3_f32 v2, v2, v46, v47
 v_subrev_u32 v30, 4096, v30
 v_subrev_u32 v31, 4096, v31
 s_add_u32 s32, s32, 1
 s_cmp_le_u32 s32, s33
 s_cbranch_scc1 L17_fb_p1
 v_mov_b32 v1, v2
 s_nop 1
 v_permlane32_swap_b32 v1, v2
 v_max_f32 v2, v2, v1
 v_mov_b32 v80, 0
 v_mov_b32 v81, 0
 v_mov_b32 v82, 0
 v_mov_b32 v83, 0
 v_mov_b32 v84, 0
 v_mov_b32 v85, 0
 v_mov_b32 v86, 0
 v_mov_b32 v87, 0
 v_mov_b32 v88, 0
 v_mov_b32 v89, 0
 v_mov_b32 v90, 0
 v_mov_b32 v91, 0
 v_mov_b32 v92, 0
 v_mov_b32 v93, 0
 v_mov_b32 v94, 0
 v_mov_b32 v95, 0
 v_add_u32 v30, s34, v28
 v_add_u32 v31, s34, v29
 s_mov_b32 s32, 0
L17_fb_p2:
 s_mov_b64 exec, s[66:67]
 ds_read_b128 v[240:243], v31 offset:2048
 ds_read_b128 v[244:247], v31 offset:3072
 s_mov_b64 exec, -1
 ds_read_b128 v[104:107], v30 offset:0
 s_waitcnt lgkmcnt(0)
 s_cmp_eq_u32 s32, 0
 s_cbranch_scc1 L17_fb_ya
 s_cmp_eq_u32 s32, 8
 s_cbranch_scc1 L17_fb_yb
 v_mfma_f32_32x32x16_bf16 v[32:47], v[104:107], v[116:119], 0
 s_branch L17_fb_yc
L17_fb_ya:
 v_mfma_f32_32x32x16_bf16 v[32:47], v[104:107], v[116:119], v[208:223]
 s_branch L17_fb_yc
L17_fb_yb:
 v_mfma_f32_32x32x16_bf16 v[32:47], v[104:107], v[116:119], v[224:239]
L17_fb_yc:
 s_nop 15
 v_sub_f32 v32, v32, v2
 v_sub_f32 v33, v33, v2
 v_sub_f32 v34, v34, v2
 v_sub_f32 v35, v35, v2
 v_sub_f32 v36, v36, v2
 v_sub_f32 v37, v37, v2
 v_sub_f32 v38, v38, v2
 v_sub_f32 v39, v39, v2
 v_sub_f32 v40, v40, v2
 v_sub_f32 v41, v41, v2
 v_sub_f32 v42, v42, v2
 v_sub_f32 v43, v43, v2
 v_sub_f32 v44, v44, v2
 v_sub_f32 v45, v45, v2
 v_sub_f32 v46, v46, v2
 v_sub_f32 v47, v47, v2
 v_exp_f32 v32, v32
 v_exp_f32 v33, v33
 v_exp_f32 v34, v34
 v_exp_f32 v35, v35
 v_exp_f32 v36, v36
 v_exp_f32 v37, v37
 v_exp_f32 v38, v38
 v_exp_f32 v39, v39
 v_exp_f32 v40, v40
 v_exp_f32 v41, v41
 v_exp_f32 v42, v42
 v_exp_f32 v43, v43
 v_exp_f32 v44, v44
 v_exp_f32 v45, v45
 v_exp_f32 v46, v46
 v_exp_f32 v47, v47
 v_cvt_pk_bf16_f32 v96, v32, v33
 v_cvt_pk_bf16_f32 v97, v34, v35
 v_cvt_pk_bf16_f32 v98, v36, v37
 v_cvt_pk_bf16_f32 v99, v38, v39
 v_cvt_pk_bf16_f32 v100, v40, v41
 v_cvt_pk_bf16_f32 v101, v42, v43
 v_cvt_pk_bf16_f32 v102, v44, v45
 v_cvt_pk_bf16_f32 v103, v46, v47
 v_mfma_f32_32x32x16_bf16 v[80:95], v[240:243], v[96:99], v[80:95]
 s_nop 0
 v_mfma_f32_32x32x16_bf16 v[80:95], v[244:247], v[100:103], v[80:95]
 s_nop 15
 v_subrev_u32 v30, 4096, v30
 v_subrev_u32 v31, 4096, v31
 s_add_u32 s32, s32, 1
 s_cmp_le_u32 s32, s33
 s_cbranch_scc1 L17_fb_p2
 s_branch L18_fbret
L19_fb:
 s_waitcnt lgkmcnt(0)
 s_nop 15
 s_min_u32 s33, s20, 8
 s_add_u32 s34, s70, 8
 s_lshl_b32 s34, s34, 12
 v_add_u32 v30, s34, v28
 v_add_u32 v31, s34, v29
 s_mov_b32 s32, 0
 v_mov_b32 v2, 0xff7fffff
L19_fb_p1:
 ds_read_b128 v[104:107], v30 offset:0
 s_waitcnt lgkmcnt(0)
 s_cmp_eq_u32 s32, 0
 s_cbranch_scc1 L19_fb_xa
 s_cmp_eq_u32 s32, 8
 s_cbranch_scc1 L19_fb_xb
 v_mfma_f32_32x32x16_bf16 v[32:47], v[104:107], v[112:115], 0
 s_branch L19_fb_xc
L19_fb_xa:
 v_mfma_f32_32x32x16_bf16 v[32:47], v[104:107], v[112:115], v[208:223]
 s_branch L19_fb_xc
L19_fb_xb:
 v_mfma_f32_32x32x16_bf16 v[32:47], v[104:107], v[112:115], v[224:239]
L19_fb_xc:
 s_nop 15
 v_max3_f32 v2, v2, v32, v33
 v_max3_f32 v2, v2, v34, v35
 v_max3_f32 v2, v2, v36, v37
 v_max3_f32 v2, v2, v38, v39
 v_max3_f32 v2, v2, v40, v41
 v_max3_f32 v2, v2, v42, v43
 v_max3_f32 v2, v2, v44, v45
 v_max3_f32 v2, v2, v46, v47
 v_subrev_u32 v30, 4096, v30
 v_subrev_u32 v31, 4096, v31
 s_add_u32 s32, s32, 1
 s_cmp_le_u32 s32, s33
 s_cbranch_scc1 L19_fb_p1
 v_mov_b32 v1, v2
 s_nop 1
 v_permlane32_swap_b32 v1, v2
 v_max_f32 v2, v2, v1
 v_mov_b32 v64, 0
 v_mov_b32 v65, 0
 v_mov_b32 v66, 0
 v_mov_b32 v67, 0
 v_mov_b32 v68, 0
 v_mov_b32 v69, 0
 v_mov_b32 v70, 0
 v_mov_b32 v71, 0
 v_mov_b32 v72, 0
 v_mov_b32 v73, 0
 v_mov_b32 v74, 0
 v_mov_b32 v75, 0
 v_mov_b32 v76, 0
 v_mov_b32 v77, 0
 v_mov_b32 v78, 0
 v_mov_b32 v79, 0
 v_add_u32 v30, s34, v28
 v_add_u32 v31, s34, v29
 s_mov_b32 s32, 0
L19_fb_p2:
 s_mov_b64 exec, s[66:67]
 ds_read_b128 v[240:243], v31 offset:2048
 ds_read_b128 v[244:247], v31 offset:3072
 s_mov_b64 exec, -1
 ds_read_b128 v[104:107], v30 offset:0
 s_waitcnt lgkmcnt(0)
 s_cmp_eq_u32 s32, 0
 s_cbranch_scc1 L19_fb_ya
 s_cmp_eq_u32 s32, 8
 s_cbranch_scc1 L19_fb_yb
 v_mfma_f32_32x32x16_bf16 v[32:47], v[104:107], v[112:115], 0
 s_branch L19_fb_yc
L19_fb_ya:
 v_mfma_f32_32x32x16_bf16 v[32:47], v[104:107], v[112:115], v[208:223]
 s_branch L19_fb_yc
L19_fb_yb:
 v_mfma_f32_32x32x16_bf16 v[32:47], v[104:107], v[112:115], v[224:239]
L19_fb_yc:
 s_nop 15
 v_sub_f32 v32, v32, v2
 v_sub_f32 v33, v33, v2
 v_sub_f32 v34, v34, v2
 v_sub_f32 v35, v35, v2
 v_sub_f32 v36, v36, v2
 v_sub_f32 v37, v37, v2
 v_sub_f32 v38, v38, v2
 v_sub_f32 v39, v39, v2
 v_sub_f32 v40, v40, v2
 v_sub_f32 v41, v41, v2
 v_sub_f32 v42, v42, v2
 v_sub_f32 v43, v43, v2
 v_sub_f32 v44, v44, v2
 v_sub_f32 v45, v45, v2
 v_sub_f32 v46, v46, v2
 v_sub_f32 v47, v47, v2
 v_exp_f32 v32, v32
 v_exp_f32 v33, v33
 v_exp_f32 v34, v34
 v_exp_f32 v35, v35
 v_exp_f32 v36, v36
 v_exp_f32 v37, v37
 v_exp_f32 v38, v38
 v_exp_f32 v39, v39
 v_exp_f32 v40, v40
 v_exp_f32 v41, v41
 v_exp_f32 v42, v42
 v_exp_f32 v43, v43
 v_exp_f32 v44, v44
 v_exp_f32 v45, v45
 v_exp_f32 v46, v46
 v_exp_f32 v47, v47
 v_cvt_pk_bf16_f32 v96, v32, v33
 v_cvt_pk_bf16_f32 v97, v34, v35
 v_cvt_pk_bf16_f32 v98, v36, v37
 v_cvt_pk_bf16_f32 v99, v38, v39
 v_cvt_pk_bf16_f32 v100, v40, v41
 v_cvt_pk_bf16_f32 v101, v42, v43
 v_cvt_pk_bf16_f32 v102, v44, v45
 v_cvt_pk_bf16_f32 v103, v46, v47
 v_mfma_f32_32x32x16_bf16 v[64:79], v[240:243], v[96:99], v[64:79]
 s_nop 0
 v_mfma_f32_32x32x16_bf16 v[64:79], v[244:247], v[100:103], v[64:79]
 s_nop 15
 v_subrev_u32 v30, 4096, v30
 v_subrev_u32 v31, 4096, v31
 s_add_u32 s32, s32, 1
 s_cmp_le_u32 s32, s33
 s_cbranch_scc1 L19_fb_p2
 s_branch L20_fbret
L21_rel:
 s_waitcnt vmcnt(0)
 buffer_wbl2 sc1
 s_waitcnt vmcnt(0)
 buffer_store_dword v2, v0, s[4:7], s24 offen sc1
 buffer_store_dword v2, v0, s[4:7], s25 offen sc1
 s_branch L22_relb
L25_spin:
 buffer_load_dword v10, v9, s[4:7], s36 offen offset:0 sc1
 s_sub_u32 s57, s57, 1
 s_cbranch_scc1 L25_spin_x
 s_waitcnt vmcnt(0)
 v_cmp_ne_u32 vcc, s55, v10
 s_cbranch_vccnz L25_spin
 s_branch L26_got
L25_spin_x:
 s_mov_b32 s57, 0
 s_waitcnt vmcnt(0)
 s_branch L26_got
L27_rel:
 s_waitcnt vmcnt(0)
 buffer_wbl2 sc1
 s_waitcnt vmcnt(0)
 buffer_store_dword v2, v0, s[4:7], s30 offen sc1
 s_branch L28_relb
L31_rel:
 s_waitcnt vmcnt(0)
 buffer_wbl2 sc1
 s_waitcnt vmcnt(0)
 buffer_store_dword v2, v0, s[4:7], s30 offen sc1
 s_branch L32_relb
L33_spin:
 buffer_load_dword v240, v1, s[4:7], s28 offen offset:64 sc1
 s_sub_u32 s57, s57, 1
 s_cbranch_scc1 L33_spin_x
 s_waitcnt vmcnt(0)
 v_cmp_ne_u32 vcc, s55, v240
 s_cbranch_vccnz L33_spin
 s_branch L34_got
L33_spin_x:
 s_mov_b32 s57, 0
 s_waitcnt vmcnt(0)
 s_branch L34_got
L37_rel:
 s_waitcnt vmcnt(0)
 buffer_wbl2 sc1
 s_waitcnt vmcnt(0)
 buffer_store_dword v2, v0, s[4:7], s36 offen sc1
 s_branch L38_relb
L39_rel:
 s_waitcnt vmcnt(0)
 buffer_wbl2 sc1
 s_waitcnt vmcnt(0)
 buffer_store_dword v2, v0, s[4:7], s38 offen sc1
 s_branch L40_relb
L35_five:
 s_nop 9
 v_pk_mul_f32 v[224:225], v[2:3], v[224:225] op_sel:[1,0]
 v_pk_mul_f32 v[226:227], v[2:3], v[226:227] op_sel:[1,0]
 v_pk_mul_f32 v[228:229], v[2:3], v[228:229] op_sel:[1,0]
 v_pk_mul_f32 v[230:231], v[2:3], v[230:231] op_sel:[1,0]
 v_pk_mul_f32 v[224:225], v[224:225], v[232:233]
 v_pk_mul_f32 v[226:227], v[226:227], v[234:235]
 v_pk_mul_f32 v[228:229], v[228:229], v[236:237]
 v_pk_mul_f32 v[230:231], v[230:231], v[238:239]
 v_cvt_pk_bf16_f32 v224, v224, v225
 v_cvt_pk_bf16_f32 v225, v226, v227
 v_cvt_pk_bf16_f32 v226, v228, v229
 v_cvt_pk_bf16_f32 v227, v230, v231
 buffer_store_dwordx4 v[224:227], v0, s[4:7], s34 offen sc1
 s_mov_b32 s39, 2146435072
 v_mov_b32 v2, s55
 s_cmp_lg_u32 s68, 0
 s_mov_b64 exec, 1
 s_waitcnt vmcnt(6)
 s_cbranch_scc1 L37_rel
 buffer_store_dword v2, v0, s[4:7], s36 offen
L38_relb:
 s_mov_b64 exec, -1
 v_mov_b32 v2, s55
 s_cmp_lg_u32 s68, 0
 s_mov_b64 exec, 1
 s_waitcnt vmcnt(1)
 s_cbranch_scc1 L39_rel
 buffer_store_dword v2, v0, s[4:7], s38 offen
L40_relb:
 s_mov_b64 exec, -1
 buffer_load_dword v160, v1, s[4:7], s28 offen sc1
 s_branch L36_gujoin
L41_rel:
 s_waitcnt vmcnt(0)
 buffer_wbl2 sc1
 s_waitcnt vmcnt(0)
 buffer_store_dword v2, v0, s[4:7], s36 offen sc1
 s_branch L42_relb
L43_rel:
 s_waitcnt vmcnt(0)
 buffer_wbl2 sc1
 s_waitcnt vmcnt(0)
 buffer_store_dword v2, v0, s[4:7], s38 offen sc1
 s_branch L44_relb
L46_spin:
 buffer_load_dword v160, v1, s[4:7], s28 offen offset:0 sc1
 s_sub_u32 s57, s57, 1
 s_cbranch_scc1 L46_spin_x
 s_waitcnt vmcnt(0)
 v_cmp_ne_u32 vcc, s55, v160
 s_cbranch_vccnz L46_spin
 s_branch L47_got
L46_spin_x:
 s_mov_b32 s57, 0
 s_waitcnt vmcnt(0)
 s_branch L47_got
L48_rel:
 s_waitcnt vmcnt(0)
 buffer_wbl2 sc1
 s_waitcnt vmcnt(0)
 buffer_store_dword v2, v0, s[4:7], s39 offen sc1
 s_branch L49_relb
L50_spin:
 buffer_load_dword v3, v1, s[4:7], s28 offen offset:64 sc1
 s_sub_u32 s57, s57, 1
 s_cbranch_scc1 L50_spin_x
 s_waitcnt vmcnt(0)
 v_cmp_ne_u32 vcc, s55, v3
 s_cbranch_vccnz L50_spin
 s_branch L51_got
L50_spin_x:
 s_mov_b32 s57, 0
 s_waitcnt vmcnt(0)
 s_branch L51_got
L52_spin:
 buffer_load_dword v3, v8, s[4:7], s32 offen offset:0 sc1
 s_sub_u32 s57, s57, 1
 s_cbranch_scc1 L52_spin_x
 s_waitcnt vmcnt(0)
 v_cmp_ne_u32 vcc, s55, v3
 s_cbranch_vccnz L52_spin
 s_branch L53_got
L52_spin_x:
 s_mov_b32 s57, 0
 s_waitcnt vmcnt(0)
 s_branch L53_got
L54_rel:
 s_waitcnt vmcnt(0)
 buffer_wbl2 sc1
 s_waitcnt vmcnt(0)
 buffer_store_dword v2, v0, s[4:7], s30 offen sc1
 s_branch L55_relb
L58_rel:
 s_waitcnt vmcnt(0)
 buffer_wbl2 sc1
 s_waitcnt vmcnt(0)
 buffer_store_dword v2, v0, s[4:7], s30 offen sc1
 s_branch L59_relb
L60_spin:
 buffer_load_dword v30, v1, s[4:7], s28 offen offset:64 sc1
 s_sub_u32 s57, s57, 1
 s_cbranch_scc1 L60_spin_x
 s_waitcnt vmcnt(0)
 v_cmp_ne_u32 vcc, s55, v30
 s_cbranch_vccnz L60_spin
 s_branch L61_got
L60_spin_x:
 s_mov_b32 s57, 0
 s_waitcnt vmcnt(0)
 s_branch L61_got
L65_spin:
 buffer_load_dword v31, v30, s[4:7], s35 offen offset:0 sc1
 s_sub_u32 s57, s57, 1
 s_cbranch_scc1 L65_spin_x
 s_waitcnt vmcnt(0)
 v_cmp_ne_u32 vcc, s55, v31
 s_cbranch_vccnz L65_spin
 s_branch L66_got
L65_spin_x:
 s_mov_b32 s57, 0
 s_waitcnt vmcnt(0)
 s_branch L66_got
L69_spin:
 buffer_load_dword v31, v30, s[4:7], s28 offen offset:0 sc1
 s_sub_u32 s57, s57, 1
 s_cbranch_scc1 L69_spin_x
 s_waitcnt vmcnt(0)
 v_and_b32 v1, 0xfffffff0, v31
 v_cmp_ne_u32 vcc, s55, v1
 s_cbranch_vccnz L69_spin
 s_branch L70_got
L69_spin_x:
 s_mov_b32 s57, 0
 s_waitcnt vmcnt(0)
 s_branch L70_got
L71_spin:
 buffer_load_dword v31, v30, s[4:7], s28 offen offset:0 sc1
 s_sub_u32 s57, s57, 1
 s_cbranch_scc1 L71_spin_x
 s_waitcnt vmcnt(0)
 v_and_b32 v1, 0xfffffff0, v31
 v_cmp_ne_u32 vcc, s55, v1
 s_cbranch_vccnz L71_spin
 s_branch L72_got
L71_spin_x:
 s_mov_b32 s57, 0
 s_waitcnt vmcnt(0)
 s_branch L72_got
L73_spin:
 buffer_load_dword v31, v30, s[4:7], s28 offen offset:0 sc1
 s_sub_u32 s57, s57, 1
 s_cbranch_scc1 L73_spin_x
 s_waitcnt vmcnt(0)
 v_and_b32 v1, 0xfffffff0, v31
 v_cmp_ne_u32 vcc, s55, v1
 s_cbranch_vccnz L73_spin
 s_branch L74_got
L73_spin_x:
 s_mov_b32 s57, 0
 s_waitcnt vmcnt(0)
 s_branch L74_got
L75_spin:
 buffer_load_dword v31, v30, s[4:7], s28 offen offset:0 sc1
 s_sub_u32 s57, s57, 1
 s_cbranch_scc1 L75_spin_x
 s_waitcnt vmcnt(0)
 v_and_b32 v1, 0xfffffff0, v31
 v_cmp_ne_u32 vcc, s55, v1
 s_cbranch_vccnz L75_spin
 s_branch L76_got
L75_spin_x:
 s_mov_b32 s57, 0
 s_waitcnt vmcnt(0)
 s_branch L76_got
L67_x:
 s_waitcnt vmcnt(0)
 s_barrier
 s_or_b32 s28, s2, s50
 s_cmp_lg_u32 s28, 0
 s_cbranch_scc1 L68_noepoch
 v_lshlrev_b32 v30, 3, v0
 s_mov_b32 s28, 4096
 buffer_load_dword v31, v30, s[4:7], s28 offen sc1
 s_waitcnt vmcnt(0)
 v_and_b32 v1, 0xfffffff0, v31
 v_cmp_ne_u32 vcc, s55, v1
 s_cbranch_vccnz L69_spin
L70_got:
 s_mov_b32 s28, 12288
 buffer_load_dword v31, v30, s[4:7], s28 offen sc1
 s_waitcnt vmcnt(0)
 v_and_b32 v1, 0xfffffff0, v31
 v_cmp_ne_u32 vcc, s55, v1
 s_cbranch_vccnz L71_spin
L72_got:
 s_mov_b32 s28, 20480
 buffer_load_dword v31, v30, s[4:7], s28 offen sc1
 s_waitcnt vmcnt(0)
 v_and_b32 v1, 0xfffffff0, v31
 v_cmp_ne_u32 vcc, s55, v1
 s_cbranch_vccnz L73_spin
L74_got:
 s_mov_b32 s28, 28672
 buffer_load_dword v31, v30, s[4:7], s28 offen sc1
 s_waitcnt vmcnt(0)
 v_and_b32 v1, 0xfffffff0, v31
 v_cmp_ne_u32 vcc, s55, v1
 s_cbranch_vccnz L75_spin
L76_got:
 v_lshrrev_b32 v1, 2, v0
 v_mov_b32 v2, s55
 s_mov_b32 exec_hi, 0
 buffer_store_dword v2, v1, s[4:7], 0 offen sc1
 s_mov_b32 exec_hi, -1
L68_noepoch:
 s_lshl_b32 s28, s50, 14
 s_add_u32 s28, s28, s41
 s_add_u32 s28, s28, 14336
 s_xor_b32 s29, s28, 1024
 buffer_load_dwordx4 v[144:147], v0, s[4:7], s28 offen sc1
 buffer_load_dwordx4 v[148:151], v0, s[4:7], s29 offen sc1
 s_mul_i32 s37, s52, 204800
 s_mul_i32 s3, s50, 0xffffec00
 s_add_u32 s37, s37, s3
 s_add_u32 s37, s37, 19033088
 s_add_u32 m0, s65, 65536
 s_nop 0
 buffer_load_dwordx4 v0, s[4:7], s37 offen sc1 lds
 buffer_load_dwordx4 v0, s[4:7], s37 offen offset:1024 sc1 lds
 buffer_load_dwordx4 v0, s[4:7], s37 offen offset:2048 sc1 lds
 buffer_load_dwordx4 v0, s[4:7], s37 offen offset:3072 sc1 lds
 s_sub_u32 s37, s37, 20480
 s_add_u32 m0, s65, 81920
 s_nop 0
 buffer_load_dwordx4 v0, s[4:7], s37 offen sc1 lds
 buffer_load_dwordx4 v0, s[4:7], s37 offen offset:1024 sc1 lds
 buffer_load_dwordx4 v0, s[4:7], s37 offen offset:2048 sc1 lds
 buffer_load_dwordx4 v0, s[4:7], s37 offen offset:3072 sc1 lds
 s_sub_u32 s37, s37, 20480
 s_add_u32 m0, s65, 98304
 s_nop 0
 buffer_load_dwordx4 v0, s[4:7], s37 offen sc1 lds
 buffer_load_dwordx4 v0, s[4:7], s37 offen offset:1024 sc1 lds
 buffer_load_dwordx4 v0, s[4:7], s37 offen offset:2048 sc1 lds
 buffer_load_dwordx4 v0, s[4:7], s37 offen offset:3072 sc1 lds
 s_sub_u32 s37, s37, 20480
 s_add_u32 m0, s65, 114688
 s_nop 0
 buffer_load_dwordx4 v0, s[4:7], s37 offen sc1 lds
 buffer_load_dwordx4 v0, s[4:7], s37 offen offset:1024 sc1 lds
 buffer_load_dwordx4 v0, s[4:7], s37 offen offset:2048 sc1 lds
 buffer_load_dwordx4 v0, s[4:7], s37 offen offset:3072 sc1 lds
 s_sub_u32 s37, s37, 20480
 s_add_u32 m0, s65, 131072
 s_nop 0
 buffer_load_dwordx4 v0, s[4:7], s37 offen sc1 lds
 buffer_load_dwordx4 v0, s[4:7], s37 offen offset:1024 sc1 lds
 buffer_load_dwordx4 v0, s[4:7], s37 offen offset:2048 sc1 lds
 buffer_load_dwordx4 v0, s[4:7], s37 offen offset:3072 sc1 lds
 s_sub_u32 s37, s37, 20480
 s_add_u32 m0, s65, 147456
 s_nop 0
 buffer_load_dwordx4 v0, s[4:7], s37 offen sc1 lds
 buffer_load_dwordx4 v0, s[4:7], s37 offen offset:1024 sc1 lds
 buffer_load_dwordx4 v0, s[4:7], s37 offen offset:2048 sc1 lds
 buffer_load_dwordx4 v0, s[4:7], s37 offen offset:3072 sc1 lds
 s_sub_u32 s37, s37, 20480
 s_nop 11
 s_branch L63_aepi
L77_x:
 s_waitcnt lgkmcnt(0)
 v_mfma_f32_32x32x16_bf16 v[80:95], v[252:255], v[100:103], v[80:95]
 s_add_u32 m0, s65, 131072
 s_nop 0
 buffer_load_dwordx4 v0, s[4:7], s37 offen sc1 lds
 buffer_load_dwordx4 v0, s[4:7], s37 offen offset:1024 sc1 lds
 buffer_load_dwordx4 v0, s[4:7], s37 offen offset:2048 sc1 lds
 buffer_load_dwordx4 v0, s[4:7], s37 offen offset:3072 sc1 lds
 s_sub_u32 s37, s37, 20480
 s_add_u32 m0, s65, 147456
 s_nop 0
 buffer_load_dwordx4 v0, s[4:7], s37 offen sc1 lds
 buffer_load_dwordx4 v0, s[4:7], s37 offen offset:1024 sc1 lds
 buffer_load_dwordx4 v0, s[4:7], s37 offen offset:2048 sc1 lds
 buffer_load_dwordx4 v0, s[4:7], s37 offen offset:3072 sc1 lds
 s_sub_u32 s37, s37, 20480
 s_nop 11
 s_branch L63_aepi
L62_p1:
 ds_read_b128 v[104:107], v28 offset:32768
 ds_read_b128 v[108:111], v28 offset:36864
 s_mov_b64 exec, s[66:67]
 ds_read_b128 v[240:243], v29 offset:34816
 ds_read_b128 v[244:247], v29 offset:35840
 s_mov_b64 exec, -1
 ds_read_b128 v[112:115], v28 offset:55296
 ds_read_b128 v[116:119], v28 offset:59392
 buffer_load_dword v31, v30, s[4:7], s35 offen sc1
 s_waitcnt lgkmcnt(1)
 v_mfma_f32_32x32x16_bf16 v[32:47], v[104:107], v[112:115], 0
 s_waitcnt lgkmcnt(0)
 v_mfma_f32_32x32x16_bf16 v[48:63], v[104:107], v[116:119], 0
 ds_read_b128 v[104:107], v28 offset:40960
 s_nop 8
 v_exp_f32 v32, v32
 v_exp_f32 v33, v33
 s_mov_b64 exec, s[66:67]
 ds_read_b128 v[248:251], v29 offset:38912
 ds_read_b128 v[252:255], v29 offset:39936
 s_mov_b64 exec, -1
 v_exp_f32 v34, v34
 v_cvt_pk_bf16_f32 v96, v32, v33
 v_exp_f32 v35, v35
 v_exp_f32 v36, v36
 v_cvt_pk_bf16_f32 v97, v34, v35
 v_exp_f32 v37, v37
 v_exp_f32 v38, v38
 v_cvt_pk_bf16_f32 v98, v36, v37
 v_exp_f32 v39, v39
 v_exp_f32 v40, v40
 v_cvt_pk_bf16_f32 v99, v38, v39
 v_exp_f32 v41, v41
 v_exp_f32 v42, v42
 v_mfma_f32_32x32x16_bf16 v[64:79], v[240:243], v[96:99], 0
 v_cvt_pk_bf16_f32 v100, v40, v41
 v_exp_f32 v43, v43
 v_exp_f32 v44, v44
 v_cvt_pk_bf16_f32 v101, v42, v43
 v_exp_f32 v45, v45
 v_exp_f32 v46, v46
 v_exp_f32 v47, v47
 v_cvt_pk_bf16_f32 v102, v44, v45
 v_cvt_pk_bf16_f32 v103, v46, v47
 v_exp_f32 v48, v48
 v_exp_f32 v49, v49
 v_mfma_f32_32x32x16_bf16 v[64:79], v[244:247], v[100:103], v[64:79]
 v_exp_f32 v50, v50
 v_cvt_pk_bf16_f32 v96, v48, v49
 v_exp_f32 v51, v51
 v_exp_f32 v52, v52
 v_cvt_pk_bf16_f32 v97, v50, v51
 v_mfma_f32_32x32x16_bf16 v[32:47], v[108:111], v[112:115], v[208:223]
 v_exp_f32 v53, v53
 v_exp_f32 v54, v54
 v_cvt_pk_bf16_f32 v98, v52, v53
 v_exp_f32 v55, v55
 v_exp_f32 v56, v56
 v_cvt_pk_bf16_f32 v99, v54, v55
 v_exp_f32 v57, v57
 v_exp_f32 v58, v58
 v_mfma_f32_32x32x16_bf16 v[80:95], v[240:243], v[96:99], 0
 v_cvt_pk_bf16_f32 v100, v56, v57
 v_exp_f32 v59, v59
 v_exp_f32 v60, v60
 v_cvt_pk_bf16_f32 v101, v58, v59
 v_exp_f32 v61, v61
 v_exp_f32 v62, v62
 v_exp_f32 v63, v63
 v_cvt_pk_bf16_f32 v102, v60, v61
 v_cvt_pk_bf16_f32 v103, v62, v63
 v_exp_f32 v32, v32
 v_exp_f32 v33, v33
 v_mfma_f32_32x32x16_bf16 v[80:95], v[244:247], v[100:103], v[80:95]
 s_mov_b64 exec, s[66:67]
 ds_read_b128 v[240:243], v29 offset:43008
 ds_read_b128 v[244:247], v29 offset:44032
 s_mov_b64 exec, -1
 v_exp_f32 v34, v34
 v_cvt_pk_bf16_f32 v96, v32, v33
 v_exp_f32 v35, v35
 s_add_u32 m0, s65, 16384
 s_cmp_eq_u32 s51, 0
 s_waitcnt vmcnt(0)
 s_cbranch_scc1 L64_g0
 v_cmp_ne_u32 vcc, s55, v31
 s_cbranch_vccnz L65_spin
L66_got:
L64_g0:
 buffer_load_dwordx4 v0, s[4:7], s36 offen sc1 nt lds
 buffer_load_dwordx4 v0, s[4:7], s36 offen offset:1024 sc1 nt lds
 buffer_load_dwordx4 v0, s[4:7], s36 offen offset:2048 sc1 nt lds
 buffer_load_dwordx4 v0, s[4:7], s36 offen offset:3072 sc1 nt lds
 v_exp_f32 v36, v36
 v_cvt_pk_bf16_f32 v97, v34, v35
 v_mfma_f32_32x32x16_bf16 v[48:63], v[108:111], v[116:119], 0
 v_exp_f32 v37, v37
 v_exp_f32 v38, v38
 v_cvt_pk_bf16_f32 v98, v36, v37
 v_exp_f32 v39, v39
 v_exp_f32 v40, v40
 v_cvt_pk_bf16_f32 v99, v38, v39
 v_exp_f32 v41, v41
 v_exp_f32 v42, v42
 s_waitcnt lgkmcnt(2)
 v_mfma_f32_32x32x16_bf16 v[64:79], v[248:251], v[96:99], v[64:79]
 v_cvt_pk_bf16_f32 v100, v40, v41
 v_exp_f32 v43, v43
 v_exp_f32 v44, v44
 v_cvt_pk_bf16_f32 v101, v42, v43
 v_exp_f32 v45, v45
 v_exp_f32 v46, v46
 v_exp_f32 v47, v47
 v_cvt_pk_bf16_f32 v102, v44, v45
 v_cvt_pk_bf16_f32 v103, v46, v47
 v_exp_f32 v48, v48
 v_exp_f32 v49, v49
 v_mfma_f32_32x32x16_bf16 v[64:79], v[252:255], v[100:103], v[64:79]
 v_exp_f32 v50, v50
 v_cvt_pk_bf16_f32 v96, v48, v49
 v_exp_f32 v51, v51
 v_exp_f32 v52, v52
 v_cvt_pk_bf16_f32 v97, v50, v51
 v_mfma_f32_32x32x16_bf16 v[32:47], v[104:107], v[116:119], v[208:223]
 v_exp_f32 v53, v53
 v_exp_f32 v54, v54
 v_cvt_pk_bf16_f32 v98, v52, v53
 v_exp_f32 v55, v55
 v_exp_f32 v56, v56
 v_cvt_pk_bf16_f32 v99, v54, v55
 v_exp_f32 v57, v57
 v_exp_f32 v58, v58
 v_mfma_f32_32x32x16_bf16 v[80:95], v[248:251], v[96:99], v[80:95]
 v_cvt_pk_bf16_f32 v100, v56, v57
 v_exp_f32 v59, v59
 v_exp_f32 v60, v60
 v_cvt_pk_bf16_f32 v101, v58, v59
 v_exp_f32 v61, v61
 v_exp_f32 v62, v62
 v_exp_f32 v63, v63
 v_cvt_pk_bf16_f32 v102, v60, v61
 v_cvt_pk_bf16_f32 v103, v62, v63
 v_exp_f32 v32, v32
 v_exp_f32 v33, v33
 v_mfma_f32_32x32x16_bf16 v[80:95], v[252:255], v[100:103], v[80:95]
 v_exp_f32 v34, v34
 v_cvt_pk_bf16_f32 v96, v32, v33
 v_exp_f32 v35, v35
 v_exp_f32 v36, v36
 v_cvt_pk_bf16_f32 v97, v34, v35
 v_exp_f32 v37, v37
 v_exp_f32 v38, v38
 v_cvt_pk_bf16_f32 v98, v36, v37
 v_exp_f32 v39, v39
 v_exp_f32 v40, v40
 v_cvt_pk_bf16_f32 v99, v38, v39
 v_exp_f32 v41, v41
 v_exp_f32 v42, v42
 s_waitcnt lgkmcnt(0)
 v_mfma_f32_32x32x16_bf16 v[80:95], v[240:243], v[96:99], v[80:95]
 v_cvt_pk_bf16_f32 v100, v40, v41
 v_exp_f32 v43, v43
 v_exp_f32 v44, v44
 v_cvt_pk_bf16_f32 v101, v42, v43
 v_exp_f32 v45, v45
 v_exp_f32 v46, v46
 v_exp_f32 v47, v47
 v_cvt_pk_bf16_f32 v102, v44, v45
 v_cvt_pk_bf16_f32 v103, v46, v47
 s_nop 1
 v_mfma_f32_32x32x16_bf16 v[80:95], v[244:247], v[100:103], v[80:95]
 s_sub_u32 s28, s36, 16384
 s_cmp_ge_u32 s51, 2
 s_cselect_b32 s28, s28, 2146435072
 s_add_u32 m0, s65, 0
 s_nop 0
 buffer_load_dwordx4 v0, s[4:7], s28 offen sc1 nt lds
 buffer_load_dwordx4 v0, s[4:7], s28 offen offset:1024 sc1 nt lds
 buffer_load_dwordx4 v0, s[4:7], s28 offen offset:2048 sc1 nt lds
 buffer_load_dwordx4 v0, s[4:7], s28 offen offset:3072 sc1 nt lds
 s_getpc_b64 s[30:31]
L_pc31:
 s_sub_u32 s30, s30, L_pc31-L63_aepi
 s_subb_u32 s31, s31, 0
 s_lshl2_add_u32 s3, s54, s50
 s_mul_i32 s3, s3, 256
 v_lshl_add_u32 v2, v0, 3, s3
 v_min_u32 v2, L_codeend-L63_aepi-4, v2
 s_mov_b64 exec, 3
 global_load_dword v191, v2, s[30:31]
 s_mov_b64 exec, -1
 s_cmp_eq_u32 s51, 0
 s_cbranch_scc1 L67_x
 s_waitcnt vmcnt(5)
 s_barrier
 ds_read_b128 v[104:107], v28 offset:28672
 s_mov_b64 exec, s[66:67]
 ds_read_b128 v[240:243], v29 offset:30720
 ds_read_b128 v[244:247], v29 offset:31744
 s_mov_b64 exec, -1
 s_waitcnt lgkmcnt(2)
 v_mfma_f32_32x32x16_bf16 v[32:47], v[104:107], v[112:115], 0
 v_mfma_f32_32x32x16_bf16 v[48:63], v[104:107], v[116:119], 0
 s_nop 10
 v_exp_f32 v32, v32
 v_exp_f32 v33, v33
 v_exp_f32 v34, v34
 v_cvt_pk_bf16_f32 v96, v32, v33
 v_exp_f32 v35, v35
 s_lshl_b32 s28, s50, 14
 s_add_u32 s28, s28, s41
 s_add_u32 s28, s28, 14336
 s_xor_b32 s29, s28, 1024
 buffer_load_dwordx4 v[144:147], v0, s[4:7], s28 offen sc1
 buffer_load_dwordx4 v[148:151], v0, s[4:7], s29 offen sc1
 v_exp_f32 v36, v36
 v_cvt_pk_bf16_f32 v97, v34, v35
 v_exp_f32 v37, v37
 v_exp_f32 v38, v38
 v_cvt_pk_bf16_f32 v98, v36, v37
 v_exp_f32 v39, v39
 v_exp_f32 v40, v40
 v_cvt_pk_bf16_f32 v99, v38, v39
 s_mul_i32 s37, s52, 204800
 s_mul_i32 s3, s50, 0xffffec00
 s_add_u32 s37, s37, s3
 s_add_u32 s37, s37, 19033088
 s_add_u32 m0, s65, 65536
 s_nop 0
 buffer_load_dwordx4 v0, s[4:7], s37 offen sc1 lds
 v_exp_f32 v41, v41
 v_exp_f32 v42, v42
 s_waitcnt lgkmcnt(0)
 v_mfma_f32_32x32x16_bf16 v[64:79], v[240:243], v[96:99], v[64:79]
 v_cvt_pk_bf16_f32 v100, v40, v41
 v_exp_f32 v43, v43
 v_exp_f32 v44, v44
 v_cvt_pk_bf16_f32 v101, v42, v43
 v_exp_f32 v45, v45
 ds_read_b128 v[108:111], v28 offset:24576
 s_mov_b64 exec, s[66:67]
 ds_read_b128 v[248:251], v29 offset:26624
 ds_read_b128 v[252:255], v29 offset:27648
 s_mov_b64 exec, -1
 buffer_load_dwordx4 v0, s[4:7], s37 offen offset:1024 sc1 lds
 v_exp_f32 v46, v46
 v_exp_f32 v47, v47
 v_cvt_pk_bf16_f32 v102, v44, v45
 v_cvt_pk_bf16_f32 v103, v46, v47
 v_exp_f32 v48, v48
 v_exp_f32 v49, v49
 v_mfma_f32_32x32x16_bf16 v[64:79], v[244:247], v[100:103], v[64:79]
 v_exp_f32 v50, v50
 v_cvt_pk_bf16_f32 v96, v48, v49
 v_exp_f32 v51, v51
 buffer_load_dwordx4 v0, s[4:7], s37 offen offset:2048 sc1 lds
 v_exp_f32 v52, v52
 v_cvt_pk_bf16_f32 v97, v50, v51
 s_waitcnt lgkmcnt(0)
 v_mfma_f32_32x32x16_bf16 v[32:47], v[108:111], v[112:115], 0
 v_exp_f32 v53, v53
 v_exp_f32 v54, v54
 v_cvt_pk_bf16_f32 v98, v52, v53
 v_exp_f32 v55, v55
 v_exp_f32 v56, v56
 v_cvt_pk_bf16_f32 v99, v54, v55
 buffer_load_dwordx4 v0, s[4:7], s37 offen offset:3072 sc1 lds
 s_sub_u32 s37, s37, 20480
 v_exp_f32 v57, v57
 v_exp_f32 v58, v58
 v_mfma_f32_32x32x16_bf16 v[80:95], v[240:243], v[96:99], v[80:95]
 v_cvt_pk_bf16_f32 v100, v56, v57
 v_exp_f32 v59, v59
 v_exp_f32 v60, v60
 v_cvt_pk_bf16_f32 v101, v58, v59
 v_exp_f32 v61, v61
 v_exp_f32 v62, v62
 v_exp_f32 v63, v63
 v_cvt_pk_bf16_f32 v102, v60, v61
 v_cvt_pk_bf16_f32 v103, v62, v63
 v_exp_f32 v32, v32
 v_exp_f32 v33, v33
 v_mfma_f32_32x32x16_bf16 v[80:95], v[244:247], v[100:103], v[80:95]
 v_exp_f32 v34, v34
 v_cvt_pk_bf16_f32 v96, v32, v33
 v_exp_f32 v35, v35
 s_add_u32 m0, s65, 81920
 s_nop 0
 buffer_load_dwordx4 v0, s[4:7], s37 offen sc1 lds
 v_exp_f32 v36, v36
 v_cvt_pk_bf16_f32 v97, v34, v35
 v_mfma_f32_32x32x16_bf16 v[48:63], v[108:111], v[116:119], 0
 v_exp_f32 v37, v37
 v_exp_f32 v38, v38
 v_cvt_pk_bf16_f32 v98, v36, v37
 v_exp_f32 v39, v39
 v_exp_f32 v40, v40
 v_cvt_pk_bf16_f32 v99, v38, v39
 buffer_load_dwordx4 v0, s[4:7], s37 offen offset:1024 sc1 lds
 v_exp_f32 v41, v41
 v_exp_f32 v42, v42
 v_mfma_f32_32x32x16_bf16 v[64:79], v[248:251], v[96:99], v[64:79]
 v_cvt_pk_bf16_f32 v100, v40, v41
 v_exp_f32 v43, v43
 v_exp_f32 v44, v44
 v_cvt_pk_bf16_f32 v101, v42, v43
 v_exp_f32 v45, v45
 ds_read_b128 v[104:107], v28 offset:20480
 s_mov_b64 exec, s[66:67]
 ds_read_b128 v[240:243], v29 offset:22528
 ds_read_b128 v[244:247], v29 offset:23552
 s_mov_b64 exec, -1
 v_exp_f32 v46, v46
 v_exp_f32 v47, v47
 v_cvt_pk_bf16_f32 v102, v44, v45
 v_cvt_pk_bf16_f32 v103, v46, v47
 v_exp_f32 v48, v48
 v_exp_f32 v49, v49
 v_mfma_f32_32x32x16_bf16 v[64:79], v[252:255], v[100:103], v[64:79]
 v_exp_f32 v50, v50
 v_cvt_pk_bf16_f32 v96, v48, v49
 v_exp_f32 v51, v51
 buffer_load_dwordx4 v0, s[4:7], s37 offen offset:2048 sc1 lds
 v_exp_f32 v52, v52
 v_cvt_pk_bf16_f32 v97, v50, v51
 s_waitcnt lgkmcnt(0)
 v_mfma_f32_32x32x16_bf16 v[32:47], v[104:107], v[112:115], 0
 v_exp_f32 v53, v53
 v_exp_f32 v54, v54
 v_cvt_pk_bf16_f32 v98, v52, v53
 v_exp_f32 v55, v55
 v_exp_f32 v56, v56
 v_cvt_pk_bf16_f32 v99, v54, v55
 buffer_load_dwordx4 v0, s[4:7], s37 offen offset:3072 sc1 lds
 s_sub_u32 s37, s37, 20480
 v_exp_f32 v57, v57
 v_exp_f32 v58, v58
 v_mfma_f32_32x32x16_bf16 v[80:95], v[248:251], v[96:99], v[80:95]
 v_cvt_pk_bf16_f32 v100, v56, v57
 v_exp_f32 v59, v59
 v_exp_f32 v60, v60
 v_cvt_pk_bf16_f32 v101, v58, v59
 v_exp_f32 v61, v61
 v_exp_f32 v62, v62
 v_exp_f32 v63, v63
 v_cvt_pk_bf16_f32 v102, v60, v61
 v_cvt_pk_bf16_f32 v103, v62, v63
 v_exp_f32 v32, v32
 v_exp_f32 v33, v33
 v_mfma_f32_32x32x16_bf16 v[80:95], v[252:255], v[100:103], v[80:95]
 v_exp_f32 v34, v34
 v_cvt_pk_bf16_f32 v96, v32, v33
 v_exp_f32 v35, v35
 s_add_u32 m0, s65, 98304
 s_nop 0
 buffer_load_dwordx4 v0, s[4:7], s37 offen sc1 lds
 v_exp_f32 v36, v36
 v_cvt_pk_bf16_f32 v97, v34, v35
 v_mfma_f32_32x32x16_bf16 v[48:63], v[104:107], v[116:119], 0
 v_exp_f32 v37, v37
 v_exp_f32 v38, v38
 v_cvt_pk_bf16_f32 v98, v36, v37
 v_exp_f32 v39, v39
 v_exp_f32 v40, v40
 v_cvt_pk_bf16_f32 v99, v38, v39
 buffer_load_dwordx4 v0, s[4:7], s37 offen offset:1024 sc1 lds
 v_exp_f32 v41, v41
 v_exp_f32 v42, v42
 v_mfma_f32_32x32x16_bf16 v[64:79], v[240:243], v[96:99], v[64:79]
 v_cvt_pk_bf16_f32 v100, v40, v41
 v_exp_f32 v43, v43
 v_exp_f32 v44, v44
 v_cvt_pk_bf16_f32 v101, v42, v43
 v_exp_f32 v45, v45
 ds_read_b128 v[108:111], v28 offset:16384
 s_mov_b64 exec, s[66:67]
 ds_read_b128 v[248:251], v29 offset:18432
 ds_read_b128 v[252:255], v29 offset:19456
 s_mov_b64 exec, -1
 v_exp_f32 v46, v46
 v_exp_f32 v47, v47
 v_cvt_pk_bf16_f32 v102, v44, v45
 v_cvt_pk_bf16_f32 v103, v46, v47
 v_exp_f32 v48, v48
 v_exp_f32 v49, v49
 v_mfma_f32_32x32x16_bf16 v[64:79], v[244:247], v[100:103], v[64:79]
 v_exp_f32 v50, v50
 v_cvt_pk_bf16_f32 v96, v48, v49
 v_exp_f32 v51, v51
 buffer_load_dwordx4 v0, s[4:7], s37 offen offset:2048 sc1 lds
 v_exp_f32 v52, v52
 v_cvt_pk_bf16_f32 v97, v50, v51
 s_waitcnt lgkmcnt(0)
 v_mfma_f32_32x32x16_bf16 v[32:47], v[108:111], v[112:115], 0
 v_exp_f32 v53, v53
 v_exp_f32 v54, v54
 v_cvt_pk_bf16_f32 v98, v52, v53
 v_exp_f32 v55, v55
 v_exp_f32 v56, v56
 v_cvt_pk_bf16_f32 v99, v54, v55
 buffer_load_dwordx4 v0, s[4:7], s37 offen offset:3072 sc1 lds
 s_sub_u32 s37, s37, 20480
 v_exp_f32 v57, v57
 v_exp_f32 v58, v58
 v_mfma_f32_32x32x16_bf16 v[80:95], v[240:243], v[96:99], v[80:95]
 v_cvt_pk_bf16_f32 v100, v56, v57
 v_exp_f32 v59, v59
 v_exp_f32 v60, v60
 v_cvt_pk_bf16_f32 v101, v58, v59
 v_exp_f32 v61, v61
 v_exp_f32 v62, v62
 v_exp_f32 v63, v63
 v_cvt_pk_bf16_f32 v102, v60, v61
 v_cvt_pk_bf16_f32 v103, v62, v63
 v_exp_f32 v32, v32
 v_exp_f32 v33, v33
 v_mfma_f32_32x32x16_bf16 v[80:95], v[244:247], v[100:103], v[80:95]
 v_exp_f32 v34, v34
 v_cvt_pk_bf16_f32 v96, v32, v33
 v_exp_f32 v35, v35
 s_add_u32 m0, s65, 114688
 s_nop 0
 buffer_load_dwordx4 v0, s[4:7], s37 offen sc1 lds
 v_exp_f32 v36, v36
 v_cvt_pk_bf16_f32 v97, v34, v35
 v_mfma_f32_32x32x16_bf16 v[48:63], v[108:111], v[116:119], 0
 v_exp_f32 v37, v37
 v_exp_f32 v38, v38
 v_cvt_pk_bf16_f32 v98, v36, v37
 v_exp_f32 v39, v39
 v_exp_f32 v40, v40
 v_cvt_pk_bf16_f32 v99, v38, v39
 buffer_load_dwordx4 v0, s[4:7], s37 offen offset:1024 sc1 lds
 v_exp_f32 v41, v41
 v_exp_f32 v42, v42
 v_mfma_f32_32x32x16_bf16 v[64:79], v[248:251], v[96:99], v[64:79]
 v_cvt_pk_bf16_f32 v100, v40, v41
 v_exp_f32 v43, v43
 v_exp_f32 v44, v44
 v_cvt_pk_bf16_f32 v101, v42, v43
 v_exp_f32 v45, v45
 s_waitcnt vmcnt(17)
 s_barrier
 ds_read_b128 v[104:107], v28 offset:12288
 s_mov_b64 exec, s[66:67]
 ds_read_b128 v[240:243], v29 offset:14336
 ds_read_b128 v[244:247], v29 offset:15360
 s_mov_b64 exec, -1
 v_exp_f32 v46, v46
 v_exp_f32 v47, v47
 v_cvt_pk_bf16_f32 v102, v44, v45
 v_cvt_pk_bf16_f32 v103, v46, v47
 v_exp_f32 v48, v48
 v_exp_f32 v49, v49
 v_mfma_f32_32x32x16_bf16 v[64:79], v[252:255], v[100:103], v[64:79]
 v_exp_f32 v50, v50
 v_cvt_pk_bf16_f32 v96, v48, v49
 v_exp_f32 v51, v51
 buffer_load_dwordx4 v0, s[4:7], s37 offen offset:2048 sc1 lds
 v_exp_f32 v52, v52
 v_cvt_pk_bf16_f32 v97, v50, v51
 s_waitcnt lgkmcnt(0)
 v_mfma_f32_32x32x16_bf16 v[32:47], v[104:107], v[112:115], 0
 v_exp_f32 v53, v53
 v_exp_f32 v54, v54
 v_cvt_pk_bf16_f32 v98, v52, v53
 v_exp_f32 v55, v55
 v_exp_f32 v56, v56
 v_cvt_pk_bf16_f32 v99, v54, v55
 buffer_load_dwordx4 v0, s[4:7], s37 offen offset:3072 sc1 lds
 s_sub_u32 s37, s37, 20480
 v_exp_f32 v57, v57
 v_exp_f32 v58, v58
 v_mfma_f32_32x32x16_bf16 v[80:95], v[248:251], v[96:99], v[80:95]
 v_cvt_pk_bf16_f32 v100, v56, v57
 v_exp_f32 v59, v59
 v_exp_f32 v60, v60
 v_cvt_pk_bf16_f32 v101, v58, v59
 v_exp_f32 v61, v61
 v_exp_f32 v62, v62
 v_exp_f32 v63, v63
 v_cvt_pk_bf16_f32 v102, v60, v61
 v_cvt_pk_bf16_f32 v103, v62, v63
 s_cmp_eq_u32 s51, 1
 s_cbranch_scc1 L77_x
 v_exp_f32 v32, v32
 v_exp_f32 v33, v33
 v_mfma_f32_32x32x16_bf16 v[80:95], v[252:255], v[100:103], v[80:95]
 v_exp_f32 v34, v34
 v_cvt_pk_bf16_f32 v96, v32, v33
 v_exp_f32 v35, v35
 s_add_u32 m0, s65, 131072
 s_nop 0
 buffer_load_dwordx4 v0, s[4:7], s37 offen sc1 lds
 v_exp_f32 v36, v36
 v_cvt_pk_bf16_f32 v97, v34, v35
 v_mfma_f32_32x32x16_bf16 v[48:63], v[104:107], v[116:119], 0
 v_exp_f32 v37, v37
 v_exp_f32 v38, v38
 v_cvt_pk_bf16_f32 v98, v36, v37
 v_exp_f32 v39, v39
 v_exp_f32 v40, v40
 v_cvt_pk_bf16_f32 v99, v38, v39
 buffer_load_dwordx4 v0, s[4:7], s37 offen offset:1024 sc1 lds
 v_exp_f32 v41, v41
 v_exp_f32 v42, v42
 v_mfma_f32_32x32x16_bf16 v[64:79], v[240:243], v[96:99], v[64:79]
 v_cvt_pk_bf16_f32 v100, v40, v41
 v_exp_f32 v43, v43
 v_exp_f32 v44, v44
 v_cvt_pk_bf16_f32 v101, v42, v43
 v_exp_f32 v45, v45
 ds_read_b128 v[108:111], v28 offset:8192
 s_mov_b64 exec, s[66:67]
 ds_read_b128 v[248:251], v29 offset:10240
 ds_read_b128 v[252:255], v29 offset:11264
 s_mov_b64 exec, -1
 v_exp_f32 v46, v46
 v_exp_f32 v47, v47
 v_cvt_pk_bf16_f32 v102, v44, v45
 v_cvt_pk_bf16_f32 v103, v46, v47
 v_exp_f32 v48, v48
 v_exp_f32 v49, v49
 v_mfma_f32_32x32x16_bf16 v[64:79], v[244:247], v[100:103], v[64:79]
 v_exp_f32 v50, v50
 v_cvt_pk_bf16_f32 v96, v48, v49
 v_exp_f32 v51, v51
 buffer_load_dwordx4 v0, s[4:7], s37 offen offset:2048 sc1 lds
 v_exp_f32 v52, v52
 v_cvt_pk_bf16_f32 v97, v50, v51
 s_waitcnt lgkmcnt(0)
 v_mfma_f32_32x32x16_bf16 v[32:47], v[108:111], v[112:115], 0
 v_exp_f32 v53, v53
 v_exp_f32 v54, v54
 v_cvt_pk_bf16_f32 v98, v52, v53
 v_exp_f32 v55, v55
 v_exp_f32 v56, v56
 v_cvt_pk_bf16_f32 v99, v54, v55
 buffer_load_dwordx4 v0, s[4:7], s37 offen offset:3072 sc1 lds
 s_sub_u32 s37, s37, 20480
 v_exp_f32 v57, v57
 v_exp_f32 v58, v58
 v_mfma_f32_32x32x16_bf16 v[80:95], v[240:243], v[96:99], v[80:95]
 v_cvt_pk_bf16_f32 v100, v56, v57
 v_exp_f32 v59, v59
 v_exp_f32 v60, v60
 v_cvt_pk_bf16_f32 v101, v58, v59
 v_exp_f32 v61, v61
 v_exp_f32 v62, v62
 v_exp_f32 v63, v63
 v_cvt_pk_bf16_f32 v102, v60, v61
 v_cvt_pk_bf16_f32 v103, v62, v63
 v_exp_f32 v32, v32
 v_exp_f32 v33, v33
 v_mfma_f32_32x32x16_bf16 v[80:95], v[244:247], v[100:103], v[80:95]
 v_exp_f32 v34, v34
 v_cvt_pk_bf16_f32 v96, v32, v33
 v_exp_f32 v35, v35
 s_add_u32 m0, s65, 147456
 s_nop 0
 buffer_load_dwordx4 v0, s[4:7], s37 offen sc1 lds
 v_exp_f32 v36, v36
 v_cvt_pk_bf16_f32 v97, v34, v35
 v_mfma_f32_32x32x16_bf16 v[48:63], v[108:111], v[116:119], v[224:239]
 v_exp_f32 v37, v37
 v_exp_f32 v38, v38
 v_cvt_pk_bf16_f32 v98, v36, v37
 v_exp_f32 v39, v39
 v_exp_f32 v40, v40
 v_cvt_pk_bf16_f32 v99, v38, v39
 buffer_load_dwordx4 v0, s[4:7], s37 offen offset:1024 sc1 lds
 v_exp_f32 v41, v41
 v_exp_f32 v42, v42
 v_mfma_f32_32x32x16_bf16 v[64:79], v[248:251], v[96:99], v[64:79]
 v_cvt_pk_bf16_f32 v100, v40, v41
 v_exp_f32 v43, v43
 v_exp_f32 v44, v44
 v_cvt_pk_bf16_f32 v101, v42, v43
 v_exp_f32 v45, v45
 ds_read_b128 v[104:107], v28 offset:4096
 s_mov_b64 exec, s[66:67]
 ds_read_b128 v[240:243], v29 offset:6144
 ds_read_b128 v[244:247], v29 offset:7168
 s_mov_b64 exec, -1
 v_exp_f32 v46, v46
 v_exp_f32 v47, v47
 v_cvt_pk_bf16_f32 v102, v44, v45
 v_cvt_pk_bf16_f32 v103, v46, v47
 v_exp_f32 v48, v48
 v_exp_f32 v49, v49
 v_mfma_f32_32x32x16_bf16 v[64:79], v[252:255], v[100:103], v[64:79]
 v_exp_f32 v50, v50
 v_cvt_pk_bf16_f32 v96, v48, v49
 v_exp_f32 v51, v51
 buffer_load_dwordx4 v0, s[4:7], s37 offen offset:2048 sc1 lds
 v_exp_f32 v52, v52
 v_cvt_pk_bf16_f32 v97, v50, v51
 s_waitcnt lgkmcnt(0)
 v_mfma_f32_32x32x16_bf16 v[32:47], v[104:107], v[112:115], v[224:239]
 v_exp_f32 v53, v53
 v_exp_f32 v54, v54
 v_cvt_pk_bf16_f32 v98, v52, v53
 v_exp_f32 v55, v55
 v_exp_f32 v56, v56
 v_cvt_pk_bf16_f32 v99, v54, v55
 buffer_load_dwordx4 v0, s[4:7], s37 offen offset:3072 sc1 lds
 s_sub_u32 s37, s37, 20480
 v_exp_f32 v57, v57
 v_exp_f32 v58, v58
 v_mfma_f32_32x32x16_bf16 v[80:95], v[248:251], v[96:99], v[80:95]
 v_cvt_pk_bf16_f32 v100, v56, v57
 v_exp_f32 v59, v59
 v_exp_f32 v60, v60
 v_cvt_pk_bf16_f32 v101, v58, v59
 v_exp_f32 v61, v61
 v_exp_f32 v62, v62
 v_exp_f32 v63, v63
 v_cvt_pk_bf16_f32 v102, v60, v61
 v_cvt_pk_bf16_f32 v103, v62, v63
 v_exp_f32 v32, v32
 v_exp_f32 v33, v33
 v_mfma_f32_32x32x16_bf16 v[80:95], v[252:255], v[100:103], v[80:95]
 v_exp_f32 v34, v34
 v_cvt_pk_bf16_f32 v96, v32, v33
 v_exp_f32 v35, v35
 v_exp_f32 v36, v36
 v_cvt_pk_bf16_f32 v97, v34, v35
 v_exp_f32 v37, v37
 v_exp_f32 v38, v38
 v_cvt_pk_bf16_f32 v98, v36, v37
 v_exp_f32 v39, v39
 v_exp_f32 v40, v40
 v_cvt_pk_bf16_f32 v99, v38, v39
 v_exp_f32 v41, v41
 v_exp_f32 v42, v42
 v_mfma_f32_32x32x16_bf16 v[64:79], v[240:243], v[96:99], v[64:79]
 v_cvt_pk_bf16_f32 v100, v40, v41
 v_exp_f32 v43, v43
 v_exp_f32 v44, v44
 v_cvt_pk_bf16_f32 v101, v42, v43
 v_exp_f32 v45, v45
 v_exp_f32 v46, v46
 v_exp_f32 v47, v47
 v_cvt_pk_bf16_f32 v102, v44, v45
 v_cvt_pk_bf16_f32 v103, v46, v47
 s_nop 1
 v_mfma_f32_32x32x16_bf16 v[64:79], v[244:247], v[100:103], v[64:79]
 s_branch L63_aepi
L79_spin:
 buffer_load_dword v31, v30, s[4:7], s35 offen offset:0 sc1
 s_sub_u32 s57, s57, 1
 s_cbranch_scc1 L79_spin_x
 s_waitcnt vmcnt(0)
 v_cmp_ne_u32 vcc, s55, v31
 s_cbranch_vccnz L79_spin
 s_branch L80_got
L79_spin_x:
 s_mov_b32 s57, 0
 s_waitcnt vmcnt(0)
 s_branch L80_got
L83_spin:
 buffer_load_dword v31, v30, s[4:7], s28 offen offset:0 sc1
 s_sub_u32 s57, s57, 1
 s_cbranch_scc1 L83_spin_x
 s_waitcnt vmcnt(0)
 v_and_b32 v1, 0xfffffff0, v31
 v_cmp_ne_u32 vcc, s55, v1
 s_cbranch_vccnz L83_spin
 s_branch L84_got
L83_spin_x:
 s_mov_b32 s57, 0
 s_waitcnt vmcnt(0)
 s_branch L84_got
L85_spin:
 buffer_load_dword v31, v30, s[4:7], s28 offen offset:0 sc1
 s_sub_u32 s57, s57, 1
 s_cbranch_scc1 L85_spin_x
 s_waitcnt vmcnt(0)
 v_and_b32 v1, 0xfffffff0, v31
 v_cmp_ne_u32 vcc, s55, v1
 s_cbranch_vccnz L85_spin
 s_branch L86_got
L85_spin_x:
 s_mov_b32 s57, 0
 s_waitcnt vmcnt(0)
 s_branch L86_got
L87_spin:
 buffer_load_dword v31, v30, s[4:7], s28 offen offset:0 sc1
 s_sub_u32 s57, s57, 1
 s_cbranch_scc1 L87_spin_x
 s_waitcnt vmcnt(0)
 v_and_b32 v1, 0xfffffff0, v31
 v_cmp_ne_u32 vcc, s55, v1
 s_cbranch_vccnz L87_spin
 s_branch L88_got
L87_spin_x:
 s_mov_b32 s57, 0
 s_waitcnt vmcnt(0)
 s_branch L88_got
L89_spin:
 buffer_load_dword v31, v30, s[4:7], s28 offen offset:0 sc1
 s_sub_u32 s57, s57, 1
 s_cbranch_scc1 L89_spin_x
 s_waitcnt vmcnt(0)
 v_and_b32 v1, 0xfffffff0, v31
 v_cmp_ne_u32 vcc, s55, v1
 s_cbranch_vccnz L89_spin
 s_branch L90_got
L89_spin_x:
 s_mov_b32 s57, 0
 s_waitcnt vmcnt(0)
 s_branch L90_got
L81_x:
 s_waitcnt vmcnt(0)
 s_barrier
 s_or_b32 s28, s2, s50
 s_cmp_lg_u32 s28, 0
 s_cbranch_scc1 L82_noepoch
 v_lshlrev_b32 v30, 3, v0
 s_mov_b32 s28, 4096
 buffer_load_dword v31, v30, s[4:7], s28 offen sc1
 s_waitcnt vmcnt(0)
 v_and_b32 v1, 0xfffffff0, v31
 v_cmp_ne_u32 vcc, s55, v1
 s_cbranch_vccnz L83_spin
L84_got:
 s_mov_b32 s28, 12288
 buffer_load_dword v31, v30, s[4:7], s28 offen sc1
 s_waitcnt vmcnt(0)
 v_and_b32 v1, 0xfffffff0, v31
 v_cmp_ne_u32 vcc, s55, v1
 s_cbranch_vccnz L85_spin
L86_got:
 s_mov_b32 s28, 20480
 buffer_load_dword v31, v30, s[4:7], s28 offen sc1
 s_waitcnt vmcnt(0)
 v_and_b32 v1, 0xfffffff0, v31
 v_cmp_ne_u32 vcc, s55, v1
 s_cbranch_vccnz L87_spin
L88_got:
 s_mov_b32 s28, 28672
 buffer_load_dword v31, v30, s[4:7], s28 offen sc1
 s_waitcnt vmcnt(0)
 v_and_b32 v1, 0xfffffff0, v31
 v_cmp_ne_u32 vcc, s55, v1
 s_cbranch_vccnz L89_spin
L90_got:
 v_lshrrev_b32 v1, 2, v0
 v_mov_b32 v2, s55
 s_mov_b32 exec_hi, 0
 buffer_store_dword v2, v1, s[4:7], 0 offen sc1
 s_mov_b32 exec_hi, -1
L82_noepoch:
 s_lshl_b32 s28, s50, 14
 s_add_u32 s28, s28, s41
 s_add_u32 s28, s28, 14336
 s_xor_b32 s29, s28, 1024
 buffer_load_dwordx4 v[144:147], v0, s[4:7], s28 offen sc1
 buffer_load_dwordx4 v[148:151], v0, s[4:7], s29 offen sc1
 s_mul_i32 s37, s52, 204800
 s_mul_i32 s3, s50, 0xffffec00
 s_add_u32 s37, s37, s3
 s_add_u32 s37, s37, 19033088
 s_add_u32 m0, s65, 65536
 s_nop 0
 buffer_load_dwordx4 v0, s[4:7], s37 offen sc1 lds
 buffer_load_dwordx4 v0, s[4:7], s37 offen offset:1024 sc1 lds
 buffer_load_dwordx4 v0, s[4:7], s37 offen offset:2048 sc1 lds
 buffer_load_dwordx4 v0, s[4:7], s37 offen offset:3072 sc1 lds
 s_sub_u32 s37, s37, 20480
 s_add_u32 m0, s65, 81920
 s_nop 0
 buffer_load_dwordx4 v0, s[4:7], s37 offen sc1 lds
 buffer_load_dwordx4 v0, s[4:7], s37 offen offset:1024 sc1 lds
 buffer_load_dwordx4 v0, s[4:7], s37 offen offset:2048 sc1 lds
 buffer_load_dwordx4 v0, s[4:7], s37 offen offset:3072 sc1 lds
 s_sub_u32 s37, s37, 20480
 s_add_u32 m0, s65, 98304
 s_nop 0
 buffer_load_dwordx4 v0, s[4:7], s37 offen sc1 lds
 buffer_load_dwordx4 v0, s[4:7], s37 offen offset:1024 sc1 lds
 buffer_load_dwordx4 v0, s[4:7], s37 offen offset:2048 sc1 lds
 buffer_load_dwordx4 v0, s[4:7], s37 offen offset:3072 sc1 lds
 s_sub_u32 s37, s37, 20480
 s_add_u32 m0, s65, 114688
 s_nop 0
 buffer_load_dwordx4 v0, s[4:7], s37 offen sc1 lds
 buffer_load_dwordx4 v0, s[4:7], s37 offen offset:1024 sc1 lds
 buffer_load_dwordx4 v0, s[4:7], s37 offen offset:2048 sc1 lds
 buffer_load_dwordx4 v0, s[4:7], s37 offen offset:3072 sc1 lds
 s_sub_u32 s37, s37, 20480
 s_add_u32 m0, s65, 131072
 s_nop 0
 buffer_load_dwordx4 v0, s[4:7], s37 offen sc1 lds
 buffer_load_dwordx4 v0, s[4:7], s37 offen offset:1024 sc1 lds
 buffer_load_dwordx4 v0, s[4:7], s37 offen offset:2048 sc1 lds
 buffer_load_dwordx4 v0, s[4:7], s37 offen offset:3072 sc1 lds
 s_sub_u32 s37, s37, 20480
 s_add_u32 m0, s65, 147456
 s_nop 0
 buffer_load_dwordx4 v0, s[4:7], s37 offen sc1 lds
 buffer_load_dwordx4 v0, s[4:7], s37 offen offset:1024 sc1 lds
 buffer_load_dwordx4 v0, s[4:7], s37 offen offset:2048 sc1 lds
 buffer_load_dwordx4 v0, s[4:7], s37 offen offset:3072 sc1 lds
 s_sub_u32 s37, s37, 20480
 s_nop 11
 s_branch L63_aepi
L91_x:
 s_waitcnt lgkmcnt(0)
 v_mfma_f32_32x32x16_bf16 v[80:95], v[252:255], v[100:103], v[80:95]
 s_add_u32 m0, s65, 131072
 s_nop 0
 buffer_load_dwordx4 v0, s[4:7], s37 offen sc1 lds
 buffer_load_dwordx4 v0, s[4:7], s37 offen offset:1024 sc1 lds
 buffer_load_dwordx4 v0, s[4:7], s37 offen offset:2048 sc1 lds
 buffer_load_dwordx4 v0, s[4:7], s37 offen offset:3072 sc1 lds
 s_sub_u32 s37, s37, 20480
 s_add_u32 m0, s65, 147456
 s_nop 0
 buffer_load_dwordx4 v0, s[4:7], s37 offen sc1 lds
 buffer_load_dwordx4 v0, s[4:7], s37 offen offset:1024 sc1 lds
 buffer_load_dwordx4 v0, s[4:7], s37 offen offset:2048 sc1 lds
 buffer_load_dwordx4 v0, s[4:7], s37 offen offset:3072 sc1 lds
 s_sub_u32 s37, s37, 20480
 s_nop 11
 s_branch L63_aepi
L92_fb:
 s_waitcnt lgkmcnt(0)
 s_nop 15
 s_min_u32 s33, s21, 8
 s_add_u32 s34, s71, 8
 s_lshl_b32 s34, s34, 12
 v_add_u32 v30, s34, v28
 v_add_u32 v31, s34, v29
 s_mov_b32 s32, 0
 v_mov_b32 v2, 0xff7fffff
L92_fb_p1:
 ds_read_b128 v[104:107], v30 offset:0
 s_waitcnt lgkmcnt(0)
 s_cmp_eq_u32 s32, 0
 s_cbranch_scc1 L92_fb_xa
 s_cmp_eq_u32 s32, 8
 s_cbranch_scc1 L92_fb_xb
 v_mfma_f32_32x32x16_bf16 v[32:47], v[104:107], v[116:119], 0
 s_branch L92_fb_xc
L92_fb_xa:
 v_mfma_f32_32x32x16_bf16 v[32:47], v[104:107], v[116:119], v[208:223]
 s_branch L92_fb_xc
L92_fb_xb:
 v_mfma_f32_32x32x16_bf16 v[32:47], v[104:107], v[116:119], v[224:239]
L92_fb_xc:
 s_nop 15
 v_max3_f32 v2, v2, v32, v33
 v_max3_f32 v2, v2, v34, v35
 v_max3_f32 v2, v2, v36, v37
 v_max3_f32 v2, v2, v38, v39
 v_max3_f32 v2, v2, v40, v41
 v_max3_f32 v2, v2, v42, v43
 v_max3_f32 v2, v2, v44, v45
 v_max3_f32 v2, v2, v46, v47
 v_subrev_u32 v30, 4096, v30
 v_subrev_u32 v31, 4096, v31
 s_add_u32 s32, s32, 1
 s_cmp_le_u32 s32, s33
 s_cbranch_scc1 L92_fb_p1
 v_mov_b32 v1, v2
 s_nop 1
 v_permlane32_swap_b32 v1, v2
 v_max_f32 v2, v2, v1
 v_mov_b32 v80, 0
 v_mov_b32 v81, 0
 v_mov_b32 v82, 0
 v_mov_b32 v83, 0
 v_mov_b32 v84, 0
 v_mov_b32 v85, 0
 v_mov_b32 v86, 0
 v_mov_b32 v87, 0
 v_mov_b32 v88, 0
 v_mov_b32 v89, 0
 v_mov_b32 v90, 0
 v_mov_b32 v91, 0
 v_mov_b32 v92, 0
 v_mov_b32 v93, 0
 v_mov_b32 v94, 0
 v_mov_b32 v95, 0
 v_add_u32 v30, s34, v28
 v_add_u32 v31, s34, v29
 s_mov_b32 s32, 0
L92_fb_p2:
 s_mov_b64 exec, s[66:67]
 ds_read_b128 v[240:243], v31 offset:2048
 ds_read_b128 v[244:247], v31 offset:3072
 s_mov_b64 exec, -1
 ds_read_b128 v[104:107], v30 offset:0
 s_waitcnt lgkmcnt(0)
 s_cmp_eq_u32 s32, 0
 s_cbranch_scc1 L92_fb_ya
 s_cmp_eq_u32 s32, 8
 s_cbranch_scc1 L92_fb_yb
 v_mfma_f32_32x32x16_bf16 v[32:47], v[104:107], v[116:119], 0
 s_branch L92_fb_yc
L92_fb_ya:
 v_mfma_f32_32x32x16_bf16 v[32:47], v[104:107], v[116:119], v[208:223]
 s_branch L92_fb_yc
L92_fb_yb:
 v_mfma_f32_32x32x16_bf16 v[32:47], v[104:107], v[116:119], v[224:239]
L92_fb_yc:
 s_nop 15
 v_sub_f32 v32, v32, v2
 v_sub_f32 v33, v33, v2
 v_sub_f32 v34, v34, v2
 v_sub_f32 v35, v35, v2
 v_sub_f32 v36, v36, v2
 v_sub_f32 v37, v37, v2
 v_sub_f32 v38, v38, v2
 v_sub_f32 v39, v39, v2
 v_sub_f32 v40, v40, v2
 v_sub_f32 v41, v41, v2
 v_sub_f32 v42, v42, v2
 v_sub_f32 v43, v43, v2
 v_sub_f32 v44, v44, v2
 v_sub_f32 v45, v45, v2
 v_sub_f32 v46, v46, v2
 v_sub_f32 v47, v47, v2
 v_exp_f32 v32, v32
 v_exp_f32 v33, v33
 v_exp_f32 v34, v34
 v_exp_f32 v35, v35
 v_exp_f32 v36, v36
 v_exp_f32 v37, v37
 v_exp_f32 v38, v38
 v_exp_f32 v39, v39
 v_exp_f32 v40, v40
 v_exp_f32 v41, v41
 v_exp_f32 v42, v42
 v_exp_f32 v43, v43
 v_exp_f32 v44, v44
 v_exp_f32 v45, v45
 v_exp_f32 v46, v46
 v_exp_f32 v47, v47
 v_cvt_pk_bf16_f32 v96, v32, v33
 v_cvt_pk_bf16_f32 v97, v34, v35
 v_cvt_pk_bf16_f32 v98, v36, v37
 v_cvt_pk_bf16_f32 v99, v38, v39
 v_cvt_pk_bf16_f32 v100, v40, v41
 v_cvt_pk_bf16_f32 v101, v42, v43
 v_cvt_pk_bf16_f32 v102, v44, v45
 v_cvt_pk_bf16_f32 v103, v46, v47
 v_mfma_f32_32x32x16_bf16 v[80:95], v[240:243], v[96:99], v[80:95]
 s_nop 0
 v_mfma_f32_32x32x16_bf16 v[80:95], v[244:247], v[100:103], v[80:95]
 s_nop 15
 v_subrev_u32 v30, 4096, v30
 v_subrev_u32 v31, 4096, v31
 s_add_u32 s32, s32, 1
 s_cmp_le_u32 s32, s33
 s_cbranch_scc1 L92_fb_p2
 s_branch L93_fbret
L94_fb:
 s_waitcnt lgkmcnt(0)
 s_nop 15
 s_min_u32 s33, s20, 8
 s_add_u32 s34, s70, 8
 s_lshl_b32 s34, s34, 12
 v_add_u32 v30, s34, v28
 v_add_u32 v31, s34, v29
 s_mov_b32 s32, 0
 v_mov_b32 v2, 0xff7fffff
L94_fb_p1:
 ds_read_b128 v[104:107], v30 offset:0
 s_waitcnt lgkmcnt(0)
 s_cmp_eq_u32 s32, 0
 s_cbranch_scc1 L94_fb_xa
 s_cmp_eq_u32 s32, 8
 s_cbranch_scc1 L94_fb_xb
 v_mfma_f32_32x32x16_bf16 v[32:47], v[104:107], v[112:115], 0
 s_branch L94_fb_xc
L94_fb_xa:
 v_mfma_f32_32x32x16_bf16 v[32:47], v[104:107], v[112:115], v[208:223]
 s_branch L94_fb_xc
L94_fb_xb:
 v_mfma_f32_32x32x16_bf16 v[32:47], v[104:107], v[112:115], v[224:239]
L94_fb_xc:
 s_nop 15
 v_max3_f32 v2, v2, v32, v33
 v_max3_f32 v2, v2, v34, v35
 v_max3_f32 v2, v2, v36, v37
 v_max3_f32 v2, v2, v38, v39
 v_max3_f32 v2, v2, v40, v41
 v_max3_f32 v2, v2, v42, v43
 v_max3_f32 v2, v2, v44, v45
 v_max3_f32 v2, v2, v46, v47
 v_subrev_u32 v30, 4096, v30
 v_subrev_u32 v31, 4096, v31
 s_add_u32 s32, s32, 1
 s_cmp_le_u32 s32, s33
 s_cbranch_scc1 L94_fb_p1
 v_mov_b32 v1, v2
 s_nop 1
 v_permlane32_swap_b32 v1, v2
 v_max_f32 v2, v2, v1
 v_mov_b32 v64, 0
 v_mov_b32 v65, 0
 v_mov_b32 v66, 0
 v_mov_b32 v67, 0
 v_mov_b32 v68, 0
 v_mov_b32 v69, 0
 v_mov_b32 v70, 0
 v_mov_b32 v71, 0
 v_mov_b32 v72, 0
 v_mov_b32 v73, 0
 v_mov_b32 v74, 0
 v_mov_b32 v75, 0
 v_mov_b32 v76, 0
 v_mov_b32 v77, 0
 v_mov_b32 v78, 0
 v_mov_b32 v79, 0
 v_add_u32 v30, s34, v28
 v_add_u32 v31, s34, v29
 s_mov_b32 s32, 0
L94_fb_p2:
 s_mov_b64 exec, s[66:67]
 ds_read_b128 v[240:243], v31 offset:2048
 ds_read_b128 v[244:247], v31 offset:3072
 s_mov_b64 exec, -1
 ds_read_b128 v[104:107], v30 offset:0
 s_waitcnt lgkmcnt(0)
 s_cmp_eq_u32 s32, 0
 s_cbranch_scc1 L94_fb_ya
 s_cmp_eq_u32 s32, 8
 s_cbranch_scc1 L94_fb_yb
 v_mfma_f32_32x32x16_bf16 v[32:47], v[104:107], v[112:115], 0
 s_branch L94_fb_yc
L94_fb_ya:
 v_mfma_f32_32x32x16_bf16 v[32:47], v[104:107], v[112:115], v[208:223]
 s_branch L94_fb_yc
L94_fb_yb:
 v_mfma_f32_32x32x16_bf16 v[32:47], v[104:107], v[112:115], v[224:239]
L94_fb_yc:
 s_nop 15
 v_sub_f32 v32, v32, v2
 v_sub_f32 v33, v33, v2
 v_sub_f32 v34, v34, v2
 v_sub_f32 v35, v35, v2
 v_sub_f32 v36, v36, v2
 v_sub_f32 v37, v37, v2
 v_sub_f32 v38, v38, v2
 v_sub_f32 v39, v39, v2
 v_sub_f32 v40, v40, v2
 v_sub_f32 v41, v41, v2
 v_sub_f32 v42, v42, v2
 v_sub_f32 v43, v43, v2
 v_sub_f32 v44, v44, v2
 v_sub_f32 v45, v45, v2
 v_sub_f32 v46, v46, v2
 v_sub_f32 v47, v47, v2
 v_exp_f32 v32, v32
 v_exp_f32 v33, v33
 v_exp_f32 v34, v34
 v_exp_f32 v35, v35
 v_exp_f32 v36, v36
 v_exp_f32 v37, v37
 v_exp_f32 v38, v38
 v_exp_f32 v39, v39
 v_exp_f32 v40, v40
 v_exp_f32 v41, v41
 v_exp_f32 v42, v42
 v_exp_f32 v43, v43
 v_exp_f32 v44, v44
 v_exp_f32 v45, v45
 v_exp_f32 v46, v46
 v_exp_f32 v47, v47
 v_cvt_pk_bf16_f32 v96, v32, v33
 v_cvt_pk_bf16_f32 v97, v34, v35
 v_cvt_pk_bf16_f32 v98, v36, v37
 v_cvt_pk_bf16_f32 v99, v38, v39
 v_cvt_pk_bf16_f32 v100, v40, v41
 v_cvt_pk_bf16_f32 v101, v42, v43
 v_cvt_pk_bf16_f32 v102, v44, v45
 v_cvt_pk_bf16_f32 v103, v46, v47
 v_mfma_f32_32x32x16_bf16 v[64:79], v[240:243], v[96:99], v[64:79]
 s_nop 0
 v_mfma_f32_32x32x16_bf16 v[64:79], v[244:247], v[100:103], v[64:79]
 s_nop 15
 v_subrev_u32 v30, 4096, v30
 v_subrev_u32 v31, 4096, v31
 s_add_u32 s32, s32, 1
 s_cmp_le_u32 s32, s33
 s_cbranch_scc1 L94_fb_p2
 s_branch L95_fbret
L96_rel:
 s_waitcnt vmcnt(0)
 buffer_wbl2 sc1
 s_waitcnt vmcnt(0)
 buffer_store_dword v2, v0, s[4:7], s24 offen sc1
 buffer_store_dword v2, v0, s[4:7], s25 offen sc1
 s_branch L97_relb
L100_rel:
 s_waitcnt vmcnt(0)
 buffer_wbl2 sc1
 s_waitcnt vmcnt(0)
 buffer_store_dword v2, v0, s[4:7], s30 offen sc1
 s_branch L101_relb
L104_rel:
 s_waitcnt vmcnt(0)
 buffer_wbl2 sc1
 s_waitcnt vmcnt(0)
 buffer_store_dword v2, v0, s[4:7], s30 offen sc1
 s_branch L105_relb
L106_spin:
 buffer_load_dword v240, v1, s[4:7], s28 offen offset:64 sc1
 s_sub_u32 s57, s57, 1
 s_cbranch_scc1 L106_spin_x
 s_waitcnt vmcnt(0)
 v_cmp_ne_u32 vcc, s55, v240
 s_cbranch_vccnz L106_spin
 s_branch L107_got
L106_spin_x:
 s_mov_b32 s57, 0
 s_waitcnt vmcnt(0)
 s_branch L107_got
L108_rel:
 s_waitcnt vmcnt(0)
 buffer_wbl2 sc1
 s_waitcnt vmcnt(0)
 buffer_store_dword v2, v0, s[4:7], s36 offen sc1
 s_branch L109_relb
L112_rel:
 s_waitcnt vmcnt(0)
 buffer_wbl2 sc1
 s_waitcnt vmcnt(0)
 buffer_store_dword v2, v0, s[4:7], s38 offen sc1
 s_branch L113_relb
L114_spin:
 buffer_load_dword v160, v4, s[4:7], s26 offen offset:0 sc1
 s_sub_u32 s57, s57, 1
 s_cbranch_scc1 L114_spin_x
 s_waitcnt vmcnt(0)
 v_cmp_ne_u32 vcc, s55, v160
 s_cbranch_vccnz L114_spin
 s_branch L115_got
L114_spin_x:
 s_mov_b32 s57, 0
 s_waitcnt vmcnt(0)
 s_branch L115_got
L110_five:
 s_nop 8
 v_pk_mul_f32 v[224:225], v[2:3], v[224:225] op_sel:[1,0]
 v_pk_mul_f32 v[226:227], v[2:3], v[226:227] op_sel:[1,0]
 v_pk_mul_f32 v[228:229], v[2:3], v[228:229] op_sel:[1,0]
 v_pk_mul_f32 v[230:231], v[2:3], v[230:231] op_sel:[1,0]
 v_pk_mul_f32 v[224:225], v[224:225], v[232:233]
 v_pk_mul_f32 v[226:227], v[226:227], v[234:235]
 v_pk_mul_f32 v[228:229], v[228:229], v[236:237]
 v_pk_mul_f32 v[230:231], v[230:231], v[238:239]
 v_cvt_pk_bf16_f32 v224, v224, v225
 v_cvt_pk_bf16_f32 v225, v226, v227
 v_cvt_pk_bf16_f32 v226, v228, v229
 v_cvt_pk_bf16_f32 v227, v230, v231
 buffer_store_dwordx4 v[224:227], v0, s[4:7], s34 offen
 buffer_load_dword v160, v4, s[4:7], s26 offen sc1
 s_mov_b32 s39, 2146435072
 s_waitcnt lgkmcnt(0)
 v_mov_b32 v2, s55
 s_cmp_lg_u32 s68, 0
 s_mov_b64 exec, 1
 s_waitcnt vmcnt(1)
 s_cbranch_scc1 L112_rel
 buffer_store_dword v2, v0, s[4:7], s38 offen
L113_relb:
 s_mov_b64 exec, -1
 s_waitcnt vmcnt(1)
 v_cmp_ne_u32 vcc, s55, v160
 s_cbranch_vccnz L114_spin
L115_got:
 buffer_load_dwordx4 v[160:163], v0, s[4:7], s42 offen sc1
 buffer_load_dwordx4 v[164:167], v0, s[4:7], s42 offen offset:1024 sc1
 buffer_load_dwordx4 v[168:171], v0, s[4:7], s42 offen offset:2048 sc1
 buffer_load_dwordx4 v[172:175], v0, s[4:7], s42 offen offset:3072 sc1
 s_add_u32 s46, s42, 4096
 buffer_load_dwordx4 v[176:179], v0, s[4:7], s46 offen offset:1024 sc1
 buffer_load_dwordx4 v[180:183], v0, s[4:7], s46 offen offset:2048 sc1
 buffer_load_dwordx4 v[184:187], v0, s[4:7], s46 offen offset:3072 sc1
 s_add_u32 s46, s42, 8192
 buffer_load_dwordx4 v[188:191], v0, s[4:7], s46 offen sc1
 buffer_load_dwordx4 v[192:195], v0, s[4:7], s46 offen offset:2048 sc1
 buffer_load_dwordx4 v[196:199], v0, s[4:7], s46 offen offset:3072 sc1
 s_add_u32 s46, s42, 12288
 buffer_load_dwordx4 v[200:203], v0, s[4:7], s46 offen sc1
 buffer_load_dwordx4 v[204:207], v0, s[4:7], s46 offen offset:1024 sc1
 buffer_store_dword v2, v0, s[4:7], s39 offen
 buffer_store_dword v2, v0, s[4:7], s39 offen
 s_branch L111_gujoin
L116_spin:
 buffer_load_dword v160, v4, s[4:7], s26 offen offset:0 sc1
 s_sub_u32 s57, s57, 1
 s_cbranch_scc1 L116_spin_x
 s_waitcnt vmcnt(0)
 v_cmp_ne_u32 vcc, s55, v160
 s_cbranch_vccnz L116_spin
 s_branch L117_got
L116_spin_x:
 s_mov_b32 s57, 0
 s_waitcnt vmcnt(0)
 s_branch L117_got
L118_rel:
 s_waitcnt vmcnt(0)
 buffer_wbl2 sc1
 s_waitcnt vmcnt(0)
 buffer_store_dword v2, v0, s[4:7], s38 offen sc1
 s_branch L119_relb
L120_rel:
 s_waitcnt vmcnt(0)
 buffer_wbl2 sc1
 s_waitcnt vmcnt(0)
 buffer_store_dword v2, v0, s[4:7], s39 offen sc1
 s_branch L121_relb
L122_spin:
 buffer_load_dword v3, v4, s[4:7], s26 offen offset:64 sc1
 s_sub_u32 s57, s57, 1
 s_cbranch_scc1 L122_spin_x
 s_waitcnt vmcnt(0)
 v_cmp_ne_u32 vcc, s55, v3
 s_cbranch_vccnz L122_spin
 s_branch L123_got
L122_spin_x:
 s_mov_b32 s57, 0
 s_waitcnt vmcnt(0)
 s_branch L123_got
L124_spin:
 buffer_load_dword v3, v8, s[4:7], s32 offen offset:0 sc1
 s_sub_u32 s57, s57, 1
 s_cbranch_scc1 L124_spin_x
 s_waitcnt vmcnt(0)
 v_cmp_ne_u32 vcc, s55, v3
 s_cbranch_vccnz L124_spin
 s_branch L125_got
L124_spin_x:
 s_mov_b32 s57, 0
 s_waitcnt vmcnt(0)
 s_branch L125_got
L_codeend:
 s_endpgm
.section .rodata,"a"
.p2align 6
.amdhsa_kernel interleave_layers__sliding_block__glu_gated_bilinear__prompt_kernel
  .amdhsa_next_free_vgpr 512
  .amdhsa_next_free_sgpr 102
  .amdhsa_accum_offset 256
  .amdhsa_group_segment_fixed_size 0
  .amdhsa_kernarg_size 80
  .amdhsa_user_sgpr_count 2
  .amdhsa_user_sgpr_kernarg_segment_ptr 1
  .amdhsa_system_sgpr_workgroup_id_x 1
.end_amdhsa_kernel
```
